```python
import torch

def _softmax(x, axis=-1):
    return torch.softmax(x, dim=axis)
def _gelu(x):
    return torch.nn.functional.gelu(x, approximate="tanh")
def _silu(x):
    return torch.nn.functional.silu(x)
def _sigmoid(x):
    return torch.sigmoid(x)
def _layernorm(x, axis=-1, eps=1e-5):
    m = x.mean(dim=axis, keepdim=True)
    v = x.var(dim=axis, keepdim=True, unbiased=False)
    return (x - m) / torch.sqrt(v + eps)
def _scatter_add(tgt, idx, src, axis=0):
    return tgt.clone().index_add_(axis, idx, src)
def _segment_sum(src, seg, n):
    out = torch.zeros((n,) + src.shape[1:], dtype=src.dtype)
    return out.index_add_(0, seg, src)
def _pad(x, pw):
    flat = tuple(v for pair in reversed(pw) for v in pair)
    return torch.nn.functional.pad(x, flat)

kernel_name = 'sequential_preLN__grouped_kv_mqa__glu_gated_geglu__prompt'

def setup_inputs():

    _w = (lambda a: (lambda t: t.to(torch.bfloat16) if t.is_floating_point() else t)(torch.as_tensor(a)))
    def _A_setup():
        B, S, D, H = 1, 2048, 576, 32
        Dh = D // H
        return {
            "x": _w((lambda *s: torch.randn(*s, dtype=torch.bfloat16) * 0.05)(B, S, D)),
            "wq": _w((lambda *s: torch.randn(*s, dtype=torch.bfloat16) * 0.05)(D, H * Dh)),
            "wk": _w((lambda *s: torch.randn(*s, dtype=torch.bfloat16) * 0.05)(D, Dh)),
            "wv": _w((lambda *s: torch.randn(*s, dtype=torch.bfloat16) * 0.05)(D, Dh)),
            "wo": _w((lambda *s: torch.randn(*s, dtype=torch.bfloat16) * 0.05)(H * Dh, D)),
        }
    _A_in = _A_setup()

    def _B_setup():
        B, S, Dm, Df = 1, 2048, 576, 4608
        return {
            "x": _w((lambda *s: torch.randn(*s, dtype=torch.bfloat16) * 0.05)(B, S, Dm)),
            "w_gate": _w((lambda *s: torch.randn(*s, dtype=torch.bfloat16) * 0.8)(Dm, Df) * (Dm ** -0.5)),
            "w_up": _w((lambda *s: torch.randn(*s, dtype=torch.bfloat16) * 0.8)(Dm, Df) * (Dm ** -0.5)),
            "w_down": _w((lambda *s: torch.randn(*s, dtype=torch.bfloat16) * 0.8)(Df, Dm) * (Df ** -0.5)),
        }
    _B_in = _B_setup()

    return {
        "A_x": _A_in["x"],
        "A_wq": _A_in["wq"],
        "A_wk": _A_in["wk"],
        "A_wv": _A_in["wv"],
        "A_wo": _A_in["wo"],
        "B_x": _B_in["x"],
        "B_w_gate": _B_in["w_gate"],
        "B_w_up": _B_in["w_up"],
        "B_w_down": _B_in["w_down"],
    }

def reference(A_x, A_wq, A_wk, A_wv, A_wo, B_x, B_w_gate, B_w_up, B_w_down):
    def _A_ref(x, wq, wk, wv, wo):
        B, S, D = x.shape
        H = 32
        Dh = D // H
        q = (lambda x, *d: x.permute(*d))((x @ wq).reshape(B, S, H, Dh), 0, 2, 1, 3)
        k = x @ wk
        v = x @ wv
        scores = torch.einsum("bhqd,bkd->bhqk", q, k) * (Dh ** -0.5)
        p = _softmax(scores, axis=-1)
        o = torch.einsum("bhqk,bkd->bhqd", p, v)
        return (lambda x, *d: x.permute(*d))(o, 0, 2, 1, 3).reshape(B, S, H * Dh) @ wo

    def _B_ref(x, w_gate, w_up, w_down):
        g = torch.einsum("bsd,df->bsf", x, w_gate)
        u = torch.einsum("bsd,df->bsf", x, w_up)
        h = _gelu(g) * u
        return torch.einsum("bsf,fd->bsd", h, w_down)

    x = A_x
    h = x + _A_ref(_layernorm(x, axis=-1), A_wq, A_wk, A_wv, A_wo)
    h2 = h + _B_ref(_layernorm(h, axis=-1), B_w_gate, B_w_up, B_w_down)
    return h2
```

```asm
; @launch grid=(256,1,1) block=(256,1,1) lds=163840
.amdgcn_target "amdgcn-amd-amdhsa--gfx950"
.text
.globl sequential_preLN__grouped_kv_mqa__glu_gated_geglu__prompt_kernel
.p2align 12
.p2align 8
.type sequential_preLN__grouped_kv_mqa__glu_gated_geglu__prompt_kernel,@function
sequential_preLN__grouped_kv_mqa__glu_gated_geglu__prompt_kernel:
    s_cmp_ge_u32 s2, 256
    s_cbranch_scc1 KM_end
    s_load_dwordx8 s[36:43], s[0:1], 0
    s_load_dwordx2 s[20:21], s[0:1], 88
    s_load_dwordx2 s[16:17], s[0:1], 80
    v_lshrrev_b32 v1, 6, v0
    v_and_b32 v0, 63, v0
    v_readfirstlane_b32 s26, v1
    s_and_b32 s46, s2, 7
    s_lshr_b32 s3, s2, 3
    s_mul_i32 s46, s46, 31
    s_add_u32 s46, s46, s3
    s_cmp_eq_u32 s3, 31
    s_cselect_b32 s61, s2, s46
    s_mul_i32 s27, s61, 373
    s_lshr_b32 s27, s27, 12
    s_cmp_ge_u32 s27, 22
    s_cbranch_scc1 KA_aux
    s_lshl2_add_u32 s49, s61, s26
    s_mul_i32 s48, s49, 2560
    s_mul_i32 s47, s27, 2048
    s_sub_u32 s48, s48, s47
    v_lshlrev_b32 v118, 7, v0
    v_min_u32 v119, 2432, v118
    s_mov_b32 s10, 2359296
    s_mov_b32 s11, 0x20000
    s_waitcnt lgkmcnt(0)
    s_mov_b64 s[8:9], s[36:37]
    buffer_load_dword v149, v119, s[8:11], s48 offen
    s_mov_b64 s[12:13], s[38:39]
    s_mov_b32 s14, 663552
    s_mov_b32 s15, 0x20000
    v_min_u32 v120, 384, v118
    s_mul_i32 s49, s49, 512
    s_add_u32 s49, s49, 221184
    buffer_load_dword v149, v120, s[12:15], s49 offen
    s_mul_i32 s47, s27, 11
    s_sub_u32 s25, s61, s47
    s_mul_i32 s24, s27, 96
    s_cmp_eq_u32 s25, 10
    s_cselect_b32 s47, 48, 0
    s_add_u32 s24, s24, s47
    v_lshrrev_b32 v118, 3, v0
    v_and_b32 v124, 7, v0
    s_and_b32 s46, s26, 1
    s_lshl_b32 s46, s46, 2
    v_lshrrev_b32 v125, 1, v118
    v_xor_b32 v121, v124, v125
    v_xor_b32 v121, s46, v121
    v_mul_u32_u24 v108, 1152, v118
    v_lshl_add_u32 v108, v121, 4, v108
    s_lshl3_add_u32 s28, s26, s24
    s_mul_i32 s28, s28, 1152
    v_add_u32 v108, s28, v108
    v_add_u32 v109, 36864, v108
    v_add_u32 v110, 73728, v108
    s_lshl_b32 s60, s26, 10
    v_lshlrev_b32 v125, 1, v125
    v_xor_b32 v124, v124, v125
    v_lshrrev_b32 v125, 2, v118
    v_lshl_add_u32 v118, v125, 2, v118
    s_lshr_b32 s47, s26, 1
    s_lshl4_add_u32 s46, s47, s46
    v_add_u32 v118, s46, v118
    v_mov_b32 v127, 0
    s_mov_b32 s45, 0
    s_cmp_ge_u32 s25, 9
    s_cbranch_scc1 KA_lkv
    v_mul_u32_u24 v126, 1152, v118
    v_lshl_add_u32 v126, v124, 4, v126
    v_lshl_add_u32 v126, s25, 7, v126
    v_lshl_add_u64 v[112:113], s[38:39], 0, v[126:127]
    s_mov_b32 s44, 36864
    s_branch KA_lgo
KA_lkv:
    v_mul_u32_u24 v126, 36, v118
    v_and_b32 v125, 3, v124
    v_lshlrev_b32 v125, 4, v125
    v_min_u32 v125, 20, v125
    v_add_u32 v126, v126, v125
    v_cmp_lt_u32 vcc, 3, v124
    v_lshl_add_u64 v[112:113], s[40:41], 0, v[126:127]
    v_lshl_add_u64 v[126:127], s[42:43], 0, v[126:127]
    v_cndmask_b32 v112, v112, v126, vcc
    v_cndmask_b32 v113, v113, v127, vcc
    s_mov_b32 s44, 1152
    s_add_u32 s46, s24, 48
    s_mul_i32 s46, s46, 1152
    s_min_u32 s10, s10, s46
KA_lgo:
    s_add_u32 m0, s60, 13312
    s_nop 0
    global_load_lds_dwordx4 v[112:113], off
    v_lshl_add_u64 v[112:113], s[44:45], 0, v[112:113]
    s_add_u32 m0, s60, 1024
    s_nop 0
    buffer_load_dwordx4 v108, s[8:11], 0 offen offset:0 lds
    s_add_u32 m0, s60, 17408
    s_nop 0
    global_load_lds_dwordx4 v[112:113], off
    v_lshl_add_u64 v[112:113], s[44:45], 0, v[112:113]
    s_add_u32 m0, s60, 5120
    s_nop 0
    buffer_load_dwordx4 v109, s[8:11], 0 offen offset:0 lds
    s_add_u32 m0, s60, 9216
    s_nop 0
    buffer_load_dwordx4 v110, s[8:11], 0 offen offset:0 lds
    s_add_u32 m0, s60, 33792
    s_nop 0
    global_load_lds_dwordx4 v[112:113], off
    v_lshl_add_u64 v[112:113], s[44:45], 0, v[112:113]
    s_add_u32 m0, s60, 21376
    s_nop 0
    buffer_load_dwordx4 v108, s[8:11], 0 offen offset:128 lds
    s_add_u32 m0, s60, 37888
    s_nop 0
    global_load_lds_dwordx4 v[112:113], off
    v_lshl_add_u64 v[112:113], s[44:45], 0, v[112:113]
    s_add_u32 m0, s60, 25472
    s_nop 0
    buffer_load_dwordx4 v109, s[8:11], 0 offen offset:128 lds
    s_add_u32 m0, s60, 29568
    s_nop 0
    buffer_load_dwordx4 v110, s[8:11], 0 offen offset:128 lds
    v_and_b32 v1, 15, v0
    v_lshrrev_b32 v2, 4, v0
    s_mov_b32 s22, 268435456
    s_mov_b32 s23, 0x20000
    s_mov_b32 s18, 256
    s_mov_b32 s19, 0x20000
    s_waitcnt lgkmcnt(0)
    s_lshl_b32 s46, s61, 12
    s_mul_i32 s47, s26, 1024
    s_add_u32 s46, s46, s47
    s_add_u32 s46, s46, 41943040
    v_min_u32 v148, 7, v0
    v_lshlrev_b32 v148, 7, v148
    buffer_load_dword v149, v148, s[20:23], s46 offen
    s_lshr_b32 s28, s26, 1
    s_and_b32 s29, s26, 1
    s_lshl1_add_u32 s30, s29, s28
    s_cmp_ge_u32 s25, 9
    s_cselect_b32 s31, 0, s28
    s_mul_i32 s31, s31, 48
    v_lshrrev_b32 v118, 1, v1
    v_xor_b32 v118, v118, v2
    v_add_u32 v119, s31, v1
    v_lshlrev_b32 v120, 7, v119
    v_lshl_add_u32 v3, v118, 4, v120
    s_lshl_b32 s46, s29, 6
    v_xor_b32 v3, s46, v3
    v_xor_b32 v4, 64, v3
    v_lshrrev_b32 v118, 2, v1
    v_and_b32 v120, 1, v2
    v_lshl_add_u32 v120, v120, 2, v118
    v_lshrrev_b32 v121, 1, v120
    v_xor_b32 v121, s30, v121
    v_lshrrev_b32 v122, 1, v2
    v_lshl_add_u32 v120, v122, 4, v120
    v_lshlrev_b32 v120, 7, v120
    v_lshl_add_u32 v120, v121, 5, v120
    v_and_b32 v121, 3, v0
    v_lshl_add_u32 v5, v121, 3, v120
    v_lshl_add_u32 v5, s29, 12, v5
    v_xor_b32 v6, 32, v5
    v_xor_b32 v7, 4096, v5
    v_xor_b32 v8, 4096, v6
    v_mov_b32 v64, 0x3f803f80
    v_mov_b32 v65, 0x3f803f80
    v_mov_b32 v66, 0x3f803f80
    v_mov_b32 v67, 0x3f803f80
    s_mul_i32 s46, s28, 768
    s_add_u32 s46, s46, 144384
    v_lshl_add_u32 v23, v1, 4, s46
    v_cmp_eq_u32 vcc, v118, v2
    v_lshl_add_u32 v120, s29, 3, v23
    v_mov_b32 v122, 146176
    v_cndmask_b32 v22, v122, v120, vcc
    s_lshl_b32 s46, s30, 6
    s_add_u32 s46, s46, 145920
    v_lshl_add_u32 v128, v2, 4, s46
    v_xor_b32 v129, 64, v128
    v_cmp_eq_u32 s[54:55], 1, v121
    v_cmp_eq_u32 s[56:57], 2, v121
    v_cmp_eq_u32 s[58:59], 3, v121
    s_mov_b32 s53, 1.0
    s_cmp_ge_u32 s25, 9
    s_cbranch_scc1 KA_akv
    v_add_u32 v119, s24, v119
    v_lshrrev_b32 v120, 3, v119
    v_mul_u32_u24 v9, 9216, v120
    v_and_b32 v120, 7, v1
    v_lshl_add_u32 v9, v120, 3, v9
    v_lshl_add_u32 v9, v2, 6, v9
    s_lshl2_add_u32 s46, s25, s30
    s_lshl_b32 s32, s46, 8
    s_xor_b32 s33, s32, 256
    s_mov_b32 s22, 2359296
    s_branch KA_ad
KA_akv:
    s_cmp_eq_u32 s28, 0
    s_cselect_b32 s34, 0, 6
    s_cselect_b32 s35, 16, 2
    v_lshlrev_b32 v121, 2, v2
    v_subrev_u32 v121, s34, v121
    s_cmp_eq_u32 s29, 0
    s_cselect_b32 s53, 0x3eae1a93, s53
    s_cmp_ge_u32 s30, 2
    s_cbranch_scc1 KA_av
    s_mov_b32 s46, 2
    s_mov_b32 s47, 2
    s_mov_b32 s52, 64
    v_lshlrev_b32 v120, 2, v1
    v_add_u32 v120, 150460, v120
    s_cmp_eq_u32 s30, 1
    s_cbranch_scc1 KA_ae
    s_mov_b32 s47, 6
    s_movk_i32 s52, 512
    v_lshrrev_b32 v120, 1, v2
    v_lshlrev_b32 v120, 8, v120
    v_lshl_add_u32 v120, v1, 4, v120
    v_and_b32 v123, 1, v2
    v_lshl_add_u32 v120, v123, 2, v120
    v_add_u32 v120, 147200, v120
    s_branch KA_ae
KA_av:
    s_mov_b32 s46, 16
    s_mov_b32 s47, 16
    s_movk_i32 s52, 576
    s_mul_i32 s48, s28, 160
    s_add_u32 s48, s48, 148736
    v_lshrrev_b32 v120, 3, v1
    v_mul_u32_u24 v120, 288, v120
    v_and_b32 v123, 7, v1
    v_lshl_add_u32 v120, v123, 1, v120
    v_lshl_add_u32 v120, v2, 6, v120
    v_add_u32 v120, s48, v120
KA_ae:
    v_cmp_gt_u32 vcc, s35, v121
    v_add_u32 v121, 1, v121
    v_add_u32 v123, s52, v120
    v_add_u32 v124, s52, v123
    v_cndmask_b32 v10, v122, v120, vcc
    v_cndmask_b32 v14, v122, v123, vcc
    v_cndmask_b32 v18, v122, v124, vcc
    v_add_u32 v120, s46, v120
    v_cmp_gt_u32 vcc, s35, v121
    v_add_u32 v121, 1, v121
    v_add_u32 v123, s52, v120
    v_add_u32 v124, s52, v123
    v_cndmask_b32 v11, v122, v120, vcc
    v_cndmask_b32 v15, v122, v123, vcc
    v_cndmask_b32 v19, v122, v124, vcc
    v_add_u32 v120, s47, v120
    v_cmp_gt_u32 vcc, s35, v121
    v_add_u32 v121, 1, v121
    v_add_u32 v123, s52, v120
    v_add_u32 v124, s52, v123
    v_cndmask_b32 v12, v122, v120, vcc
    v_cndmask_b32 v16, v122, v123, vcc
    v_cndmask_b32 v20, v122, v124, vcc
    v_add_u32 v120, s46, v120
    v_cmp_gt_u32 vcc, s35, v121
    v_add_u32 v121, 1, v121
    v_add_u32 v123, s52, v120
    v_add_u32 v124, s52, v123
    v_cndmask_b32 v13, v122, v120, vcc
    v_cndmask_b32 v17, v122, v123, vcc
    v_cndmask_b32 v21, v122, v124, vcc
    v_add_u32 v120, s46, v120
    s_mul_i32 s46, s26, 54
    v_add_u32 v118, s46, v0
    v_lshlrev_b32 v119, 4, v118
    v_add_u32 v111, 147200, v119
    v_lshrrev_b32 v120, 5, v118
    v_and_b32 v121, 15, v118
    v_lshl_add_u32 v120, v120, 4, v121
    v_add_u32 v120, s24, v120
    v_lshrrev_b32 v121, 5, v120
    v_lshlrev_b32 v121, 10, v121
    v_and_b32 v123, 31, v120
    v_lshl_add_u32 v121, v123, 4, v121
    v_bfe_u32 v123, v118, 4, 1
    v_lshl_add_u32 v121, v123, 9, v121
    v_cmp_gt_u32 vcc, 0x10000, v121
    v_mov_b32 v124, 1073741824
    v_add_u32 v121, 2359296, v121
    v_cndmask_b32 v9, v124, v121, vcc
    s_mul_i32 s46, s24, 36
    s_sub_u32 s46, s46, 1536
    v_add_u32 v121, s46, v119
    v_cmp_gt_u32 vcc, 73728, v121
    v_add_u32 v121, 2457600, v121
    s_lshl_b32 s46, s24, 2
    v_cndmask_b32 v121, v124, v121, vcc
    v_cmp_lt_u32 vcc, 95, v118
    s_sub_u32 s46, s46, 3264
    v_add_u32 v123, s46, v119
    v_cndmask_b32 v9, v9, v121, vcc
    v_cmp_gt_u32 vcc, 8192, v123
    v_add_u32 v123, 2424832, v123
    s_nop 0
    v_cndmask_b32 v123, v124, v123, vcc
    v_cmp_lt_u32 vcc, 203, v118
    s_nop 1
    v_cndmask_b32 v9, v9, v123, vcc
    v_cmp_lt_u32 vcc, 53, v0
    s_nop 1
    v_cndmask_b32 v9, v9, v124, vcc
KA_ad:
    s_load_dwordx4 s[36:39], s[0:1], 48
    s_load_dwordx2 s[40:41], s[0:1], 64
    s_lshr_b32 s46, s2, 3
    s_lshl2_add_u32 s46, s46, s26
    s_mul_i32 s46, s46, 9
    v_min_u32 v152, 8, v0
    v_add_u32 v152, s46, v152
    v_min_u32 v152, 863, v152
    v_mul_u32_u24 v153, 7282, v152
    v_lshrrev_b32 v153, 16, v153
    v_mul_u32_u24 v154, 9, v153
    v_sub_u32 v152, v152, v154
    v_lshlrev_b32 v152, 7, v152
    v_lshrrev_b32 v154, 5, v153
    v_mul_u32_u24 v155, 160, v154
    v_add_u32 v155, v155, v153
    v_mul_u32_u24 v156, 1152, v155
    v_add_u32 v156, v156, v152
    v_bfe_u32 v157, v153, 4, 1
    v_mad_u32_u24 v155, v157, 48, v155
    v_and_b32 v154, 1, v154
    v_lshlrev_b32 v154, 5, v154
    v_sub_u32 v155, v155, v154
    v_mul_u32_u24 v155, 9216, v155
    v_add_u32 v155, v155, v152
    s_and_b32 s50, s2, 7
    s_mul_i32 s51, s50, 663552
    s_mul_i32 s50, s50, 1152
    s_waitcnt lgkmcnt(0)
    s_cmp_eq_u32 s26, 0
    s_cbranch_scc1 KP_0
    s_cmp_eq_u32 s26, 1
    s_cbranch_scc1 KP_1
    s_cmp_eq_u32 s26, 2
    s_cbranch_scc1 KP_2
    s_branch KP_3
KP_back:
    s_branch KA_body
.p2align 12
KA_body:
    s_branch KO_0
KP_0:
    s_branch KP_back
KO_0:
    s_add_u32 m0, s60, 54272
    s_nop 0
    global_load_lds_dwordx4 v[112:113], off
    v_lshl_add_u64 v[112:113], s[44:45], 0, v[112:113]
    s_add_u32 m0, s60, 41728
    s_nop 0
    buffer_load_dwordx4 v108, s[8:11], 0 offen offset:256 lds
    s_add_u32 m0, s60, 58368
    s_nop 0
    global_load_lds_dwordx4 v[112:113], off
    v_lshl_add_u64 v[112:113], s[44:45], 0, v[112:113]
    s_add_u32 m0, s60, 45824
    s_nop 0
    buffer_load_dwordx4 v109, s[8:11], 0 offen offset:256 lds
    s_add_u32 m0, s60, 49920
    s_nop 0
    buffer_load_dwordx4 v110, s[8:11], 0 offen offset:256 lds
    s_add_u32 m0, s60, 74752
    s_nop 0
    global_load_lds_dwordx4 v[112:113], off
    v_lshl_add_u64 v[112:113], s[44:45], 0, v[112:113]
    s_add_u32 m0, s60, 62080
    s_nop 0
    buffer_load_dwordx4 v108, s[8:11], 0 offen offset:384 lds
    s_add_u32 m0, s60, 78848
    s_nop 0
    global_load_lds_dwordx4 v[112:113], off
    v_lshl_add_u64 v[112:113], s[44:45], 0, v[112:113]
    s_add_u32 m0, s60, 66176
    s_nop 0
    buffer_load_dwordx4 v109, s[8:11], 0 offen offset:384 lds
    s_add_u32 m0, s60, 70272
    s_nop 0
    buffer_load_dwordx4 v110, s[8:11], 0 offen offset:384 lds
    s_waitcnt vmcnt(16)
    s_barrier
    ds_read_b64_tr_b16 v[68:69], v5 offset:13312
    ds_read_b64_tr_b16 v[70:71], v5 offset:14336
    ds_read_b128 v[84:87], v3 offset:1024
    ds_read_b128 v[88:91], v3 offset:3072
    ds_read_b128 v[92:95], v3 offset:5120
    ds_read_b64_tr_b16 v[72:73], v6 offset:13312
    ds_read_b64_tr_b16 v[74:75], v6 offset:14336
    s_waitcnt lgkmcnt(5)
    v_mfma_f32_16x16x32_bf16 v[48:51], v[68:71], v[64:67], 0
    s_add_u32 m0, s60, 95232
    ds_read_b64_tr_b16 v[76:77], v7 offset:13312
    s_waitcnt lgkmcnt(5)
    v_mfma_f32_16x16x32_bf16 v[24:27], v[68:71], v[84:87], 0
    global_load_lds_dwordx4 v[112:113], off
    v_lshl_add_u64 v[112:113], s[44:45], 0, v[112:113]
    s_waitcnt lgkmcnt(4)
    v_mfma_f32_16x16x32_bf16 v[28:31], v[68:71], v[88:91], 0
    ds_read_b64_tr_b16 v[78:79], v7 offset:14336
    s_waitcnt lgkmcnt(4)
    v_mfma_f32_16x16x32_bf16 v[32:35], v[68:71], v[92:95], 0
    ds_read_b128 v[96:99], v4 offset:1024
    s_waitcnt lgkmcnt(3)
    v_mfma_f32_16x16x32_bf16 v[36:39], v[72:75], v[84:87], 0
    s_add_u32 m0, s60, 82432
    ds_read_b128 v[100:103], v4 offset:3072
    v_mfma_f32_16x16x32_bf16 v[40:43], v[72:75], v[88:91], 0
    buffer_load_dwordx4 v108, s[8:11], 0 offen offset:512 lds
    v_mfma_f32_16x16x32_bf16 v[44:47], v[72:75], v[92:95], 0
    ds_read_b128 v[104:107], v4 offset:5120
    v_mfma_f32_16x16x32_bf16 v[52:55], v[84:87], v[84:87], 0
    ds_read_b64_tr_b16 v[80:81], v8 offset:13312
    v_mfma_f32_16x16x32_bf16 v[56:59], v[88:91], v[88:91], 0
    s_add_u32 m0, s60, 99328
    ds_read_b64_tr_b16 v[82:83], v8 offset:14336
    v_mfma_f32_16x16x32_bf16 v[60:63], v[92:95], v[92:95], 0
    global_load_lds_dwordx4 v[112:113], off
    v_lshl_add_u64 v[112:113], s[44:45], 0, v[112:113]
    v_mfma_f32_16x16x32_bf16 v[132:135], v[64:67], v[84:87], 0
    s_add_u32 m0, s60, 86528
    v_mfma_f32_16x16x32_bf16 v[136:139], v[64:67], v[88:91], 0
    buffer_load_dwordx4 v109, s[8:11], 0 offen offset:512 lds
    v_mfma_f32_16x16x32_bf16 v[140:143], v[64:67], v[92:95], 0
    s_waitcnt vmcnt(15)
    s_barrier
    ds_read_b64_tr_b16 v[68:69], v5 offset:33792
    s_waitcnt lgkmcnt(6)
    v_mfma_f32_16x16x32_bf16 v[48:51], v[76:79], v[64:67], v[48:51]
    ds_read_b64_tr_b16 v[70:71], v5 offset:34816
    s_waitcnt lgkmcnt(6)
    v_mfma_f32_16x16x32_bf16 v[24:27], v[76:79], v[96:99], v[24:27]
    ds_read_b128 v[84:87], v3 offset:21504
    s_waitcnt lgkmcnt(6)
    v_mfma_f32_16x16x32_bf16 v[28:31], v[76:79], v[100:103], v[28:31]
    s_add_u32 m0, s60, 90624
    ds_read_b128 v[88:91], v3 offset:23552
    s_waitcnt lgkmcnt(6)
    v_mfma_f32_16x16x32_bf16 v[32:35], v[76:79], v[104:107], v[32:35]
    buffer_load_dwordx4 v110, s[8:11], 0 offen offset:512 lds
    s_waitcnt lgkmcnt(4)
    v_mfma_f32_16x16x32_bf16 v[36:39], v[80:83], v[96:99], v[36:39]
    ds_read_b128 v[92:95], v3 offset:25600
    v_mfma_f32_16x16x32_bf16 v[40:43], v[80:83], v[100:103], v[40:43]
    ds_read_b64_tr_b16 v[72:73], v6 offset:33792
    v_mfma_f32_16x16x32_bf16 v[44:47], v[80:83], v[104:107], v[44:47]
    ds_read_b64_tr_b16 v[74:75], v6 offset:34816
    s_waitcnt lgkmcnt(5)
    v_mfma_f32_16x16x32_bf16 v[48:51], v[68:71], v[64:67], v[48:51]
    s_add_u32 m0, s60, 115712
    ds_read_b64_tr_b16 v[76:77], v7 offset:33792
    s_waitcnt lgkmcnt(5)
    v_mfma_f32_16x16x32_bf16 v[24:27], v[68:71], v[84:87], v[24:27]
    global_load_lds_dwordx4 v[112:113], off
    v_lshl_add_u64 v[112:113], s[44:45], 0, v[112:113]
    s_waitcnt lgkmcnt(4)
    v_mfma_f32_16x16x32_bf16 v[28:31], v[68:71], v[88:91], v[28:31]
    ds_read_b64_tr_b16 v[78:79], v7 offset:34816
    s_waitcnt lgkmcnt(4)
    v_mfma_f32_16x16x32_bf16 v[32:35], v[68:71], v[92:95], v[32:35]
    ds_read_b128 v[96:99], v4 offset:21504
    s_waitcnt lgkmcnt(3)
    v_mfma_f32_16x16x32_bf16 v[36:39], v[72:75], v[84:87], v[36:39]
    s_add_u32 m0, s60, 102784
    ds_read_b128 v[100:103], v4 offset:23552
    v_mfma_f32_16x16x32_bf16 v[40:43], v[72:75], v[88:91], v[40:43]
    buffer_load_dwordx4 v108, s[8:11], 0 offen offset:640 lds
    v_mfma_f32_16x16x32_bf16 v[44:47], v[72:75], v[92:95], v[44:47]
    ds_read_b128 v[104:107], v4 offset:25600
    v_mfma_f32_16x16x32_bf16 v[52:55], v[84:87], v[84:87], v[52:55]
    ds_read_b64_tr_b16 v[80:81], v8 offset:33792
    v_mfma_f32_16x16x32_bf16 v[56:59], v[88:91], v[88:91], v[56:59]
    s_add_u32 m0, s60, 119808
    ds_read_b64_tr_b16 v[82:83], v8 offset:34816
    v_mfma_f32_16x16x32_bf16 v[60:63], v[92:95], v[92:95], v[60:63]
    global_load_lds_dwordx4 v[112:113], off
    v_lshl_add_u64 v[112:113], s[44:45], 0, v[112:113]
    v_mfma_f32_16x16x32_bf16 v[132:135], v[64:67], v[84:87], v[132:135]
    s_add_u32 m0, s60, 106880
    v_mfma_f32_16x16x32_bf16 v[136:139], v[64:67], v[88:91], v[136:139]
    buffer_load_dwordx4 v109, s[8:11], 0 offen offset:640 lds
    v_mfma_f32_16x16x32_bf16 v[140:143], v[64:67], v[92:95], v[140:143]
    s_waitcnt vmcnt(14)
    s_barrier
    ds_read_b64_tr_b16 v[68:69], v5 offset:54272
    s_waitcnt lgkmcnt(6)
    v_mfma_f32_16x16x32_bf16 v[48:51], v[76:79], v[64:67], v[48:51]
    ds_read_b64_tr_b16 v[70:71], v5 offset:55296
    s_waitcnt lgkmcnt(6)
    v_mfma_f32_16x16x32_bf16 v[24:27], v[76:79], v[96:99], v[24:27]
    ds_read_b128 v[84:87], v3 offset:41984
    s_waitcnt lgkmcnt(6)
    v_mfma_f32_16x16x32_bf16 v[28:31], v[76:79], v[100:103], v[28:31]
    s_add_u32 m0, s60, 110976
    ds_read_b128 v[88:91], v3 offset:44032
    s_waitcnt lgkmcnt(6)
    v_mfma_f32_16x16x32_bf16 v[32:35], v[76:79], v[104:107], v[32:35]
    buffer_load_dwordx4 v110, s[8:11], 0 offen offset:640 lds
    s_waitcnt lgkmcnt(4)
    v_mfma_f32_16x16x32_bf16 v[36:39], v[80:83], v[96:99], v[36:39]
    ds_read_b128 v[92:95], v3 offset:46080
    v_mfma_f32_16x16x32_bf16 v[40:43], v[80:83], v[100:103], v[40:43]
    ds_read_b64_tr_b16 v[72:73], v6 offset:54272
    v_mfma_f32_16x16x32_bf16 v[44:47], v[80:83], v[104:107], v[44:47]
    ds_read_b64_tr_b16 v[74:75], v6 offset:55296
    s_waitcnt lgkmcnt(5)
    v_mfma_f32_16x16x32_bf16 v[48:51], v[68:71], v[64:67], v[48:51]
    s_add_u32 m0, s60, 136192
    ds_read_b64_tr_b16 v[76:77], v7 offset:54272
    s_waitcnt lgkmcnt(5)
    v_mfma_f32_16x16x32_bf16 v[24:27], v[68:71], v[84:87], v[24:27]
    global_load_lds_dwordx4 v[112:113], off
    v_lshl_add_u64 v[112:113], s[44:45], 0, v[112:113]
    s_waitcnt lgkmcnt(4)
    v_mfma_f32_16x16x32_bf16 v[28:31], v[68:71], v[88:91], v[28:31]
    ds_read_b64_tr_b16 v[78:79], v7 offset:55296
    s_waitcnt lgkmcnt(4)
    v_mfma_f32_16x16x32_bf16 v[32:35], v[68:71], v[92:95], v[32:35]
    ds_read_b128 v[96:99], v4 offset:41984
    s_waitcnt lgkmcnt(3)
    v_mfma_f32_16x16x32_bf16 v[36:39], v[72:75], v[84:87], v[36:39]
    s_add_u32 m0, s60, 123136
    ds_read_b128 v[100:103], v4 offset:44032
    v_mfma_f32_16x16x32_bf16 v[40:43], v[72:75], v[88:91], v[40:43]
    buffer_load_dwordx4 v108, s[8:11], 0 offen offset:768 lds
    v_mfma_f32_16x16x32_bf16 v[44:47], v[72:75], v[92:95], v[44:47]
    ds_read_b128 v[104:107], v4 offset:46080
    v_mfma_f32_16x16x32_bf16 v[52:55], v[84:87], v[84:87], v[52:55]
    ds_read_b64_tr_b16 v[80:81], v8 offset:54272
    v_mfma_f32_16x16x32_bf16 v[56:59], v[88:91], v[88:91], v[56:59]
    s_add_u32 m0, s60, 140288
    ds_read_b64_tr_b16 v[82:83], v8 offset:55296
    v_mfma_f32_16x16x32_bf16 v[60:63], v[92:95], v[92:95], v[60:63]
    global_load_lds_dwordx4 v[112:113], off
    v_lshl_add_u64 v[112:113], s[44:45], 0, v[112:113]
    v_mfma_f32_16x16x32_bf16 v[132:135], v[64:67], v[84:87], v[132:135]
    s_add_u32 m0, s60, 127232
    v_mfma_f32_16x16x32_bf16 v[136:139], v[64:67], v[88:91], v[136:139]
    buffer_load_dwordx4 v109, s[8:11], 0 offen offset:768 lds
    v_mfma_f32_16x16x32_bf16 v[140:143], v[64:67], v[92:95], v[140:143]
    s_waitcnt vmcnt(14)
    s_barrier
    v_add_u32 v3, 61440, v3
    v_add_u32 v4, 61440, v4
    v_add_u32 v5, 61440, v5
    v_add_u32 v6, 61440, v6
    v_add_u32 v7, 61440, v7
    v_add_u32 v8, 61440, v8
    ds_read_b64_tr_b16 v[68:69], v5 offset:13312
    s_waitcnt lgkmcnt(6)
    v_mfma_f32_16x16x32_bf16 v[48:51], v[76:79], v[64:67], v[48:51]
    ds_read_b64_tr_b16 v[70:71], v5 offset:14336
    s_waitcnt lgkmcnt(6)
    v_mfma_f32_16x16x32_bf16 v[24:27], v[76:79], v[96:99], v[24:27]
    ds_read_b128 v[84:87], v3 offset:1024
    s_waitcnt lgkmcnt(6)
    v_mfma_f32_16x16x32_bf16 v[28:31], v[76:79], v[100:103], v[28:31]
    s_add_u32 m0, s60, 131328
    ds_read_b128 v[88:91], v3 offset:3072
    s_waitcnt lgkmcnt(6)
    v_mfma_f32_16x16x32_bf16 v[32:35], v[76:79], v[104:107], v[32:35]
    buffer_load_dwordx4 v110, s[8:11], 0 offen offset:768 lds
    s_waitcnt lgkmcnt(4)
    v_mfma_f32_16x16x32_bf16 v[36:39], v[80:83], v[96:99], v[36:39]
    ds_read_b128 v[92:95], v3 offset:5120
    v_mfma_f32_16x16x32_bf16 v[40:43], v[80:83], v[100:103], v[40:43]
    ds_read_b64_tr_b16 v[72:73], v6 offset:13312
    v_mfma_f32_16x16x32_bf16 v[44:47], v[80:83], v[104:107], v[44:47]
    ds_read_b64_tr_b16 v[74:75], v6 offset:14336
    s_waitcnt lgkmcnt(5)
    v_mfma_f32_16x16x32_bf16 v[48:51], v[68:71], v[64:67], v[48:51]
    s_add_u32 m0, s60, 13312
    ds_read_b64_tr_b16 v[76:77], v7 offset:13312
    s_waitcnt lgkmcnt(5)
    v_mfma_f32_16x16x32_bf16 v[24:27], v[68:71], v[84:87], v[24:27]
    global_load_lds_dwordx4 v[112:113], off
    v_lshl_add_u64 v[112:113], s[44:45], 0, v[112:113]
    s_waitcnt lgkmcnt(4)
    v_mfma_f32_16x16x32_bf16 v[28:31], v[68:71], v[88:91], v[28:31]
    ds_read_b64_tr_b16 v[78:79], v7 offset:14336
    s_waitcnt lgkmcnt(4)
    v_mfma_f32_16x16x32_bf16 v[32:35], v[68:71], v[92:95], v[32:35]
    ds_read_b128 v[96:99], v4 offset:1024
    s_waitcnt lgkmcnt(3)
    v_mfma_f32_16x16x32_bf16 v[36:39], v[72:75], v[84:87], v[36:39]
    s_add_u32 m0, s60, 128
    ds_read_b128 v[100:103], v4 offset:3072
    v_mfma_f32_16x16x32_bf16 v[40:43], v[72:75], v[88:91], v[40:43]
    buffer_load_dwordx4 v108, s[8:11], 0 offen offset:896 lds
    v_mfma_f32_16x16x32_bf16 v[44:47], v[72:75], v[92:95], v[44:47]
    ds_read_b128 v[104:107], v4 offset:5120
    v_mfma_f32_16x16x32_bf16 v[52:55], v[84:87], v[84:87], v[52:55]
    ds_read_b64_tr_b16 v[80:81], v8 offset:13312
    v_mfma_f32_16x16x32_bf16 v[56:59], v[88:91], v[88:91], v[56:59]
    s_add_u32 m0, s60, 17408
    ds_read_b64_tr_b16 v[82:83], v8 offset:14336
    v_mfma_f32_16x16x32_bf16 v[60:63], v[92:95], v[92:95], v[60:63]
    global_load_lds_dwordx4 v[112:113], off
    v_lshl_add_u64 v[112:113], s[44:45], 0, v[112:113]
    v_mfma_f32_16x16x32_bf16 v[132:135], v[64:67], v[84:87], v[132:135]
    s_add_u32 m0, s60, 4224
    v_mfma_f32_16x16x32_bf16 v[136:139], v[64:67], v[88:91], v[136:139]
    buffer_load_dwordx4 v109, s[8:11], 0 offen offset:896 lds
    v_mfma_f32_16x16x32_bf16 v[140:143], v[64:67], v[92:95], v[140:143]
    s_waitcnt vmcnt(14)
    s_barrier
    ds_read_b64_tr_b16 v[68:69], v5 offset:33792
    s_waitcnt lgkmcnt(6)
    v_mfma_f32_16x16x32_bf16 v[48:51], v[76:79], v[64:67], v[48:51]
    ds_read_b64_tr_b16 v[70:71], v5 offset:34816
    s_waitcnt lgkmcnt(6)
    v_mfma_f32_16x16x32_bf16 v[24:27], v[76:79], v[96:99], v[24:27]
    ds_read_b128 v[84:87], v3 offset:21504
    s_waitcnt lgkmcnt(6)
    v_mfma_f32_16x16x32_bf16 v[28:31], v[76:79], v[100:103], v[28:31]
    s_add_u32 m0, s60, 8320
    ds_read_b128 v[88:91], v3 offset:23552
    s_waitcnt lgkmcnt(6)
    v_mfma_f32_16x16x32_bf16 v[32:35], v[76:79], v[104:107], v[32:35]
    buffer_load_dwordx4 v110, s[8:11], 0 offen offset:896 lds
    s_waitcnt lgkmcnt(4)
    v_mfma_f32_16x16x32_bf16 v[36:39], v[80:83], v[96:99], v[36:39]
    ds_read_b128 v[92:95], v3 offset:25600
    v_mfma_f32_16x16x32_bf16 v[40:43], v[80:83], v[100:103], v[40:43]
    ds_read_b64_tr_b16 v[72:73], v6 offset:33792
    v_mfma_f32_16x16x32_bf16 v[44:47], v[80:83], v[104:107], v[44:47]
    ds_read_b64_tr_b16 v[74:75], v6 offset:34816
    s_waitcnt lgkmcnt(5)
    v_mfma_f32_16x16x32_bf16 v[48:51], v[68:71], v[64:67], v[48:51]
    s_add_u32 m0, s60, 33792
    ds_read_b64_tr_b16 v[76:77], v7 offset:33792
    s_waitcnt lgkmcnt(5)
    v_mfma_f32_16x16x32_bf16 v[24:27], v[68:71], v[84:87], v[24:27]
    global_load_lds_dwordx4 v[112:113], off
    v_lshl_add_u64 v[112:113], s[44:45], 0, v[112:113]
    s_waitcnt lgkmcnt(4)
    v_mfma_f32_16x16x32_bf16 v[28:31], v[68:71], v[88:91], v[28:31]
    ds_read_b64_tr_b16 v[78:79], v7 offset:34816
    s_waitcnt lgkmcnt(4)
    v_mfma_f32_16x16x32_bf16 v[32:35], v[68:71], v[92:95], v[32:35]
    ds_read_b128 v[96:99], v4 offset:21504
    s_waitcnt lgkmcnt(3)
    v_mfma_f32_16x16x32_bf16 v[36:39], v[72:75], v[84:87], v[36:39]
    s_add_u32 m0, s60, 20480
    ds_read_b128 v[100:103], v4 offset:23552
    v_mfma_f32_16x16x32_bf16 v[40:43], v[72:75], v[88:91], v[40:43]
    buffer_load_dwordx4 v108, s[8:11], 0 offen offset:1024 lds
    v_mfma_f32_16x16x32_bf16 v[44:47], v[72:75], v[92:95], v[44:47]
    ds_read_b128 v[104:107], v4 offset:25600
    v_mfma_f32_16x16x32_bf16 v[52:55], v[84:87], v[84:87], v[52:55]
    ds_read_b64_tr_b16 v[80:81], v8 offset:33792
    v_mfma_f32_16x16x32_bf16 v[56:59], v[88:91], v[88:91], v[56:59]
    s_add_u32 m0, s60, 37888
    ds_read_b64_tr_b16 v[82:83], v8 offset:34816
    v_mfma_f32_16x16x32_bf16 v[60:63], v[92:95], v[92:95], v[60:63]
    global_load_lds_dwordx4 v[112:113], off
    v_mfma_f32_16x16x32_bf16 v[132:135], v[64:67], v[84:87], v[132:135]
    s_add_u32 m0, s60, 24576
    v_mfma_f32_16x16x32_bf16 v[136:139], v[64:67], v[88:91], v[136:139]
    buffer_load_dwordx4 v109, s[8:11], 0 offen offset:1024 lds
    v_mfma_f32_16x16x32_bf16 v[140:143], v[64:67], v[92:95], v[140:143]
    s_waitcnt vmcnt(14)
    s_barrier
    ds_read_b64_tr_b16 v[68:69], v5 offset:54272
    s_waitcnt lgkmcnt(6)
    v_mfma_f32_16x16x32_bf16 v[48:51], v[76:79], v[64:67], v[48:51]
    ds_read_b64_tr_b16 v[70:71], v5 offset:55296
    s_waitcnt lgkmcnt(6)
    v_mfma_f32_16x16x32_bf16 v[24:27], v[76:79], v[96:99], v[24:27]
    ds_read_b128 v[84:87], v3 offset:41984
    s_waitcnt lgkmcnt(6)
    v_mfma_f32_16x16x32_bf16 v[28:31], v[76:79], v[100:103], v[28:31]
    s_add_u32 m0, s60, 28672
    ds_read_b128 v[88:91], v3 offset:44032
    s_waitcnt lgkmcnt(6)
    v_mfma_f32_16x16x32_bf16 v[32:35], v[76:79], v[104:107], v[32:35]
    buffer_load_dwordx4 v110, s[8:11], 0 offen offset:1024 lds
    s_waitcnt lgkmcnt(4)
    v_mfma_f32_16x16x32_bf16 v[36:39], v[80:83], v[96:99], v[36:39]
    ds_read_b128 v[92:95], v3 offset:46080
    v_mfma_f32_16x16x32_bf16 v[40:43], v[80:83], v[100:103], v[40:43]
    ds_read_b64_tr_b16 v[72:73], v6 offset:54272
    v_mfma_f32_16x16x32_bf16 v[44:47], v[80:83], v[104:107], v[44:47]
    ds_read_b64_tr_b16 v[74:75], v6 offset:55296
    s_waitcnt lgkmcnt(5)
    v_mfma_f32_16x16x32_bf16 v[48:51], v[68:71], v[64:67], v[48:51]
    ds_read_b64_tr_b16 v[76:77], v7 offset:54272
    s_waitcnt lgkmcnt(5)
    v_mfma_f32_16x16x32_bf16 v[24:27], v[68:71], v[84:87], v[24:27]
    buffer_load_dwordx2 v[150:151], off, s[16:19], 0 sc1
    s_waitcnt lgkmcnt(4)
    v_mfma_f32_16x16x32_bf16 v[28:31], v[68:71], v[88:91], v[28:31]
    ds_read_b64_tr_b16 v[78:79], v7 offset:55296
    s_waitcnt lgkmcnt(4)
    v_mfma_f32_16x16x32_bf16 v[32:35], v[68:71], v[92:95], v[32:35]
    ds_read_b128 v[96:99], v4 offset:41984
    s_waitcnt lgkmcnt(3)
    v_mfma_f32_16x16x32_bf16 v[36:39], v[72:75], v[84:87], v[36:39]
    s_mov_b64 s[12:13], s[36:37]
    ds_read_b128 v[100:103], v4 offset:44032
    v_mfma_f32_16x16x32_bf16 v[40:43], v[72:75], v[88:91], v[40:43]
    s_mov_b32 s14, 5308416
    buffer_load_dword v149, v155, s[12:15], s50 offen
    v_mfma_f32_16x16x32_bf16 v[44:47], v[72:75], v[92:95], v[44:47]
    ds_read_b128 v[104:107], v4 offset:46080
    v_mfma_f32_16x16x32_bf16 v[52:55], v[84:87], v[84:87], v[52:55]
    ds_read_b64_tr_b16 v[80:81], v8 offset:54272
    v_mfma_f32_16x16x32_bf16 v[56:59], v[88:91], v[88:91], v[56:59]
    s_mov_b64 s[12:13], s[38:39]
    ds_read_b64_tr_b16 v[82:83], v8 offset:55296
    v_mfma_f32_16x16x32_bf16 v[60:63], v[92:95], v[92:95], v[60:63]
    buffer_load_dword v149, v155, s[12:15], s50 offen
    v_mfma_f32_16x16x32_bf16 v[132:135], v[64:67], v[84:87], v[132:135]
    s_mov_b64 s[12:13], s[40:41]
    v_mfma_f32_16x16x32_bf16 v[136:139], v[64:67], v[88:91], v[136:139]
    buffer_load_dword v149, v156, s[12:15], s51 offen
    v_mfma_f32_16x16x32_bf16 v[140:143], v[64:67], v[92:95], v[140:143]
    s_waitcnt vmcnt(14)
    s_barrier
    v_add_u32 v3, 61440, v3
    v_add_u32 v4, 61440, v4
    v_add_u32 v5, 61440, v5
    v_add_u32 v6, 61440, v6
    v_add_u32 v7, 61440, v7
    v_add_u32 v8, 61440, v8
    ds_read_b64_tr_b16 v[68:69], v5 offset:13312
    s_waitcnt lgkmcnt(6)
    v_mfma_f32_16x16x32_bf16 v[48:51], v[76:79], v[64:67], v[48:51]
    ds_read_b64_tr_b16 v[70:71], v5 offset:14336
    s_waitcnt lgkmcnt(6)
    v_mfma_f32_16x16x32_bf16 v[24:27], v[76:79], v[96:99], v[24:27]
    ds_read_b128 v[84:87], v3 offset:1024
    s_waitcnt lgkmcnt(6)
    v_mfma_f32_16x16x32_bf16 v[28:31], v[76:79], v[100:103], v[28:31]
    ds_read_b128 v[88:91], v3 offset:3072
    s_waitcnt lgkmcnt(6)
    v_mfma_f32_16x16x32_bf16 v[32:35], v[76:79], v[104:107], v[32:35]
    s_waitcnt lgkmcnt(4)
    v_mfma_f32_16x16x32_bf16 v[36:39], v[80:83], v[96:99], v[36:39]
    ds_read_b128 v[92:95], v3 offset:5120
    v_mfma_f32_16x16x32_bf16 v[40:43], v[80:83], v[100:103], v[40:43]
    ds_read_b64_tr_b16 v[72:73], v6 offset:13312
    v_mfma_f32_16x16x32_bf16 v[44:47], v[80:83], v[104:107], v[44:47]
    ds_read_b64_tr_b16 v[74:75], v6 offset:14336
    s_waitcnt lgkmcnt(5)
    v_mfma_f32_16x16x32_bf16 v[48:51], v[68:71], v[64:67], v[48:51]
    ds_read_b64_tr_b16 v[76:77], v7 offset:13312
    s_waitcnt lgkmcnt(5)
    v_mfma_f32_16x16x32_bf16 v[24:27], v[68:71], v[84:87], v[24:27]
    s_waitcnt lgkmcnt(4)
    v_mfma_f32_16x16x32_bf16 v[28:31], v[68:71], v[88:91], v[28:31]
    ds_read_b64_tr_b16 v[78:79], v7 offset:14336
    s_waitcnt lgkmcnt(4)
    v_mfma_f32_16x16x32_bf16 v[32:35], v[68:71], v[92:95], v[32:35]
    ds_read_b128 v[96:99], v4 offset:1024
    s_waitcnt lgkmcnt(3)
    v_mfma_f32_16x16x32_bf16 v[36:39], v[72:75], v[84:87], v[36:39]
    ds_read_b128 v[100:103], v4 offset:3072
    v_mfma_f32_16x16x32_bf16 v[40:43], v[72:75], v[88:91], v[40:43]
    v_mfma_f32_16x16x32_bf16 v[44:47], v[72:75], v[92:95], v[44:47]
    ds_read_b128 v[104:107], v4 offset:5120
    v_mfma_f32_16x16x32_bf16 v[52:55], v[84:87], v[84:87], v[52:55]
    ds_read_b64_tr_b16 v[80:81], v8 offset:13312
    v_mfma_f32_16x16x32_bf16 v[56:59], v[88:91], v[88:91], v[56:59]
    ds_read_b64_tr_b16 v[82:83], v8 offset:14336
    v_mfma_f32_16x16x32_bf16 v[60:63], v[92:95], v[92:95], v[60:63]
    v_mfma_f32_16x16x32_bf16 v[132:135], v[64:67], v[84:87], v[132:135]
    v_mfma_f32_16x16x32_bf16 v[136:139], v[64:67], v[88:91], v[136:139]
    v_mfma_f32_16x16x32_bf16 v[140:143], v[64:67], v[92:95], v[140:143]
    s_waitcnt vmcnt(9)
    s_barrier
    v_add_u32 v3, 4294844416, v3
    v_add_u32 v4, 4294844416, v4
    v_add_u32 v5, 4294844416, v5
    v_add_u32 v6, 4294844416, v6
    v_add_u32 v7, 4294844416, v7
    v_add_u32 v8, 4294844416, v8
    ds_read_b64_tr_b16 v[68:69], v5 offset:13312
    s_waitcnt lgkmcnt(6)
    v_mfma_f32_16x16x32_bf16 v[48:51], v[76:79], v[64:67], v[48:51]
    ds_read_b64_tr_b16 v[70:71], v5 offset:14336
    s_waitcnt lgkmcnt(6)
    v_mfma_f32_16x16x32_bf16 v[24:27], v[76:79], v[96:99], v[24:27]
    ds_read_b128 v[84:87], v3 offset:1024
    s_waitcnt lgkmcnt(6)
    v_mfma_f32_16x16x32_bf16 v[28:31], v[76:79], v[100:103], v[28:31]
    ds_read_b128 v[88:91], v3 offset:3072
    s_waitcnt lgkmcnt(6)
    v_mfma_f32_16x16x32_bf16 v[32:35], v[76:79], v[104:107], v[32:35]
    s_waitcnt lgkmcnt(4)
    v_mfma_f32_16x16x32_bf16 v[36:39], v[80:83], v[96:99], v[36:39]
    ds_read_b128 v[92:95], v3 offset:5120
    v_mfma_f32_16x16x32_bf16 v[40:43], v[80:83], v[100:103], v[40:43]
    ds_read_b64_tr_b16 v[72:73], v6 offset:13312
    v_mfma_f32_16x16x32_bf16 v[44:47], v[80:83], v[104:107], v[44:47]
    ds_read_b64_tr_b16 v[74:75], v6 offset:14336
    s_waitcnt lgkmcnt(5)
    v_mfma_f32_16x16x32_bf16 v[48:51], v[68:71], v[64:67], v[48:51]
    ds_read_b64_tr_b16 v[76:77], v7 offset:13312
    s_waitcnt lgkmcnt(5)
    v_mfma_f32_16x16x32_bf16 v[24:27], v[68:71], v[84:87], v[24:27]
    s_waitcnt lgkmcnt(4)
    v_mfma_f32_16x16x32_bf16 v[28:31], v[68:71], v[88:91], v[28:31]
    ds_read_b64_tr_b16 v[78:79], v7 offset:14336
    s_waitcnt lgkmcnt(4)
    v_mfma_f32_16x16x32_bf16 v[32:35], v[68:71], v[92:95], v[32:35]
    ds_read_b128 v[96:99], v4 offset:1024
    s_waitcnt lgkmcnt(3)
    v_mfma_f32_16x16x32_bf16 v[36:39], v[72:75], v[84:87], v[36:39]
    ds_read_b128 v[100:103], v4 offset:3072
    v_mfma_f32_16x16x32_bf16 v[40:43], v[72:75], v[88:91], v[40:43]
    v_mfma_f32_16x16x32_bf16 v[44:47], v[72:75], v[92:95], v[44:47]
    ds_read_b128 v[104:107], v4 offset:5120
    v_mfma_f32_16x16x32_bf16 v[52:55], v[84:87], v[84:87], v[52:55]
    ds_read_b64_tr_b16 v[80:81], v8 offset:13312
    v_mfma_f32_16x16x32_bf16 v[56:59], v[88:91], v[88:91], v[56:59]
    ds_read_b64_tr_b16 v[82:83], v8 offset:14336
    v_mfma_f32_16x16x32_bf16 v[60:63], v[92:95], v[92:95], v[60:63]
    v_mfma_f32_16x16x32_bf16 v[132:135], v[64:67], v[84:87], v[132:135]
    v_mfma_f32_16x16x32_bf16 v[136:139], v[64:67], v[88:91], v[136:139]
    v_mfma_f32_16x16x32_bf16 v[140:143], v[64:67], v[92:95], v[140:143]
    s_waitcnt vmcnt(4)
    s_barrier
    ds_read_b64_tr_b16 v[68:69], v5 offset:33792
    s_waitcnt lgkmcnt(6)
    v_mfma_f32_16x16x32_bf16 v[48:51], v[76:79], v[64:67], v[48:51]
    ds_read_b64_tr_b16 v[70:71], v5 offset:34816
    s_waitcnt lgkmcnt(6)
    v_mfma_f32_16x16x32_bf16 v[24:27], v[76:79], v[96:99], v[24:27]
    ds_read_b128 v[84:87], v3 offset:21504
    s_waitcnt lgkmcnt(6)
    v_mfma_f32_16x16x32_bf16 v[28:31], v[76:79], v[100:103], v[28:31]
    ds_read_b128 v[88:91], v3 offset:23552
    s_waitcnt lgkmcnt(6)
    v_mfma_f32_16x16x32_bf16 v[32:35], v[76:79], v[104:107], v[32:35]
    s_waitcnt lgkmcnt(4)
    v_mfma_f32_16x16x32_bf16 v[36:39], v[80:83], v[96:99], v[36:39]
    ds_read_b128 v[92:95], v3 offset:25600
    v_mfma_f32_16x16x32_bf16 v[40:43], v[80:83], v[100:103], v[40:43]
    ds_read_b64_tr_b16 v[72:73], v6 offset:33792
    v_mfma_f32_16x16x32_bf16 v[44:47], v[80:83], v[104:107], v[44:47]
    ds_read_b64_tr_b16 v[74:75], v6 offset:34816
    s_waitcnt lgkmcnt(5)
    v_mfma_f32_16x16x32_bf16 v[48:51], v[68:71], v[64:67], v[48:51]
    ds_read_b64_tr_b16 v[76:77], v7 offset:33792
    s_waitcnt lgkmcnt(5)
    v_mfma_f32_16x16x32_bf16 v[24:27], v[68:71], v[84:87], v[24:27]
    s_waitcnt lgkmcnt(4)
    v_mfma_f32_16x16x32_bf16 v[28:31], v[68:71], v[88:91], v[28:31]
    ds_read_b64_tr_b16 v[78:79], v7 offset:34816
    s_waitcnt lgkmcnt(4)
    v_mfma_f32_16x16x32_bf16 v[32:35], v[68:71], v[92:95], v[32:35]
    ds_read_b128 v[96:99], v4 offset:21504
    s_waitcnt lgkmcnt(3)
    v_mfma_f32_16x16x32_bf16 v[36:39], v[72:75], v[84:87], v[36:39]
    ds_read_b128 v[100:103], v4 offset:23552
    v_mfma_f32_16x16x32_bf16 v[40:43], v[72:75], v[88:91], v[40:43]
    v_mfma_f32_16x16x32_bf16 v[44:47], v[72:75], v[92:95], v[44:47]
    ds_read_b128 v[104:107], v4 offset:25600
    v_mfma_f32_16x16x32_bf16 v[52:55], v[84:87], v[84:87], v[52:55]
    ds_read_b64_tr_b16 v[80:81], v8 offset:33792
    v_mfma_f32_16x16x32_bf16 v[56:59], v[88:91], v[88:91], v[56:59]
    ds_read_b64_tr_b16 v[82:83], v8 offset:34816
    v_mfma_f32_16x16x32_bf16 v[60:63], v[92:95], v[92:95], v[60:63]
    v_mfma_f32_16x16x32_bf16 v[132:135], v[64:67], v[84:87], v[132:135]
    v_mfma_f32_16x16x32_bf16 v[136:139], v[64:67], v[88:91], v[136:139]
    v_mfma_f32_16x16x32_bf16 v[140:143], v[64:67], v[92:95], v[140:143]
    s_waitcnt lgkmcnt(5)
    v_mfma_f32_16x16x32_bf16 v[48:51], v[76:79], v[64:67], v[48:51]
    s_waitcnt lgkmcnt(4)
    v_mfma_f32_16x16x32_bf16 v[24:27], v[76:79], v[96:99], v[24:27]
    s_waitcnt lgkmcnt(3)
    v_mfma_f32_16x16x32_bf16 v[28:31], v[76:79], v[100:103], v[28:31]
    s_waitcnt lgkmcnt(2)
    v_mfma_f32_16x16x32_bf16 v[32:35], v[76:79], v[104:107], v[32:35]
    s_waitcnt lgkmcnt(0)
    v_mfma_f32_16x16x32_bf16 v[36:39], v[80:83], v[96:99], v[36:39]
    v_mfma_f32_16x16x32_bf16 v[40:43], v[80:83], v[100:103], v[40:43]
    v_mfma_f32_16x16x32_bf16 v[44:47], v[80:83], v[104:107], v[44:47]
    s_nop 1
    ds_write_b128 v128, v[48:51]
    v_cndmask_b32 v52, v52, v53, s[54:55]
    v_cndmask_b32 v52, v52, v54, s[56:57]
    v_cndmask_b32 v132, v52, v55, s[58:59]
    ds_write_b64 v22, v[132:133] offset:0
    v_cndmask_b32 v56, v56, v57, s[54:55]
    v_cndmask_b32 v56, v56, v58, s[56:57]
    v_cndmask_b32 v136, v56, v59, s[58:59]
    ds_write_b64 v22, v[136:137] offset:256
    v_cndmask_b32 v60, v60, v61, s[54:55]
    v_cndmask_b32 v60, v60, v62, s[56:57]
    v_cndmask_b32 v140, v60, v63, s[58:59]
    ds_write_b64 v22, v[140:141] offset:512
    s_waitcnt lgkmcnt(0)
    s_barrier
    ds_read_b128 v[68:71], v23 offset:0
    ds_read_b128 v[72:75], v23 offset:256
    ds_read_b128 v[76:79], v23 offset:512
    ds_read_b128 v[80:83], v129
    v_mov_b32 v84, 0x3ae38e39
    s_cmp_ge_u32 s25, 9
    s_waitcnt lgkmcnt(1)
    v_pk_add_f32 v[68:69], v[68:69], v[70:71]
    v_pk_add_f32 v[72:73], v[72:73], v[74:75]
    v_pk_add_f32 v[76:77], v[76:77], v[78:79]
    v_mul_f32 v70, 0xbae38e39, v69
    v_mul_f32 v74, 0xbae38e39, v73
    v_mul_f32 v78, 0xbae38e39, v77
    v_mul_f32 v69, v70, v70
    v_mul_f32 v73, v74, v74
    v_mul_f32 v77, v78, v78
    v_fma_f32 v68, v68, v84, -v69
    v_fma_f32 v72, v72, v84, -v73
    v_fma_f32 v76, v76, v84, -v77
    v_max_f32 v68, 0, v68
    v_max_f32 v72, 0, v72
    v_max_f32 v76, 0, v76
    v_add_f32 v68, 0x3727c5ac, v68
    v_add_f32 v72, 0x3727c5ac, v72
    v_add_f32 v76, 0x3727c5ac, v76
    v_rsq_f32 v68, v68
    v_rsq_f32 v72, v72
    v_rsq_f32 v76, v76
    v_pk_fma_f32 v[24:25], v[70:71], v[48:49], v[24:25] op_sel_hi:[0,1,1]
    v_pk_fma_f32 v[26:27], v[70:71], v[50:51], v[26:27] op_sel_hi:[0,1,1]
    v_pk_fma_f32 v[28:29], v[74:75], v[48:49], v[28:29] op_sel_hi:[0,1,1]
    v_pk_fma_f32 v[30:31], v[74:75], v[50:51], v[30:31] op_sel_hi:[0,1,1]
    v_pk_fma_f32 v[32:33], v[78:79], v[48:49], v[32:33] op_sel_hi:[0,1,1]
    v_pk_fma_f32 v[34:35], v[78:79], v[50:51], v[34:35] op_sel_hi:[0,1,1]
    s_cbranch_scc0 KA_eq
    s_branch KO_1
KP_1:
    s_branch KP_back
KO_1:
    v_mul_f32 v68, s53, v68
    v_pk_mul_f32 v[24:25], v[68:69], v[24:25] op_sel_hi:[0,1]
    v_pk_mul_f32 v[26:27], v[68:69], v[26:27] op_sel_hi:[0,1]
    v_cvt_pk_bf16_f32 v88, v24, v25
    v_cvt_pk_bf16_f32 v89, v26, v27
    ds_write_b16 v10, v88
    ds_write_b16_d16_hi v11, v88
    ds_write_b16 v12, v89
    ds_write_b16_d16_hi v13, v89
    v_mul_f32 v72, s53, v72
    v_pk_mul_f32 v[28:29], v[72:73], v[28:29] op_sel_hi:[0,1]
    v_pk_mul_f32 v[30:31], v[72:73], v[30:31] op_sel_hi:[0,1]
    v_cvt_pk_bf16_f32 v90, v28, v29
    v_cvt_pk_bf16_f32 v91, v30, v31
    ds_write_b16 v14, v90
    ds_write_b16_d16_hi v15, v90
    ds_write_b16 v16, v91
    ds_write_b16_d16_hi v17, v91
    v_mul_f32 v76, s53, v76
    v_pk_mul_f32 v[32:33], v[76:77], v[32:33] op_sel_hi:[0,1]
    v_pk_mul_f32 v[34:35], v[76:77], v[34:35] op_sel_hi:[0,1]
    v_cvt_pk_bf16_f32 v92, v32, v33
    v_cvt_pk_bf16_f32 v93, v34, v35
    ds_write_b16 v18, v92
    ds_write_b16_d16_hi v19, v92
    ds_write_b16 v20, v93
    ds_write_b16_d16_hi v21, v93
    s_waitcnt lgkmcnt(0)
    s_barrier
    ds_read_b128 v[68:71], v111
    s_waitcnt lgkmcnt(0)
    buffer_store_dwordx4 v[68:71], v9, s[20:23], 0 offen sc1
    s_branch KA_fin
KA_eq:
    v_pk_mul_f32 v[24:25], v[68:69], v[24:25] op_sel_hi:[0,1]
    v_pk_mul_f32 v[26:27], v[68:69], v[26:27] op_sel_hi:[0,1]
    v_cvt_pk_bf16_f32 v88, v24, v25
    v_cvt_pk_bf16_f32 v89, v26, v27
    buffer_store_dwordx2 v[88:89], v9, s[20:23], s32 offen sc1
    v_add_u32 v9, 18432, v9
    v_pk_mul_f32 v[28:29], v[72:73], v[28:29] op_sel_hi:[0,1]
    v_pk_mul_f32 v[30:31], v[72:73], v[30:31] op_sel_hi:[0,1]
    v_cvt_pk_bf16_f32 v90, v28, v29
    v_cvt_pk_bf16_f32 v91, v30, v31
    buffer_store_dwordx2 v[90:91], v9, s[20:23], s32 offen sc1
    v_add_u32 v9, 18432, v9
    v_pk_mul_f32 v[32:33], v[76:77], v[32:33] op_sel_hi:[0,1]
    v_pk_mul_f32 v[34:35], v[76:77], v[34:35] op_sel_hi:[0,1]
    v_cvt_pk_bf16_f32 v92, v32, v33
    v_cvt_pk_bf16_f32 v93, v34, v35
    buffer_store_dwordx2 v[92:93], v9, s[20:23], s32 offen sc1
    v_add_u32 v9, 4294930432, v9
    s_waitcnt lgkmcnt(0)
    v_pk_fma_f32 v[36:37], v[70:71], v[80:81], v[36:37] op_sel_hi:[0,1,1]
    v_pk_fma_f32 v[38:39], v[70:71], v[82:83], v[38:39] op_sel_hi:[0,1,1]
    v_pk_mul_f32 v[36:37], v[68:69], v[36:37] op_sel_hi:[0,1]
    v_pk_mul_f32 v[38:39], v[68:69], v[38:39] op_sel_hi:[0,1]
    v_cvt_pk_bf16_f32 v94, v36, v37
    v_cvt_pk_bf16_f32 v95, v38, v39
    buffer_store_dwordx2 v[94:95], v9, s[20:23], s33 offen sc1
    v_add_u32 v9, 18432, v9
    v_pk_fma_f32 v[40:41], v[74:75], v[80:81], v[40:41] op_sel_hi:[0,1,1]
    v_pk_fma_f32 v[42:43], v[74:75], v[82:83], v[42:43] op_sel_hi:[0,1,1]
    v_pk_mul_f32 v[40:41], v[72:73], v[40:41] op_sel_hi:[0,1]
    v_pk_mul_f32 v[42:43], v[72:73], v[42:43] op_sel_hi:[0,1]
    v_cvt_pk_bf16_f32 v96, v40, v41
    v_cvt_pk_bf16_f32 v97, v42, v43
    buffer_store_dwordx2 v[96:97], v9, s[20:23], s33 offen sc1
    v_add_u32 v9, 18432, v9
    v_pk_fma_f32 v[44:45], v[78:79], v[80:81], v[44:45] op_sel_hi:[0,1,1]
    v_pk_fma_f32 v[46:47], v[78:79], v[82:83], v[46:47] op_sel_hi:[0,1,1]
    v_pk_mul_f32 v[44:45], v[76:77], v[44:45] op_sel_hi:[0,1]
    v_pk_mul_f32 v[46:47], v[76:77], v[46:47] op_sel_hi:[0,1]
    v_cvt_pk_bf16_f32 v98, v44, v45
    v_cvt_pk_bf16_f32 v99, v46, v47
    buffer_store_dwordx2 v[98:99], v9, s[20:23], s33 offen sc1
    v_add_u32 v9, 4294930432, v9
    s_mov_b32 s22, 268435456
KA_fin:
    s_lshr_b32 s101, s2, 3
    s_and_b32 s97, s2, 0
    s_lshl_b32 s97, s97, 7
    s_add_u32 s97, s97, 41946112
    s_and_b32 s3, s2, 3
    s_bfe_u32 s40, s2, 0x10003
    s_lshl1_add_u32 s3, s3, s40
    s_bfe_u32 s40, s2, 0x10002
    s_lshr_b32 s2, s2, 4
    s_lshl4_add_u32 s2, s40, s2
    s_lshl3_add_u32 s2, s2, s3
    s_lshl_b32 s98, s61, 12
    s_add_u32 s98, s98, 41946112
    s_load_dwordx2 s[8:9], s[0:1], 0
    s_load_dwordx4 s[32:35], s[0:1], 48
    s_load_dwordx2 s[6:7], s[0:1], 64
    s_load_dwordx2 s[4:5], s[0:1], 72
    v_lshlrev_b32 v1, 4, v0
    s_mul_i32 s29, s2, 9216
    s_and_b32 s25, s2, 7
    s_lshr_b32 s24, s2, 3
    s_mov_b32 s54, 0x20000
    s_lshl_b32 s40, s26, 11
    s_add_u32 s42, s40, 2424832
    s_lshl_b32 s40, s26, 14
    s_add_u32 s40, s40, 2359296
    s_mul_i32 s3, s26, 18432
    s_add_u32 s41, s3, 2457600
    v_lshlrev_b32 v144, 2, v0
    v_and_b32 v15, 31, v0
    v_lshrrev_b32 v36, 5, v0
    v_mul_u32_u24 v36, 288, v36
    v_lshl_add_u32 v36, v15, 4, v36
    v_add_u32 v36, s3, v36
    v_min_u32 v37, 19, v15
    v_lshlrev_b32 v37, 4, v37
    v_cmp_gt_u32 vcc, 18, v15
    v_add_u32 v37, 125216, v37
    v_mov_b32 v38, 2304
    v_cndmask_b32 v2, v37, v36, vcc
    v_cndmask_b32 v145, 0, v38, vcc
    v_bfe_u32 v36, v0, 3, 2
    v_mul_u32_u24 v36, 576, v36
    v_and_b32 v37, 7, v0
    v_cmp_gt_u32 vcc, 4, v37
    v_lshl_add_u32 v36, v37, 2, v36
    v_add_u32 v36, 125504, v36
    v_mov_b32 v38, 0x3f803f80
    v_cndmask_b32 v37, 0, v38, vcc
    ds_write_b32 v36, v37
    s_mov_b32 s22, 268435456
    s_mov_b32 s23, 0x20000
    s_mov_b32 s10, 2359296
    s_mov_b32 s11, 0x20000
    s_lshl_b32 s28, s26, 10
    s_add_u32 s99, s28, s29
    v_and_b32 v130, 15, v0
    v_min_u32 v130, 13, v130
    v_add_u32 v130, 242, v130
    v_lshlrev_b32 v130, 12, v130
    v_bfe_u32 v36, v0, 3, 2
    v_mul_u32_u24 v4, 288, v36
    v_and_b32 v36, 1, v36
    v_mul_u32_u24 v36, 28, v36
    v_and_b32 v37, 7, v0
    v_lshl_add_u32 v4, v37, 3, v4
    v_lshrrev_b32 v37, 5, v0
    v_lshl_add_u32 v146, v37, 7, v4
    v_sub_u32 v4, v4, v36
    v_add_u32 v4, 73984, v4
    v_sub_u32 v3, v146, v36
    v_add_u32 v3, 73728, v3
    v_add_u32 v146, v146, v36
    v_add_u32 v146, 73732, v146
    v_add_u32 v12, 104448, v1
    v_and_b32 v36, 7, v0
    v_lshlrev_b32 v36, 4, v36
    v_lshrrev_b32 v37, 3, v0
    v_lshrrev_b32 v38, 4, v0
    v_lshl_add_u32 v38, v38, 8, v36
    v_and_b32 v39, 1, v37
    v_lshl_add_u32 v38, v39, 3, v38
    s_lshl_b32 s43, s26, 9
    s_add_u32 s43, s43, 104448
    v_add_u32 v38, s43, v38
    s_lshl_b32 s43, s26, 2
    s_add_u32 s43, s43, 106496
    v_add_u32 v39, s43, v36
    v_lshlrev_b32 v40, 2, v0
    v_cmp_eq_u32 vcc, 4, v37
    v_add_u32 v40, 106752, v40
    v_lshrrev_b32 v41, 4, v0
    v_cndmask_b32 v8, v40, v39, vcc
    v_mul_u32_u24 v41, 2304, v41
    v_add_u32 v10, v41, v12
    v_cmp_gt_u32 vcc, 4, v37
    v_add_u32 v39, 4, v38
    s_mul_i32 s27, s26, 165888
    v_cndmask_b32 v8, v8, v38, vcc
    v_cndmask_b32 v9, v40, v39, vcc
    s_add_u32 s27, s27, 2621440
    s_mul_i32 s43, s26, 3072
    s_add_u32 s43, s43, 92160
    v_add_u32 v5, s43, v1
    v_lshrrev_b32 v37, 3, v0
    v_min_u32 v37, 4, v37
    v_lshl_add_u32 v37, v37, 9, v36
    s_lshl_b32 s43, s26, 7
    s_add_u32 s43, s43, 92160
    v_add_u32 v6, s43, v37
    v_lshrrev_b32 v7, 2, v36
    v_add_u32 v7, 128, v7
    s_lshl2_add_u32 s43, s26, 106752
    v_mov_b32 v11, s43
    v_and_b32 v251, 3, v0
    v_lshlrev_b32 v251, 2, v251
    v_add_u32 v251, 106752, v251
    v_mov_b32 v13, 0xdddddddd
    v_mov_b32 v14, 0
    v_accvgpr_write_b32 a245, 0
    v_accvgpr_write_b32 a246, 0
    v_accvgpr_write_b32 a248, 0
    v_accvgpr_write_b32 a249, 0
    v_mov_b32 v48, 0
    v_mov_b32 v49, 0
    v_mov_b32 v50, 0
    v_mov_b32 v51, 0
    s_mul_i32 s43, s26, 5120
    v_add_u32 v52, s43, v12
    v_and_b32 v15, 7, v0
    v_mul_u32_u24 v15, 1152, v15
    v_lshrrev_b32 v43, 4, v0
    v_lshl_add_u32 v15, v43, 3, v15
    s_lshl_b32 s43, s26, 5
    s_add_u32 s43, s43, 82944
    v_add_u32 v15, s43, v15
    s_waitcnt vmcnt(0) lgkmcnt(0)
    v_cmp_eq_u64 vcc, 0, v[150:151]
    s_cbranch_vccnz KM_nspin
KM_nok:
    v_readfirstlane_b32 s0, v150
    v_readfirstlane_b32 s1, v151
    s_cmp_lg_u32 s26, 0
    s_barrier
    s_cbranch_scc1 KM_nfa
    v_mov_b32 v20, s0
    v_mov_b32 v21, s1
    s_mov_b64 exec, 0xff
    buffer_store_dwordx4 v[20:23], v1, s[20:23], s98 offen sc1
    s_mov_b64 exec, -1
    s_nop 0
KM_nfa:
    s_add_u32 m0, s28, 82944
    s_add_u32 s43, s99, 0
    buffer_load_dwordx4 v1, s[8:11], s43 offen  lds
    v_and_b32 v44, 15, v0
    s_mul_i32 s43, s26, 43
    s_lshr_b32 s43, s43, 2
    v_add_u32 v45, s43, v44
    v_min_u32 v45, 42, v45
    v_lshrrev_b32 v46, 1, v45
    v_mul_u32_u24 v46, 9, v46
    v_add3_u32 v45, v45, v46, 9
    v_subrev_u32 v46, 12, v44
    v_lshl_add_u32 v46, v46, 2, s26
    v_min_u32 v46, 8, v46
    s_mul_i32 s43, s2, 171
    s_lshr_b32 s43, s43, 11
    s_mul_i32 s43, s43, 11
    v_cmp_gt_u32 vcc, 12, v44
    v_add_u32 v46, s43, v46
    s_nop 0
    v_cndmask_b32 v45, v46, v45, vcc
    v_lshlrev_b32 v22, 12, v45
    s_add_u32 m0, s28, 87040
    s_add_u32 s43, s99, 4096
    buffer_load_dwordx4 v1, s[8:11], s43 offen  lds
    s_mov_b32 m0, 91136
    s_add_u32 s43, s29, 8192
    buffer_load_dwordx4 v1, s[8:11], s43 offen  lds
    s_lshl_b32 s43, s24, 2
    s_add_u32 s43, s43, s26
    s_mul_i32 s44, s43, 171
    s_lshr_b32 s44, s44, 11
    s_mul_i32 s46, s44, 12
    s_sub_u32 s46, s43, s46
    s_mul_i32 s45, s44, 11
    s_lshr_b32 s45, s45, 5
    s_mul_i32 s55, s45, 3
    s_sub_u32 s44, s44, s55
    s_mul_i32 s55, s44, 6
    s_cmp_lt_u32 s43, 108
    s_cselect_b32 s14, 5308416, 0
    s_cselect_b32 s18, 268435456, 0
    s_mov_b32 s15, 0x20000
    s_mov_b32 s19, 0x20000
    s_mov_b32 s60, 64
    s_cmp_eq_u32 s44, 2
    s_cselect_b32 s61, 8, 4
    s_cselect_b32 s62, 4, 64
    s_movk_i32 s63, 9216
    s_mov_b32 s56, 147456
    s_mov_b32 s57, 589824
    s_mov_b32 s58, 147456
    s_mul_i32 s59, s25, 1152
    s_mov_b32 s51, 37888
    s_mov_b32 s47, 3072
    s_mul_i32 s50, s45, 3
    s_lshl1_add_u32 s50, s55, s50
    s_lshl_b32 s50, s50, 10
    s_add_u32 s50, s50, 6291456
    s_cmp_lt_u32 s45, 2
    s_cbranch_scc1 KM_shgu
    s_mov_b32 s60, 16
    s_mov_b32 s61, 4
    s_mov_b32 s62, 16
    s_movk_i32 s63, 1152
    s_mov_b32 s56, 36864
    s_mov_b32 s57, 0
    s_mov_b32 s58, 0
    s_mul_i32 s59, s25, 663552
    s_mov_b32 s51, 19456
    s_mov_b32 s47, 0
    s_lshl_b32 s50, s55, 10
    s_add_u32 s50, s50, 17203200
KM_shgu:
    s_mul_i32 s43, s46, 96
    s_add_u32 s59, s59, s43
    s_mul_i32 s43, s25, 12
    s_add_u32 s43, s43, s46
    s_mul_i32 s43, s43, 3
    s_mul_i32 s43, s43, s51
    s_add_u32 s50, s50, s43
    s_sub_u32 s50, s50, 1024
    s_lshl_b32 s49, s26, 13
    s_add_u32 s49, s49, 131072
    v_lshrrev_b32 v44, 4, v0
    v_bfe_u32 v45, v0, 2, 2
    v_lshl_add_u32 v44, v44, 3, v45
    v_mul_u32_u24 v44, 96, v44
    v_and_b32 v45, 3, v0
    v_lshl_add_u32 v44, v45, 3, v44
    v_add_u32 v19, s49, v44
    s_mul_i32 s48, s55, s56
    s_lshr_b32 s44, s55, 2
    s_mul_i32 s44, s44, s57
    s_add_u32 s48, s48, s44
    s_cmp_eq_u32 s55, 17
    s_cselect_b32 s44, s58, 0
    s_add_u32 s48, s48, s44
    s_add_u32 s48, s48, s59
    s_cmp_eq_u32 s45, 0
    s_cselect_b32 s12, s32, s34
    s_cselect_b32 s13, s33, s35
    s_cmp_ge_u32 s45, 2
    s_cselect_b32 s12, s6, s12
    s_cselect_b32 s13, s7, s13
    s_mov_b32 s16, s20
    s_mov_b32 s17, s21
    ds_write_b128 v52, v[48:51] offset:0
    ds_write_b128 v52, v[48:51] offset:1024
    ds_write_b128 v52, v[48:51] offset:2048
    ds_write_b128 v52, v[48:51] offset:3072
    ds_write_b128 v52, v[48:51] offset:4096
    v_mfma_f32_32x32x8_bf16 a[200:215], a[248:249], a[248:249], 0
    v_add_u32 v44, 0, v0
    v_mul_u32_u24 v45, 171, v44
    v_lshrrev_b32 v45, 10, v45
    v_mul_u32_u24 v46, 6, v45
    v_sub_u32 v44, v44, v46
    v_lshrrev_b32 v46, 3, v45
    v_and_b32 v47, 3, v45
    v_bfe_u32 v45, v45, 2, 1
    v_mad_u32_u24 v53, v46, s61, v47
    v_lshl_add_u32 v46, v46, 2, v47
    v_mad_u32_u24 v53, v45, s62, v53
    v_mad_u32_u24 v46, v45, s60, v46
    v_mul_u32_u24 v53, s63, v53
    v_mul_u32_u24 v46, s63, v46
    v_lshl_add_u32 v248, v44, 4, v53
    v_lshl_add_u32 v16, v44, 4, v46
    v_add_u32 v44, 64, v0
    v_mul_u32_u24 v45, 171, v44
    v_lshrrev_b32 v45, 10, v45
    v_mul_u32_u24 v46, 6, v45
    v_sub_u32 v44, v44, v46
    v_lshrrev_b32 v46, 3, v45
    v_and_b32 v47, 3, v45
    v_bfe_u32 v45, v45, 2, 1
    v_mad_u32_u24 v53, v46, s61, v47
    v_lshl_add_u32 v46, v46, 2, v47
    v_mad_u32_u24 v53, v45, s62, v53
    v_mad_u32_u24 v46, v45, s60, v46
    v_mul_u32_u24 v53, s63, v53
    v_mul_u32_u24 v46, s63, v46
    v_lshl_add_u32 v249, v44, 4, v53
    v_lshl_add_u32 v17, v44, 4, v46
    v_add_u32 v44, 128, v0
    v_mul_u32_u24 v45, 171, v44
    v_lshrrev_b32 v45, 10, v45
    v_mul_u32_u24 v46, 6, v45
    v_sub_u32 v44, v44, v46
    v_lshrrev_b32 v46, 3, v45
    v_and_b32 v47, 3, v45
    v_bfe_u32 v45, v45, 2, 1
    v_mad_u32_u24 v53, v46, s61, v47
    v_lshl_add_u32 v46, v46, 2, v47
    v_mad_u32_u24 v53, v45, s62, v53
    v_mad_u32_u24 v46, v45, s60, v46
    v_mul_u32_u24 v53, s63, v53
    v_mul_u32_u24 v46, s63, v46
    v_lshl_add_u32 v250, v44, 4, v53
    v_lshl_add_u32 v18, v44, 4, v46
    s_mul_i32 s43, s25, 2359296
    s_mul_i32 s44, s24, 73728
    s_add_u32 s43, s43, s44
    s_lshl_b32 s44, s26, 11
    s_add_u32 s43, s43, s44
    s_add_u32 s43, s43, 23068672
    s_add_u32 s44, s25, 5
    s_and_b32 s44, s44, 7
    s_lshl_b32 s44, s44, 13
    s_add_u32 s37, s43, s44
    s_add_u32 s44, s25, 6
    s_and_b32 s44, s44, 7
    s_lshl_b32 s44, s44, 13
    s_add_u32 s38, s43, s44
    s_add_u32 s44, s25, 7
    s_and_b32 s44, s44, 7
    s_lshl_b32 s44, s44, 13
    s_add_u32 s39, s43, s44
    v_mov_b32 v252, -1
    v_mov_b32 v253, -1
    v_mov_b32 v254, -1
    v_mov_b32 v255, -1
    buffer_load_dwordx2 v[20:21], v22, s[20:23], s97 offen sc1
    s_waitcnt vmcnt(1)
    s_barrier
    ds_read_b64 v[92:93], v15 offset:0
    ds_read_b64 v[94:95], v15 offset:128
    ds_read_b64 v[96:97], v15 offset:256
    ds_read_b64 v[98:99], v15 offset:384
    ds_read_b64 v[100:101], v15 offset:512
    ds_read_b64 v[102:103], v15 offset:640
    ds_read_b64 v[104:105], v15 offset:768
    ds_read_b64 v[106:107], v15 offset:896
    ds_read_b64 v[108:109], v15 offset:1024
    s_waitcnt lgkmcnt(0)
    v_lshlrev_b32 v148, 16, v92
    v_and_b32 v149, 0xffff0000, v92
    v_lshlrev_b32 v150, 16, v93
    v_and_b32 v151, 0xffff0000, v93
    v_lshlrev_b32 v152, 16, v94
    v_and_b32 v153, 0xffff0000, v94
    v_lshlrev_b32 v154, 16, v95
    v_and_b32 v155, 0xffff0000, v95
    v_lshlrev_b32 v156, 16, v96
    v_and_b32 v157, 0xffff0000, v96
    v_lshlrev_b32 v158, 16, v97
    v_and_b32 v159, 0xffff0000, v97
    v_lshlrev_b32 v160, 16, v98
    v_and_b32 v161, 0xffff0000, v98
    v_lshlrev_b32 v162, 16, v99
    v_and_b32 v163, 0xffff0000, v99
    v_lshlrev_b32 v164, 16, v100
    v_and_b32 v165, 0xffff0000, v100
    v_lshlrev_b32 v166, 16, v101
    v_and_b32 v167, 0xffff0000, v101
    v_lshlrev_b32 v168, 16, v102
    v_and_b32 v169, 0xffff0000, v102
    v_lshlrev_b32 v170, 16, v103
    v_and_b32 v171, 0xffff0000, v103
    v_lshlrev_b32 v172, 16, v104
    v_and_b32 v173, 0xffff0000, v104
    v_lshlrev_b32 v174, 16, v105
    v_and_b32 v175, 0xffff0000, v105
    v_lshlrev_b32 v176, 16, v106
    v_and_b32 v177, 0xffff0000, v106
    v_lshlrev_b32 v178, 16, v107
    v_and_b32 v179, 0xffff0000, v107
    v_lshlrev_b32 v180, 16, v108
    v_and_b32 v181, 0xffff0000, v108
    v_lshlrev_b32 v182, 16, v109
    v_and_b32 v183, 0xffff0000, v109
    s_waitcnt vmcnt(0)
    v_cmp_ne_u64 vcc, s[0:1], v[20:21]
    s_cbranch_vccz KM_fa_ok
KM_fa:
    buffer_load_dwordx2 v[20:21], v22, s[20:23], s97 offen sc1
    s_waitcnt vmcnt(0)
    v_cmp_ne_u64 vcc, s[0:1], v[20:21]
    s_cbranch_vccz KM_fa_ok
    s_sub_u32 s54, s54, 1
    s_cbranch_scc0 KM_fa
    s_mov_b32 s54, 0
KM_fa_ok:
    s_add_u32 m0, s28, 73728
    s_add_u32 s43, s99, 0
    buffer_load_dwordx4 v1, s[20:23], s43 offen sc1 lds
    buffer_load_dword a192, v144, s[20:23], s42 offen offset:0 sc1
    buffer_load_dword a193, v144, s[20:23], s42 offen offset:256 sc1
    buffer_load_dwordx4 a[0:3], v1, s[20:23], s40 offen offset:0 sc1
    buffer_load_dwordx4 a[4:7], v1, s[20:23], s40 offen offset:1024 sc1
    s_add_u32 m0, s3, 0
    s_nop 0
    buffer_load_dwordx4 v1, s[20:23], s41 offen offset:0 sc1 lds
    buffer_load_dwordx4 v1, s[20:23], s41 offen offset:1024 sc1 lds
    buffer_load_dwordx4 v1, s[20:23], s41 offen offset:2048 sc1 lds
    buffer_load_dwordx4 a[8:11], v1, s[20:23], s40 offen offset:2048 sc1
    buffer_load_dwordx4 a[12:15], v1, s[20:23], s40 offen offset:3072 sc1
    buffer_load_dword a194, v144, s[20:23], s42 offen offset:512 sc1
    buffer_load_dword a195, v144, s[20:23], s42 offen offset:768 sc1
    buffer_load_dwordx4 v1, s[20:23], s41 offen offset:3072 sc1 lds
    s_add_u32 m0, s3, 4096
    s_add_u32 s41, s41, 4096
    buffer_load_dwordx4 v1, s[20:23], s41 offen offset:0 sc1 lds
    s_cmp_eq_u32 s26, 0
    s_cbranch_scc1 KP_4
    s_cmp_eq_u32 s26, 1
    s_cbranch_scc1 KP_5
    s_cmp_eq_u32 s26, 2
    s_cbranch_scc1 KP_6
    s_branch KP_7
KP_back2:
    s_waitcnt vmcnt(9)
    s_barrier
    ds_read_b32 a244, v4 offset:0
    ds_read_b32 a247, v4 offset:0
    ds_read2_b32 a[240:241], v3 offset1:16
    ds_read2_b32 a[242:243], v146 offset1:16
    v_add_u32 v3, 1152, v3
    v_add_u32 v146, 1152, v146
    buffer_load_dword a196, v144, s[20:23], s42 offen offset:1024 sc1
    buffer_load_dword a197, v144, s[20:23], s42 offen offset:1280 sc1
    s_waitcnt lgkmcnt(0)
    v_mfma_f32_32x32x4_2b_bf16 v[184:215], a[192:193], a[244:245], 0
    buffer_load_dword a198, v144, s[20:23], s42 offen offset:1536 sc1
    buffer_load_dword a199, v144, s[20:23], s42 offen offset:1792 sc1
    s_add_u32 s40, s40, 4096
    buffer_load_dwordx4 a[16:19], v1, s[20:23], s40 offen offset:0 sc1
    buffer_load_dwordx4 a[20:23], v1, s[20:23], s40 offen offset:1024 sc1
    buffer_load_dwordx4 v1, s[20:23], s41 offen offset:1024 sc1 lds
    buffer_load_dwordx4 v1, s[20:23], s41 offen offset:2048 sc1 lds
    s_nop 11
    v_mfma_f32_32x32x16_bf16 v[184:199], a[0:3], a[240:243], v[184:199]
    s_waitcnt vmcnt(14)
    ds_read_b128 a[64:67], v2 offset:0
    ds_read_b128 a[68:71], v2 offset:576
    ds_read_b128 a[72:75], v2 offset:1152
    ds_read_b128 a[76:79], v2 offset:1728
    v_add_u32 v2, v2, v145
    v_mfma_f32_32x32x16_bf16 v[200:215], a[4:7], a[240:243], v[200:215]
    s_nop 5
KM_it0:
    v_exp_f32 v184, v184
    v_exp_f32 v185, v185
    s_waitcnt lgkmcnt(0)
    buffer_load_dwordx4 a[24:27], v1, s[20:23], s40 offen offset:2048 sc1
    v_exp_f32 v186, v186
    v_exp_f32 v187, v187
    v_exp_f32 v188, v188
    v_mfma_f32_32x32x4_2b_bf16 v[216:247], a[192:193], a[246:247], 0
    buffer_load_dwordx4 a[28:31], v1, s[20:23], s40 offen offset:3072 sc1
    v_exp_f32 v189, v189
    v_exp_f32 v190, v190
    v_exp_f32 v191, v191
    v_exp_f32 v192, v192
    v_exp_f32 v193, v193
    v_exp_f32 v194, v194
    v_exp_f32 v195, v195
    v_exp_f32 v196, v196
    v_smfmac_f32_32x32x32_bf16 a[200:215], a[64:67], v[184:191], v13
    buffer_load_dwordx4 v1, s[20:23], s41 offen offset:3072 sc1 lds
    v_exp_f32 v197, v197
    v_exp_f32 v198, v198
    v_exp_f32 v199, v199
    v_exp_f32 v200, v200
    v_exp_f32 v201, v201
    v_smfmac_f32_32x32x32_bf16 a[200:215], a[68:71], v[192:199], v13
    s_waitcnt vmcnt(11)
    ds_read_b128 a[80:83], v2 offset:0
    ds_read_b128 a[84:87], v2 offset:576
    v_exp_f32 v202, v202
    v_exp_f32 v203, v203
    v_exp_f32 v204, v204
    v_mfma_f32_32x32x16_bf16 v[216:231], a[8:11], a[240:243], v[216:231]
    s_add_u32 m0, s3, 8192
    s_add_u32 s41, s41, 4096
    buffer_load_dwordx4 v1, s[20:23], s41 offen offset:0 sc1 lds
    v_exp_f32 v205, v205
    v_exp_f32 v206, v206
    v_exp_f32 v207, v207
    v_mfma_f32_32x32x16_bf16 v[232:247], a[12:15], a[240:243], v[232:247]
    ds_read_b128 a[88:91], v2 offset:1152
    ds_read_b128 a[92:95], v2 offset:1728
    v_add_u32 v2, v2, v145
    v_exp_f32 v208, v208
    v_exp_f32 v209, v209
    v_exp_f32 v210, v210
    v_smfmac_f32_32x32x32_bf16 a[200:215], a[72:75], v[200:207], v13
    buffer_load_dwordx2 v[128:129], v130, s[20:23], s97 offen sc1
    v_exp_f32 v211, v211
    v_exp_f32 v212, v212
    v_exp_f32 v213, v213
    v_exp_f32 v214, v214
    v_exp_f32 v215, v215
    v_exp_f32 v216, v216
    v_exp_f32 v217, v217
    v_smfmac_f32_32x32x32_bf16 a[200:215], a[76:79], v[208:215], v13
    s_waitcnt lgkmcnt(0)
    s_add_u32 s40, s40, 4096
    buffer_load_dwordx4 a[32:35], v1, s[20:23], s40 offen offset:0 sc1
    v_exp_f32 v218, v218
    v_exp_f32 v219, v219
    v_exp_f32 v220, v220
    v_mfma_f32_32x32x4_2b_bf16 v[184:215], a[194:195], a[244:245], 0
    buffer_load_dwordx4 a[36:39], v1, s[20:23], s40 offen offset:1024 sc1
    v_exp_f32 v221, v221
    v_exp_f32 v222, v222
    v_exp_f32 v223, v223
    v_exp_f32 v224, v224
    v_exp_f32 v225, v225
    v_exp_f32 v226, v226
    v_exp_f32 v227, v227
    v_exp_f32 v228, v228
    v_smfmac_f32_32x32x32_bf16 a[200:215], a[80:83], v[216:223], v13
    buffer_load_dwordx4 v1, s[20:23], s41 offen offset:1024 sc1 lds
    v_exp_f32 v229, v229
    v_exp_f32 v230, v230
    v_exp_f32 v231, v231
    v_exp_f32 v232, v232
    v_exp_f32 v233, v233
    v_smfmac_f32_32x32x32_bf16 a[200:215], a[84:87], v[224:231], v13
    s_waitcnt vmcnt(8)
    ds_read_b128 a[96:99], v2 offset:0
    ds_read_b128 a[100:103], v2 offset:576
    v_exp_f32 v234, v234
    v_exp_f32 v235, v235
    v_exp_f32 v236, v236
    v_mfma_f32_32x32x16_bf16 v[184:199], a[16:19], a[240:243], v[184:199]
    buffer_load_dwordx4 v1, s[20:23], s41 offen offset:2048 sc1 lds
    v_exp_f32 v237, v237
    v_exp_f32 v238, v238
    v_exp_f32 v239, v239
    v_mfma_f32_32x32x16_bf16 v[200:215], a[20:23], a[240:243], v[200:215]
    ds_read_b128 a[104:107], v2 offset:1152
    ds_read_b128 a[108:111], v2 offset:1728
    v_add_u32 v2, v2, v145
    v_exp_f32 v240, v240
    v_exp_f32 v241, v241
    v_exp_f32 v242, v242
    v_smfmac_f32_32x32x32_bf16 a[200:215], a[88:91], v[232:239], v13
    buffer_load_dwordx4 v1, s[20:23], s41 offen offset:3072 sc1 lds
    v_exp_f32 v243, v243
    v_exp_f32 v244, v244
    v_exp_f32 v245, v245
    v_exp_f32 v246, v246
    v_exp_f32 v247, v247
    v_exp_f32 v184, v184
    v_exp_f32 v185, v185
    v_smfmac_f32_32x32x32_bf16 a[200:215], a[92:95], v[240:247], v13
    s_waitcnt lgkmcnt(0)
    buffer_load_dwordx4 a[40:43], v1, s[20:23], s40 offen offset:2048 sc1
    v_exp_f32 v186, v186
    v_exp_f32 v187, v187
    v_exp_f32 v188, v188
    v_mfma_f32_32x32x4_2b_bf16 v[216:247], a[194:195], a[246:247], 0
    buffer_load_dwordx4 a[44:47], v1, s[20:23], s40 offen offset:3072 sc1
    v_exp_f32 v189, v189
    v_exp_f32 v190, v190
    v_exp_f32 v191, v191
    v_exp_f32 v192, v192
    v_exp_f32 v193, v193
    v_exp_f32 v194, v194
    v_exp_f32 v195, v195
    v_exp_f32 v196, v196
    v_smfmac_f32_32x32x32_bf16 a[200:215], a[96:99], v[184:191], v13
    s_add_u32 m0, s3, 12288
    s_add_u32 s41, s41, 4096
    buffer_load_dwordx4 v1, s[20:23], s41 offen offset:0 sc1 lds
    v_exp_f32 v197, v197
    v_exp_f32 v198, v198
    v_exp_f32 v199, v199
    v_exp_f32 v200, v200
    v_exp_f32 v201, v201
    v_smfmac_f32_32x32x32_bf16 a[200:215], a[100:103], v[192:199], v13
    s_waitcnt vmcnt(9)
    ds_read_b128 a[112:115], v2 offset:0
    ds_read_b128 a[116:119], v2 offset:576
    v_exp_f32 v202, v202
    v_exp_f32 v203, v203
    v_exp_f32 v204, v204
    v_mfma_f32_32x32x16_bf16 v[216:231], a[24:27], a[240:243], v[216:231]
    buffer_load_dwordx4 v1, s[20:23], s41 offen offset:1024 sc1 lds
    v_exp_f32 v205, v205
    v_exp_f32 v206, v206
    v_exp_f32 v207, v207
    v_mfma_f32_32x32x16_bf16 v[232:247], a[28:31], a[240:243], v[232:247]
    ds_read_b128 a[120:123], v2 offset:1152
    ds_read_b128 a[124:127], v2 offset:1728
    v_add_u32 v2, v2, v145
    v_exp_f32 v208, v208
    v_exp_f32 v209, v209
    v_exp_f32 v210, v210
    v_smfmac_f32_32x32x32_bf16 a[200:215], a[104:107], v[200:207], v13
    s_add_u32 s40, s40, 4096
    buffer_load_dwordx4 a[48:51], v1, s[20:23], s40 offen offset:0 sc1
    v_exp_f32 v211, v211
    v_exp_f32 v212, v212
    v_exp_f32 v213, v213
    v_exp_f32 v214, v214
    v_exp_f32 v215, v215
    v_exp_f32 v216, v216
    v_exp_f32 v217, v217
    v_smfmac_f32_32x32x32_bf16 a[200:215], a[108:111], v[208:215], v13
    s_waitcnt lgkmcnt(0)
    buffer_load_dwordx4 a[52:55], v1, s[20:23], s40 offen offset:1024 sc1
    v_exp_f32 v218, v218
    v_exp_f32 v219, v219
    v_exp_f32 v220, v220
    v_mfma_f32_32x32x4_2b_bf16 v[184:215], a[196:197], a[244:245], 0
    buffer_load_dwordx4 v1, s[20:23], s41 offen offset:2048 sc1 lds
    v_exp_f32 v221, v221
    v_exp_f32 v222, v222
    v_exp_f32 v223, v223
    v_exp_f32 v224, v224
    s_branch KO_2
KP_2:
    s_branch KP_back
KO_2:
    v_exp_f32 v225, v225
    v_exp_f32 v226, v226
    v_exp_f32 v227, v227
    v_exp_f32 v228, v228
    v_smfmac_f32_32x32x32_bf16 a[200:215], a[112:115], v[216:223], v13
    s_waitcnt vmcnt(12)
    v_cmp_ne_u64 vcc, s[0:1], v[128:129]
    buffer_load_dwordx4 v1, s[20:23], s41 offen offset:3072 sc1 lds
    v_exp_f32 v229, v229
    v_exp_f32 v230, v230
    v_exp_f32 v231, v231
    v_exp_f32 v232, v232
    v_exp_f32 v233, v233
    v_smfmac_f32_32x32x32_bf16 a[200:215], a[116:119], v[224:231], v13
    s_waitcnt vmcnt(8)
    ds_read_b128 a[128:131], v2 offset:0
    ds_read_b128 a[132:135], v2 offset:576
    v_exp_f32 v234, v234
    v_exp_f32 v235, v235
    v_exp_f32 v236, v236
    v_mfma_f32_32x32x16_bf16 v[184:199], a[32:35], a[240:243], v[184:199]
    buffer_load_dwordx4 a[56:59], v1, s[20:23], s40 offen offset:2048 sc1
    v_exp_f32 v237, v237
    v_exp_f32 v238, v238
    v_exp_f32 v239, v239
    v_mfma_f32_32x32x16_bf16 v[200:215], a[36:39], a[240:243], v[200:215]
    ds_read_b128 a[136:139], v2 offset:1152
    ds_read_b128 a[140:143], v2 offset:1728
    v_add_u32 v2, v2, v145
    v_exp_f32 v240, v240
    v_exp_f32 v241, v241
    v_exp_f32 v242, v242
    v_smfmac_f32_32x32x32_bf16 a[200:215], a[120:123], v[232:239], v13
    buffer_load_dwordx4 a[60:63], v1, s[20:23], s40 offen offset:3072 sc1
    v_exp_f32 v243, v243
    v_exp_f32 v244, v244
    v_exp_f32 v245, v245
    v_mfma_f32_32x32x8_bf16 a[216:231], a[248:249], a[248:249], 0
    v_exp_f32 v246, v246
    v_exp_f32 v247, v247
    v_exp_f32 v184, v184
    v_exp_f32 v185, v185
    v_smfmac_f32_32x32x32_bf16 a[200:215], a[124:127], v[240:247], v13
    s_waitcnt lgkmcnt(0)
    s_add_u32 m0, s3, 16384
    s_add_u32 s41, s41, 4096
    buffer_load_dwordx4 v1, s[20:23], s41 offen offset:0 sc1 lds
    v_exp_f32 v186, v186
    v_exp_f32 v187, v187
    v_exp_f32 v188, v188
    v_mfma_f32_32x32x4_2b_bf16 v[216:247], a[196:197], a[246:247], 0
    v_exp_f32 v189, v189
    v_exp_f32 v190, v190
    v_exp_f32 v191, v191
    v_exp_f32 v192, v192
    v_exp_f32 v193, v193
    v_exp_f32 v194, v194
    v_exp_f32 v195, v195
    v_exp_f32 v196, v196
    v_smfmac_f32_32x32x32_bf16 a[200:215], a[128:131], v[184:191], v13
    s_cbranch_vccnz KM_fh
KM_fhok:
    buffer_load_dwordx4 v1, s[20:23], s41 offen offset:1024 sc1 lds
    v_exp_f32 v197, v197
    v_exp_f32 v198, v198
    v_exp_f32 v199, v199
    v_exp_f32 v200, v200
    v_exp_f32 v201, v201
    v_smfmac_f32_32x32x32_bf16 a[200:215], a[132:135], v[192:199], v13
    s_waitcnt vmcnt(8)
    ds_read_b128 a[144:147], v2 offset:0
    ds_read_b128 a[148:151], v2 offset:576
    v_exp_f32 v202, v202
    v_exp_f32 v203, v203
    v_exp_f32 v204, v204
    v_mfma_f32_32x32x16_bf16 v[216:231], a[40:43], a[240:243], v[216:231]
    s_add_u32 m0, s28, 77824
    s_add_u32 s43, s99, 4096
    buffer_load_dwordx4 v1, s[20:23], s43 offen sc1 lds
    v_exp_f32 v205, v205
    v_exp_f32 v206, v206
    v_exp_f32 v207, v207
    v_mfma_f32_32x32x16_bf16 v[232:247], a[44:47], a[240:243], v[232:247]
    ds_read_b128 a[152:155], v2 offset:1152
    ds_read_b128 a[156:159], v2 offset:1728
    v_add_u32 v2, v2, v145
    v_exp_f32 v208, v208
    v_exp_f32 v209, v209
    v_exp_f32 v210, v210
    v_smfmac_f32_32x32x32_bf16 a[200:215], a[136:139], v[200:207], v13
    s_mov_b32 m0, 81920
    s_add_u32 s43, s29, 8192
    buffer_load_dwordx4 v1, s[20:23], s43 offen sc1 lds
    v_exp_f32 v211, v211
    v_exp_f32 v212, v212
    v_exp_f32 v213, v213
    v_exp_f32 v214, v214
    v_exp_f32 v215, v215
    v_exp_f32 v216, v216
    v_exp_f32 v217, v217
    v_smfmac_f32_32x32x32_bf16 a[200:215], a[140:143], v[208:215], v13
    s_waitcnt lgkmcnt(0)
    s_add_u32 m0, s49, 0
    s_nop 0
    buffer_load_dwordx4 v16, s[12:15], s48 offen lds
    v_exp_f32 v218, v218
    v_exp_f32 v219, v219
    v_exp_f32 v220, v220
    v_mfma_f32_32x32x4_2b_bf16 v[184:215], a[198:199], a[244:245], 0
    v_exp_f32 v221, v221
    v_exp_f32 v222, v222
    v_exp_f32 v223, v223
    v_exp_f32 v224, v224
    v_exp_f32 v225, v225
    v_exp_f32 v226, v226
    v_exp_f32 v227, v227
    v_exp_f32 v228, v228
    v_smfmac_f32_32x32x32_bf16 a[200:215], a[144:147], v[216:223], v13
    s_add_u32 m0, s49, 1024
    s_nop 0
    buffer_load_dwordx4 v17, s[12:15], s48 offen lds
    v_exp_f32 v229, v229
    v_exp_f32 v230, v230
    v_exp_f32 v231, v231
    v_exp_f32 v232, v232
    v_exp_f32 v233, v233
    v_smfmac_f32_32x32x32_bf16 a[200:215], a[148:151], v[224:231], v13
    s_waitcnt vmcnt(8)
    ds_read_b128 a[160:163], v2 offset:0
    ds_read_b128 a[164:167], v2 offset:576
    v_exp_f32 v234, v234
    v_exp_f32 v235, v235
    v_exp_f32 v236, v236
    v_mfma_f32_32x32x16_bf16 v[184:199], a[48:51], a[240:243], v[184:199]
    s_add_u32 m0, s49, 2048
    s_nop 0
    buffer_load_dwordx4 v18, s[12:15], s48 offen lds
    v_exp_f32 v237, v237
    v_exp_f32 v238, v238
    v_exp_f32 v239, v239
    v_mfma_f32_32x32x16_bf16 v[200:215], a[52:55], a[240:243], v[200:215]
    ds_read_b128 a[168:171], v2 offset:1152
    ds_read_b128 a[172:175], v2 offset:1728
    v_add_u32 v2, v2, v145
    v_exp_f32 v240, v240
    v_exp_f32 v241, v241
    v_exp_f32 v242, v242
    v_smfmac_f32_32x32x32_bf16 a[200:215], a[152:155], v[232:239], v13
    s_add_u32 s30, s27, 0
    buffer_load_dwordx4 v[56:59], v1, s[20:23], s30 offen offset:0 sc1
    v_exp_f32 v243, v243
    v_exp_f32 v244, v244
    v_exp_f32 v245, v245
    v_exp_f32 v246, v246
    v_exp_f32 v247, v247
    v_exp_f32 v184, v184
    v_exp_f32 v185, v185
    v_smfmac_f32_32x32x32_bf16 a[200:215], a[156:159], v[240:247], v13
    s_waitcnt lgkmcnt(0)
    buffer_load_dwordx4 v[60:63], v1, s[20:23], s30 offen offset:1024 sc1
    v_exp_f32 v186, v186
    v_exp_f32 v187, v187
    v_exp_f32 v188, v188
    v_mfma_f32_32x32x4_2b_bf16 v[216:247], a[198:199], a[246:247], 0
    v_exp_f32 v189, v189
    v_exp_f32 v190, v190
    v_exp_f32 v191, v191
    v_exp_f32 v192, v192
    v_exp_f32 v193, v193
    v_exp_f32 v194, v194
    v_exp_f32 v195, v195
    v_exp_f32 v196, v196
    v_smfmac_f32_32x32x32_bf16 a[200:215], a[160:163], v[184:191], v13
    s_add_u32 s55, s55, 1
    buffer_load_dwordx4 v[64:67], v1, s[20:23], s30 offen offset:2048 sc1
    v_exp_f32 v197, v197
    v_exp_f32 v198, v198
    v_exp_f32 v199, v199
    v_exp_f32 v200, v200
    v_exp_f32 v201, v201
    v_smfmac_f32_32x32x32_bf16 a[200:215], a[164:167], v[192:199], v13
    s_mul_i32 s48, s55, s56
    s_lshr_b32 s44, s55, 2
    s_waitcnt vmcnt(8)
    ds_read_b128 a[176:179], v2 offset:0
    ds_read_b128 a[180:183], v2 offset:576
    ds_read_b32 a244, v4 offset:1152
    ds_read_b32 a247, v4 offset:1152
    v_exp_f32 v202, v202
    v_exp_f32 v203, v203
    v_exp_f32 v204, v204
    v_mfma_f32_32x32x16_bf16 v[216:231], a[56:59], a[240:243], v[216:231]
    buffer_load_dwordx4 v[68:71], v1, s[20:23], s30 offen offset:3072 sc1
    v_exp_f32 v205, v205
    v_exp_f32 v206, v206
    v_exp_f32 v207, v207
    v_mfma_f32_32x32x16_bf16 v[232:247], a[60:63], a[240:243], v[232:247]
    ds_read_b128 a[184:187], v2 offset:1152
    ds_read_b128 a[188:191], v2 offset:1728
    v_add_u32 v2, v2, v145
    ds_read2_b32 a[240:241], v3 offset1:16
    ds_read2_b32 a[242:243], v146 offset1:16
    v_exp_f32 v208, v208
    v_add_u32 v3, 1152, v3
    v_add_u32 v146, 1152, v146
    v_exp_f32 v209, v209
    v_exp_f32 v210, v210
    v_smfmac_f32_32x32x32_bf16 a[200:215], a[168:171], v[200:207], v13
    s_mul_i32 s44, s44, s57
    s_add_u32 s30, s27, 4096
    buffer_load_dwordx4 v[72:75], v1, s[20:23], s30 offen offset:0 sc1
    v_exp_f32 v211, v211
    v_exp_f32 v212, v212
    v_exp_f32 v213, v213
    v_exp_f32 v214, v214
    v_exp_f32 v215, v215
    v_exp_f32 v216, v216
    v_exp_f32 v217, v217
    v_smfmac_f32_32x32x32_bf16 a[200:215], a[172:175], v[208:215], v13
    s_waitcnt lgkmcnt(0)
    buffer_load_dwordx4 v[76:79], v1, s[20:23], s30 offen offset:1024 sc1
    v_exp_f32 v218, v218
    v_exp_f32 v219, v219
    v_exp_f32 v220, v220
    v_mfma_f32_32x32x4_2b_bf16 v[184:215], a[192:193], a[244:245], 0
    v_exp_f32 v221, v221
    v_exp_f32 v222, v222
    v_exp_f32 v223, v223
    v_exp_f32 v224, v224
    v_exp_f32 v225, v225
    v_exp_f32 v226, v226
    v_exp_f32 v227, v227
    v_exp_f32 v228, v228
    v_smfmac_f32_32x32x32_bf16 a[200:215], a[176:179], v[216:223], v13
    s_add_u32 s48, s48, s44
    buffer_load_dwordx4 v[80:83], v1, s[20:23], s30 offen offset:2048 sc1
    v_exp_f32 v229, v229
    v_exp_f32 v230, v230
    v_exp_f32 v231, v231
    v_exp_f32 v232, v232
    v_exp_f32 v233, v233
    v_smfmac_f32_32x32x32_bf16 a[200:215], a[180:183], v[224:231], v13
    s_cmp_eq_u32 s55, 17
    s_cselect_b32 s44, s58, 0
    v_exp_f32 v234, v234
    v_exp_f32 v235, v235
    v_exp_f32 v236, v236
    v_mfma_f32_32x32x16_bf16 v[184:199], a[0:3], a[240:243], v[184:199]
    buffer_load_dwordx4 v[84:87], v1, s[20:23], s30 offen offset:3072 sc1
    v_exp_f32 v237, v237
    v_exp_f32 v238, v238
    v_exp_f32 v239, v239
    v_mfma_f32_32x32x16_bf16 v[200:215], a[4:7], a[240:243], v[200:215]
    v_exp_f32 v240, v240
    v_exp_f32 v241, v241
    v_exp_f32 v242, v242
    v_smfmac_f32_32x32x32_bf16 a[200:215], a[184:187], v[232:239], v13
    s_add_u32 s48, s48, s44
    s_add_u32 s48, s48, s59
    s_add_u32 s30, s27, 8192
    buffer_load_dwordx4 v[88:91], v1, s[20:23], s30 offen offset:0 sc1
    v_exp_f32 v243, v243
    v_exp_f32 v244, v244
    v_exp_f32 v245, v245
    v_exp_f32 v246, v246
    v_exp_f32 v247, v247
KM_it1:
    v_exp_f32 v184, v184
    v_exp_f32 v185, v185
    v_smfmac_f32_32x32x32_bf16 a[200:215], a[188:191], v[240:247], v13
    buffer_load_dwordx4 v[92:95], v1, s[20:23], s30 offen offset:1024 sc1
    v_exp_f32 v186, v186
    v_exp_f32 v187, v187
    v_exp_f32 v188, v188
    v_mfma_f32_32x32x4_2b_bf16 v[216:247], a[192:193], a[246:247], 0
    v_exp_f32 v189, v189
    v_exp_f32 v190, v190
    v_exp_f32 v191, v191
    v_exp_f32 v192, v192
    v_exp_f32 v193, v193
    v_exp_f32 v194, v194
    v_exp_f32 v195, v195
    v_exp_f32 v196, v196
    v_smfmac_f32_32x32x32_bf16 a[216:231], a[64:67], v[184:191], v13
    buffer_load_dwordx4 v[96:99], v1, s[20:23], s30 offen offset:2048 sc1
    v_exp_f32 v197, v197
    v_exp_f32 v198, v198
    v_exp_f32 v199, v199
    v_exp_f32 v200, v200
    v_exp_f32 v201, v201
    v_smfmac_f32_32x32x32_bf16 a[216:231], a[68:71], v[192:199], v13
    ds_write_b128 v5, a[200:203] offset:0
    v_exp_f32 v202, v202
    v_exp_f32 v203, v203
    v_exp_f32 v204, v204
    v_mfma_f32_32x32x16_bf16 v[216:231], a[8:11], a[240:243], v[216:231]
    buffer_load_dwordx4 v[100:103], v1, s[20:23], s30 offen offset:3072 sc1
    ds_write_b128 v5, a[204:207] offset:1024
    v_exp_f32 v205, v205
    v_exp_f32 v206, v206
    v_exp_f32 v207, v207
    v_mfma_f32_32x32x16_bf16 v[232:247], a[12:15], a[240:243], v[232:247]
    ds_write_b128 v5, a[208:211] offset:2048
    v_exp_f32 v208, v208
    v_exp_f32 v209, v209
    v_exp_f32 v210, v210
    v_smfmac_f32_32x32x32_bf16 a[216:231], a[72:75], v[200:207], v13
    s_add_u32 s30, s27, 12288
    buffer_load_dwordx4 v[104:107], v1, s[20:23], s30 offen offset:0 sc1
    v_exp_f32 v211, v211
    v_exp_f32 v212, v212
    v_exp_f32 v213, v213
    v_exp_f32 v214, v214
    v_exp_f32 v215, v215
    v_exp_f32 v216, v216
    v_exp_f32 v217, v217
    v_smfmac_f32_32x32x32_bf16 a[216:231], a[76:79], v[208:215], v13
    buffer_load_dwordx4 v[108:111], v1, s[20:23], s30 offen offset:1024 sc1
    v_exp_f32 v218, v218
    v_exp_f32 v219, v219
    v_exp_f32 v220, v220
    v_mfma_f32_32x32x4_2b_bf16 v[184:215], a[194:195], a[244:245], 0
    v_exp_f32 v221, v221
    v_exp_f32 v222, v222
    v_exp_f32 v223, v223
    v_exp_f32 v224, v224
    v_exp_f32 v225, v225
    v_exp_f32 v226, v226
    v_exp_f32 v227, v227
    v_exp_f32 v228, v228
    v_smfmac_f32_32x32x32_bf16 a[216:231], a[80:83], v[216:223], v13
    s_waitcnt lgkmcnt(0)
    s_barrier
    buffer_load_dwordx4 v[112:115], v1, s[20:23], s30 offen offset:2048 sc1
    v_exp_f32 v229, v229
    v_exp_f32 v230, v230
    v_exp_f32 v231, v231
    v_exp_f32 v232, v232
    v_exp_f32 v233, v233
    v_smfmac_f32_32x32x32_bf16 a[216:231], a[84:87], v[224:231], v13
    ds_read_b128 v[36:39], v6 offset:0
    ds_read_b128 v[40:43], v6 offset:3072
    v_exp_f32 v234, v234
    v_exp_f32 v235, v235
    v_exp_f32 v236, v236
    v_mfma_f32_32x32x16_bf16 v[184:199], a[16:19], a[240:243], v[184:199]
    buffer_load_dwordx4 v[116:119], v1, s[20:23], s30 offen offset:3072 sc1
    v_exp_f32 v237, v237
    v_exp_f32 v238, v238
    v_exp_f32 v239, v239
    v_mfma_f32_32x32x16_bf16 v[200:215], a[20:23], a[240:243], v[200:215]
    ds_read_b128 v[44:47], v6 offset:6144
    ds_read_b128 v[48:51], v6 offset:9216
    v_exp_f32 v240, v240
    v_exp_f32 v241, v241
    v_exp_f32 v242, v242
    v_smfmac_f32_32x32x32_bf16 a[216:231], a[88:91], v[232:239], v13
    s_add_u32 s30, s27, 16384
    buffer_load_dwordx4 v[120:123], v1, s[20:23], s30 offen offset:0 sc1
    v_exp_f32 v243, v243
    v_exp_f32 v244, v244
    v_exp_f32 v245, v245
    v_exp_f32 v246, v246
    v_exp_f32 v247, v247
    v_exp_f32 v184, v184
    v_exp_f32 v185, v185
    v_smfmac_f32_32x32x32_bf16 a[216:231], a[92:95], v[240:247], v13
    s_waitcnt lgkmcnt(0)
    buffer_load_dwordx4 v[124:127], v1, s[20:23], s30 offen offset:1024 sc1
    v_add_f32 v38, v38, v42
    v_add_f32 v36, v36, v40
    v_add_f32 v37, v37, v41
    v_add_f32 v39, v39, v43
    v_add_f32 v46, v46, v50
    v_add_f32 v44, v44, v48
    v_add_f32 v45, v45, v49
    v_add_f32 v47, v47, v51
    v_add_f32 v38, v38, v46
    v_exp_f32 v186, v186
    v_exp_f32 v187, v187
    v_exp_f32 v188, v188
    v_mfma_f32_32x32x4_2b_bf16 v[216:247], a[194:195], a[246:247], 0
    ds_bpermute_b32 v52, v7, v38
    v_add_f32 v36, v36, v44
    v_add_f32 v37, v37, v45
    v_add_f32 v39, v39, v47
    v_exp_f32 v189, v189
    v_exp_f32 v190, v190
    v_exp_f32 v191, v191
    v_exp_f32 v192, v192
    v_exp_f32 v193, v193
    v_exp_f32 v194, v194
    v_exp_f32 v195, v195
    v_exp_f32 v196, v196
    v_smfmac_f32_32x32x32_bf16 a[216:231], a[96:99], v[184:191], v13
    s_add_u32 m0, s49, 4096
    s_nop 0
    buffer_load_dwordx4 v16, s[12:15], s48 offen lds
    v_exp_f32 v197, v197
    v_exp_f32 v198, v198
    v_exp_f32 v199, v199
    v_exp_f32 v200, v200
    v_exp_f32 v201, v201
    v_smfmac_f32_32x32x32_bf16 a[216:231], a[100:103], v[192:199], v13
    s_waitcnt lgkmcnt(0)
    v_rcp_f32 v54, v52
    v_exp_f32 v202, v202
    v_mul_f32 v36, v36, v54
    v_mul_f32 v37, v37, v54
    v_mul_f32 v38, v38, v54
    v_mul_f32 v39, v39, v54
    v_max3_f32 v14, v14, v52, v54
    v_cvt_pk_bf16_f32 v36, v36, v37
    v_cvt_pk_bf16_f32 v37, v38, v39
    v_exp_f32 v203, v203
    v_exp_f32 v204, v204
    v_mfma_f32_32x32x16_bf16 v[216:231], a[24:27], a[240:243], v[216:231]
    s_add_u32 m0, s49, 5120
    s_nop 0
    buffer_load_dwordx4 v17, s[12:15], s48 offen lds
    v_exp_f32 v205, v205
    v_exp_f32 v206, v206
    v_exp_f32 v207, v207
    v_mfma_f32_32x32x16_bf16 v[232:247], a[28:31], a[240:243], v[232:247]
    ds_write_b32 v8, v36 offset:0
    ds_write_b32 v9, v37 offset:0
    v_exp_f32 v208, v208
    v_exp_f32 v209, v209
    v_exp_f32 v210, v210
    v_smfmac_f32_32x32x32_bf16 a[216:231], a[104:107], v[200:207], v13
    s_add_u32 m0, s49, 6144
    s_nop 0
    buffer_load_dwordx4 v18, s[12:15], s48 offen lds
    v_exp_f32 v211, v211
    v_exp_f32 v212, v212
    v_exp_f32 v213, v213
    v_mfma_f32_32x32x8_bf16 a[200:215], a[248:249], a[248:249], 0
    v_exp_f32 v214, v214
    v_exp_f32 v215, v215
    v_exp_f32 v216, v216
    v_exp_f32 v217, v217
    v_smfmac_f32_32x32x32_bf16 a[216:231], a[108:111], v[208:215], v13
    s_waitcnt lgkmcnt(0)
    s_barrier
    v_exp_f32 v218, v218
    v_exp_f32 v219, v219
    v_exp_f32 v220, v220
    v_mfma_f32_32x32x4_2b_bf16 v[184:215], a[196:197], a[244:245], 0
    v_exp_f32 v221, v221
    v_exp_f32 v222, v222
    v_exp_f32 v223, v223
    v_exp_f32 v224, v224
    v_exp_f32 v225, v225
    v_exp_f32 v226, v226
    v_exp_f32 v227, v227
    v_exp_f32 v228, v228
    v_smfmac_f32_32x32x32_bf16 a[216:231], a[112:115], v[216:223], v13
    ds_read_b128 a[232:235], v12 offset:0
    ds_read_b128 a[236:239], v12 offset:1024
    v_exp_f32 v229, v229
    v_exp_f32 v230, v230
    v_exp_f32 v231, v231
    v_exp_f32 v232, v232
    v_exp_f32 v233, v233
    v_smfmac_f32_32x32x32_bf16 a[216:231], a[116:119], v[224:231], v13
    v_exp_f32 v234, v234
    v_exp_f32 v235, v235
    v_exp_f32 v236, v236
    v_mfma_f32_32x32x16_bf16 v[184:199], a[32:35], a[240:243], v[184:199]
    v_exp_f32 v237, v237
    v_exp_f32 v238, v238
    v_exp_f32 v239, v239
    v_mfma_f32_32x32x16_bf16 v[200:215], a[36:39], a[240:243], v[200:215]
    v_exp_f32 v240, v240
    v_exp_f32 v241, v241
    v_exp_f32 v242, v242
    v_smfmac_f32_32x32x32_bf16 a[216:231], a[120:123], v[232:239], v13
    v_exp_f32 v243, v243
    v_exp_f32 v244, v244
    v_exp_f32 v245, v245
    v_exp_f32 v246, v246
    v_exp_f32 v247, v247
    v_exp_f32 v184, v184
    v_exp_f32 v185, v185
    v_smfmac_f32_32x32x32_bf16 a[216:231], a[124:127], v[240:247], v13
    v_exp_f32 v186, v186
    v_exp_f32 v187, v187
    v_exp_f32 v188, v188
    v_mfma_f32_32x32x4_2b_bf16 v[216:247], a[196:197], a[246:247], 0
    v_exp_f32 v189, v189
    v_exp_f32 v190, v190
    v_exp_f32 v191, v191
    v_exp_f32 v192, v192
    v_exp_f32 v193, v193
    v_exp_f32 v194, v194
    v_exp_f32 v195, v195
    v_exp_f32 v196, v196
    v_smfmac_f32_32x32x32_bf16 a[216:231], a[128:131], v[184:191], v13
    s_waitcnt vmcnt(12) lgkmcnt(0)
    ds_read_b64_tr_b16 v[24:25], v19 offset:0
    ds_read_b64_tr_b16 v[26:27], v19 offset:384
    ds_read_b64_tr_b16 v[28:29], v19 offset:32
    v_exp_f32 v197, v197
    v_exp_f32 v198, v198
    v_exp_f32 v199, v199
    v_mfma_f32_16x16x32_bf16 v[148:151], v[56:59], a[232:235], v[148:151]
    v_exp_f32 v200, v200
    v_mfma_f32_16x16x32_bf16 v[152:155], v[60:63], a[232:235], v[152:155]
    v_exp_f32 v201, v201
    v_smfmac_f32_32x32x32_bf16 a[216:231], a[132:135], v[192:199], v13
    ds_read_b64_tr_b16 v[30:31], v19 offset:416
    ds_read_b64_tr_b16 v[32:33], v19 offset:64
    ds_read_b64_tr_b16 v[34:35], v19 offset:448
    v_exp_f32 v202, v202
    v_exp_f32 v203, v203
    v_exp_f32 v204, v204
    v_mfma_f32_32x32x16_bf16 v[216:231], a[40:43], a[240:243], v[216:231]
    v_exp_f32 v205, v205
    v_exp_f32 v206, v206
    v_exp_f32 v207, v207
    v_mfma_f32_32x32x16_bf16 v[232:247], a[44:47], a[240:243], v[232:247]
    v_exp_f32 v208, v208
    v_exp_f32 v209, v209
    v_exp_f32 v210, v210
    v_smfmac_f32_32x32x32_bf16 a[216:231], a[136:139], v[200:207], v13
    s_waitcnt lgkmcnt(0)
    s_add_u32 s50, s50, 1024
    buffer_store_dwordx4 v[24:27], v1, s[16:19], s50 offen sc1
    v_exp_f32 v211, v211
    v_exp_f32 v212, v212
    v_exp_f32 v213, v213
    v_mfma_f32_16x16x32_bf16 v[156:159], v[64:67], a[232:235], v[156:159]
    v_exp_f32 v214, v214
    v_mfma_f32_16x16x32_bf16 v[160:163], v[68:71], a[232:235], v[160:163]
    v_exp_f32 v215, v215
    v_mfma_f32_16x16x32_bf16 v[164:167], v[72:75], a[232:235], v[164:167]
    v_exp_f32 v216, v216
    v_mfma_f32_16x16x32_bf16 v[168:171], v[76:79], a[232:235], v[168:171]
    v_exp_f32 v217, v217
    v_smfmac_f32_32x32x32_bf16 a[216:231], a[140:143], v[208:215], v13
    s_add_u32 s46, s50, s51
    buffer_store_dwordx4 v[28:31], v1, s[16:19], s46 offen sc1
    v_exp_f32 v218, v218
    v_exp_f32 v219, v219
    v_exp_f32 v220, v220
    v_mfma_f32_32x32x4_2b_bf16 v[184:215], a[198:199], a[244:245], 0
    v_exp_f32 v221, v221
    v_exp_f32 v222, v222
    v_exp_f32 v223, v223
    v_exp_f32 v224, v224
    v_exp_f32 v225, v225
    v_exp_f32 v226, v226
    v_exp_f32 v227, v227
    v_exp_f32 v228, v228
    v_smfmac_f32_32x32x32_bf16 a[216:231], a[144:147], v[216:223], v13
    s_add_u32 s46, s46, s51
    buffer_store_dwordx4 v[32:35], v1, s[16:19], s46 offen sc1
    v_exp_f32 v229, v229
    v_exp_f32 v230, v230
    v_exp_f32 v231, v231
    v_mfma_f32_16x16x32_bf16 v[172:175], v[80:83], a[232:235], v[172:175]
    v_exp_f32 v232, v232
    v_mfma_f32_16x16x32_bf16 v[176:179], v[84:87], a[232:235], v[176:179]
    v_exp_f32 v233, v233
    v_smfmac_f32_32x32x32_bf16 a[216:231], a[148:151], v[224:231], v13
    v_exp_f32 v234, v234
    v_exp_f32 v235, v235
    v_exp_f32 v236, v236
    v_mfma_f32_32x32x16_bf16 v[184:199], a[48:51], a[240:243], v[184:199]
    buffer_load_dwordx4 v[56:59], v1, s[20:23], s30 offen offset:2048 sc1
    v_exp_f32 v237, v237
    v_exp_f32 v238, v238
    v_exp_f32 v239, v239
    v_mfma_f32_32x32x16_bf16 v[200:215], a[52:55], a[240:243], v[200:215]
    v_exp_f32 v240, v240
    v_exp_f32 v241, v241
    v_exp_f32 v242, v242
    v_smfmac_f32_32x32x32_bf16 a[216:231], a[152:155], v[232:239], v13
    s_waitcnt vmcnt(7)
    buffer_load_dwordx4 v[60:63], v1, s[20:23], s30 offen offset:3072 sc1
    v_exp_f32 v243, v243
    v_exp_f32 v244, v244
    v_exp_f32 v245, v245
    v_mfma_f32_16x16x32_bf16 v[180:183], v[88:91], a[232:235], v[180:183]
    v_exp_f32 v246, v246
    v_mfma_f32_16x16x32_bf16 v[148:151], v[92:95], a[236:239], v[148:151]
    v_exp_f32 v247, v247
    v_mfma_f32_16x16x32_bf16 v[152:155], v[96:99], a[236:239], v[152:155]
    v_exp_f32 v184, v184
    v_mfma_f32_16x16x32_bf16 v[156:159], v[100:103], a[236:239], v[156:159]
    v_exp_f32 v185, v185
    v_smfmac_f32_32x32x32_bf16 a[216:231], a[156:159], v[240:247], v13
    s_add_u32 s30, s27, 20480
    buffer_load_dwordx4 v[64:67], v1, s[20:23], s30 offen offset:0 sc1
    v_exp_f32 v186, v186
    v_exp_f32 v187, v187
    v_exp_f32 v188, v188
    v_mfma_f32_32x32x4_2b_bf16 v[216:247], a[198:199], a[246:247], 0
    v_exp_f32 v189, v189
    v_exp_f32 v190, v190
    v_exp_f32 v191, v191
    v_exp_f32 v192, v192
    v_exp_f32 v193, v193
    v_exp_f32 v194, v194
    v_exp_f32 v195, v195
    v_exp_f32 v196, v196
    v_smfmac_f32_32x32x32_bf16 a[216:231], a[160:163], v[184:191], v13
    s_add_u32 s55, s55, 1
    buffer_load_dwordx4 v[68:71], v1, s[20:23], s30 offen offset:1024 sc1
    v_exp_f32 v197, v197
    v_exp_f32 v198, v198
    v_exp_f32 v199, v199
    v_mfma_f32_16x16x32_bf16 v[160:163], v[104:107], a[236:239], v[160:163]
    v_exp_f32 v200, v200
    v_mfma_f32_16x16x32_bf16 v[164:167], v[108:111], a[236:239], v[164:167]
    v_exp_f32 v201, v201
    v_smfmac_f32_32x32x32_bf16 a[216:231], a[164:167], v[192:199], v13
    s_mul_i32 s48, s55, s56
    s_lshr_b32 s44, s55, 2
    ds_read_b32 a244, v4 offset:2304
    ds_read_b32 a247, v4 offset:2304
    v_exp_f32 v202, v202
    v_exp_f32 v203, v203
    v_exp_f32 v204, v204
    v_mfma_f32_32x32x16_bf16 v[216:231], a[56:59], a[240:243], v[216:231]
    buffer_load_dwordx4 v[72:75], v1, s[20:23], s30 offen offset:2048 sc1
    v_exp_f32 v205, v205
    v_exp_f32 v206, v206
    v_exp_f32 v207, v207
    v_mfma_f32_32x32x16_bf16 v[232:247], a[60:63], a[240:243], v[232:247]
    ds_read2_b32 a[240:241], v3 offset1:16
    ds_read2_b32 a[242:243], v146 offset1:16
    v_exp_f32 v208, v208
    v_add_u32 v3, 1152, v3
    v_add_u32 v146, 1152, v146
    v_exp_f32 v209, v209
    v_exp_f32 v210, v210
    v_smfmac_f32_32x32x32_bf16 a[216:231], a[168:171], v[200:207], v13
    s_mul_i32 s44, s44, s57
    buffer_load_dwordx4 v[76:79], v1, s[20:23], s30 offen offset:3072 sc1
    v_exp_f32 v211, v211
    v_exp_f32 v212, v212
    v_exp_f32 v213, v213
    v_mfma_f32_16x16x32_bf16 v[168:171], v[112:115], a[236:239], v[168:171]
    v_exp_f32 v214, v214
    v_mfma_f32_16x16x32_bf16 v[172:175], v[116:119], a[236:239], v[172:175]
    v_exp_f32 v215, v215
    v_exp_f32 v216, v216
    v_exp_f32 v217, v217
    v_smfmac_f32_32x32x32_bf16 a[216:231], a[172:175], v[208:215], v13
    s_waitcnt lgkmcnt(0)
    s_add_u32 s30, s27, 24576
    buffer_load_dwordx4 v[80:83], v1, s[20:23], s30 offen offset:0 sc1
    v_exp_f32 v218, v218
    v_exp_f32 v219, v219
    v_exp_f32 v220, v220
    v_mfma_f32_32x32x4_2b_bf16 v[184:215], a[192:193], a[244:245], 0
    v_exp_f32 v221, v221
    v_exp_f32 v222, v222
    v_exp_f32 v223, v223
    v_exp_f32 v224, v224
    v_exp_f32 v225, v225
    v_exp_f32 v226, v226
    v_exp_f32 v227, v227
    v_exp_f32 v228, v228
    v_smfmac_f32_32x32x32_bf16 a[216:231], a[176:179], v[216:223], v13
    s_add_u32 s48, s48, s44
    buffer_load_dwordx4 v[84:87], v1, s[20:23], s30 offen offset:1024 sc1
    v_exp_f32 v229, v229
    v_exp_f32 v230, v230
    v_exp_f32 v231, v231
    v_mfma_f32_16x16x32_bf16 v[176:179], v[120:123], a[236:239], v[176:179]
    v_exp_f32 v232, v232
    v_mfma_f32_16x16x32_bf16 v[180:183], v[124:127], a[236:239], v[180:183]
    v_exp_f32 v233, v233
    v_smfmac_f32_32x32x32_bf16 a[216:231], a[180:183], v[224:231], v13
    s_cmp_eq_u32 s55, 17
    s_cselect_b32 s44, s58, 0
    v_exp_f32 v234, v234
    v_exp_f32 v235, v235
    v_exp_f32 v236, v236
    v_mfma_f32_32x32x16_bf16 v[184:199], a[0:3], a[240:243], v[184:199]
    buffer_load_dwordx4 v[88:91], v1, s[20:23], s30 offen offset:2048 sc1
    v_exp_f32 v237, v237
    v_exp_f32 v238, v238
    v_exp_f32 v239, v239
    v_mfma_f32_32x32x16_bf16 v[200:215], a[4:7], a[240:243], v[200:215]
    v_exp_f32 v240, v240
    v_exp_f32 v241, v241
    v_exp_f32 v242, v242
    v_smfmac_f32_32x32x32_bf16 a[216:231], a[184:187], v[232:239], v13
    s_add_u32 s48, s48, s44
    s_add_u32 s48, s48, s59
    v_exp_f32 v243, v243
    v_exp_f32 v244, v244
    v_exp_f32 v245, v245
    v_exp_f32 v246, v246
    v_exp_f32 v247, v247
KM_it2:
    v_exp_f32 v184, v184
    v_exp_f32 v185, v185
    v_smfmac_f32_32x32x32_bf16 a[216:231], a[188:191], v[240:247], v13
    buffer_load_dwordx4 v[92:95], v1, s[20:23], s30 offen offset:3072 sc1
    v_exp_f32 v186, v186
    v_exp_f32 v187, v187
    v_exp_f32 v188, v188
    v_mfma_f32_32x32x4_2b_bf16 v[216:247], a[192:193], a[246:247], 0
    v_exp_f32 v189, v189
    v_exp_f32 v190, v190
    v_exp_f32 v191, v191
    v_exp_f32 v192, v192
    v_exp_f32 v193, v193
    v_exp_f32 v194, v194
    v_exp_f32 v195, v195
    v_exp_f32 v196, v196
    v_smfmac_f32_32x32x32_bf16 a[200:215], a[64:67], v[184:191], v13
    s_add_u32 s30, s27, 28672
    buffer_load_dwordx4 v[96:99], v1, s[20:23], s30 offen offset:0 sc1
    v_exp_f32 v197, v197
    v_exp_f32 v198, v198
    v_exp_f32 v199, v199
    v_exp_f32 v200, v200
    v_exp_f32 v201, v201
    v_smfmac_f32_32x32x32_bf16 a[200:215], a[68:71], v[192:199], v13
    ds_write_b128 v5, a[216:219] offset:0
    v_exp_f32 v202, v202
    v_exp_f32 v203, v203
    v_exp_f32 v204, v204
    v_mfma_f32_32x32x16_bf16 v[216:231], a[8:11], a[240:243], v[216:231]
    buffer_load_dwordx4 v[100:103], v1, s[20:23], s30 offen offset:1024 sc1
    ds_write_b128 v5, a[220:223] offset:1024
    v_exp_f32 v205, v205
    v_exp_f32 v206, v206
    v_exp_f32 v207, v207
    v_mfma_f32_32x32x16_bf16 v[232:247], a[12:15], a[240:243], v[232:247]
    ds_write_b128 v5, a[224:227] offset:2048
    v_exp_f32 v208, v208
    v_exp_f32 v209, v209
    v_exp_f32 v210, v210
    v_smfmac_f32_32x32x32_bf16 a[200:215], a[72:75], v[200:207], v13
    buffer_load_dwordx4 v[104:107], v1, s[20:23], s30 offen offset:2048 sc1
    v_exp_f32 v211, v211
    v_exp_f32 v212, v212
    v_exp_f32 v213, v213
    v_exp_f32 v214, v214
    v_exp_f32 v215, v215
    v_exp_f32 v216, v216
    v_exp_f32 v217, v217
    v_smfmac_f32_32x32x32_bf16 a[200:215], a[76:79], v[208:215], v13
    buffer_load_dwordx4 v[108:111], v1, s[20:23], s30 offen offset:3072 sc1
    v_exp_f32 v218, v218
    v_exp_f32 v219, v219
    v_exp_f32 v220, v220
    v_mfma_f32_32x32x4_2b_bf16 v[184:215], a[194:195], a[244:245], 0
    v_exp_f32 v221, v221
    v_exp_f32 v222, v222
    v_exp_f32 v223, v223
    v_exp_f32 v224, v224
    v_exp_f32 v225, v225
    v_exp_f32 v226, v226
    v_exp_f32 v227, v227
    v_exp_f32 v228, v228
    v_smfmac_f32_32x32x32_bf16 a[200:215], a[80:83], v[216:223], v13
    s_waitcnt lgkmcnt(0)
    s_barrier
    s_add_u32 s30, s27, 32768
    buffer_load_dwordx4 v[112:115], v1, s[20:23], s30 offen offset:0 sc1
    v_exp_f32 v229, v229
    v_exp_f32 v230, v230
    v_exp_f32 v231, v231
    v_exp_f32 v232, v232
    v_exp_f32 v233, v233
    v_smfmac_f32_32x32x32_bf16 a[200:215], a[84:87], v[224:231], v13
    ds_read_b128 v[36:39], v6 offset:0
    ds_read_b128 v[40:43], v6 offset:3072
    v_exp_f32 v234, v234
    v_exp_f32 v235, v235
    v_exp_f32 v236, v236
    v_mfma_f32_32x32x16_bf16 v[184:199], a[16:19], a[240:243], v[184:199]
    s_branch KO_3
KP_3:
    s_branch KP_back
KO_3:
    buffer_load_dwordx4 v[116:119], v1, s[20:23], s30 offen offset:1024 sc1
    v_exp_f32 v237, v237
    v_exp_f32 v238, v238
    v_exp_f32 v239, v239
    v_mfma_f32_32x32x16_bf16 v[200:215], a[20:23], a[240:243], v[200:215]
    ds_read_b128 v[44:47], v6 offset:6144
    ds_read_b128 v[48:51], v6 offset:9216
    v_exp_f32 v240, v240
    v_exp_f32 v241, v241
    v_exp_f32 v242, v242
    v_smfmac_f32_32x32x32_bf16 a[200:215], a[88:91], v[232:239], v13
    buffer_load_dwordx4 v[120:123], v1, s[20:23], s30 offen offset:2048 sc1
    v_exp_f32 v243, v243
    v_exp_f32 v244, v244
    v_exp_f32 v245, v245
    v_exp_f32 v246, v246
    v_exp_f32 v247, v247
    v_exp_f32 v184, v184
    v_exp_f32 v185, v185
    v_smfmac_f32_32x32x32_bf16 a[200:215], a[92:95], v[240:247], v13
    s_waitcnt lgkmcnt(0)
    buffer_load_dwordx4 v[124:127], v1, s[20:23], s30 offen offset:3072 sc1
    v_add_f32 v38, v38, v42
    v_add_f32 v36, v36, v40
    v_add_f32 v37, v37, v41
    v_add_f32 v39, v39, v43
    v_add_f32 v46, v46, v50
    v_add_f32 v44, v44, v48
    v_add_f32 v45, v45, v49
    v_add_f32 v47, v47, v51
    v_add_f32 v38, v38, v46
    v_exp_f32 v186, v186
    v_exp_f32 v187, v187
    v_exp_f32 v188, v188
    v_mfma_f32_32x32x4_2b_bf16 v[216:247], a[194:195], a[246:247], 0
    ds_bpermute_b32 v52, v7, v38
    v_add_f32 v36, v36, v44
    v_add_f32 v37, v37, v45
    v_add_f32 v39, v39, v47
    v_exp_f32 v189, v189
    v_exp_f32 v190, v190
    v_exp_f32 v191, v191
    v_exp_f32 v192, v192
    v_exp_f32 v193, v193
    v_exp_f32 v194, v194
    v_exp_f32 v195, v195
    v_exp_f32 v196, v196
    v_smfmac_f32_32x32x32_bf16 a[200:215], a[96:99], v[184:191], v13
    s_add_u32 m0, s49, 0
    s_nop 0
    buffer_load_dwordx4 v16, s[12:15], s48 offen lds
    v_exp_f32 v197, v197
    v_exp_f32 v198, v198
    v_exp_f32 v199, v199
    v_exp_f32 v200, v200
    v_exp_f32 v201, v201
    v_smfmac_f32_32x32x32_bf16 a[200:215], a[100:103], v[192:199], v13
    s_waitcnt lgkmcnt(0)
    v_rcp_f32 v54, v52
    v_exp_f32 v202, v202
    v_mul_f32 v36, v36, v54
    v_mul_f32 v37, v37, v54
    v_mul_f32 v38, v38, v54
    v_mul_f32 v39, v39, v54
    v_max3_f32 v14, v14, v52, v54
    v_cvt_pk_bf16_f32 v36, v36, v37
    v_cvt_pk_bf16_f32 v37, v38, v39
    v_exp_f32 v203, v203
    v_exp_f32 v204, v204
    v_mfma_f32_32x32x16_bf16 v[216:231], a[24:27], a[240:243], v[216:231]
    s_add_u32 m0, s49, 1024
    s_nop 0
    buffer_load_dwordx4 v17, s[12:15], s48 offen lds
    v_exp_f32 v205, v205
    v_exp_f32 v206, v206
    v_exp_f32 v207, v207
    v_mfma_f32_32x32x16_bf16 v[232:247], a[28:31], a[240:243], v[232:247]
    ds_write_b32 v8, v36 offset:2560
    ds_write_b32 v9, v37 offset:2560
    v_exp_f32 v208, v208
    v_exp_f32 v209, v209
    v_exp_f32 v210, v210
    v_smfmac_f32_32x32x32_bf16 a[200:215], a[104:107], v[200:207], v13
    s_add_u32 m0, s49, 2048
    s_nop 0
    buffer_load_dwordx4 v18, s[12:15], s48 offen lds
    v_exp_f32 v211, v211
    v_exp_f32 v212, v212
    v_exp_f32 v213, v213
    v_mfma_f32_32x32x8_bf16 a[216:231], a[248:249], a[248:249], 0
    v_exp_f32 v214, v214
    v_exp_f32 v215, v215
    v_exp_f32 v216, v216
    v_exp_f32 v217, v217
    v_smfmac_f32_32x32x32_bf16 a[200:215], a[108:111], v[208:215], v13
    s_waitcnt lgkmcnt(0)
    s_barrier
    v_exp_f32 v218, v218
    v_exp_f32 v219, v219
    v_exp_f32 v220, v220
    v_mfma_f32_32x32x4_2b_bf16 v[184:215], a[196:197], a[244:245], 0
    v_exp_f32 v221, v221
    v_exp_f32 v222, v222
    v_exp_f32 v223, v223
    v_exp_f32 v224, v224
    v_exp_f32 v225, v225
    v_exp_f32 v226, v226
    v_exp_f32 v227, v227
    v_exp_f32 v228, v228
    v_smfmac_f32_32x32x32_bf16 a[200:215], a[112:115], v[216:223], v13
    ds_read_b128 a[232:235], v12 offset:2560
    ds_read_b128 a[236:239], v12 offset:3584
    v_exp_f32 v229, v229
    v_exp_f32 v230, v230
    v_exp_f32 v231, v231
    v_exp_f32 v232, v232
    v_exp_f32 v233, v233
    v_smfmac_f32_32x32x32_bf16 a[200:215], a[116:119], v[224:231], v13
    v_exp_f32 v234, v234
    v_exp_f32 v235, v235
    v_exp_f32 v236, v236
    v_mfma_f32_32x32x16_bf16 v[184:199], a[32:35], a[240:243], v[184:199]
    v_exp_f32 v237, v237
    v_exp_f32 v238, v238
    v_exp_f32 v239, v239
    v_mfma_f32_32x32x16_bf16 v[200:215], a[36:39], a[240:243], v[200:215]
    v_exp_f32 v240, v240
    v_exp_f32 v241, v241
    v_exp_f32 v242, v242
    v_smfmac_f32_32x32x32_bf16 a[200:215], a[120:123], v[232:239], v13
    v_exp_f32 v243, v243
    v_exp_f32 v244, v244
    v_exp_f32 v245, v245
    v_exp_f32 v246, v246
    v_exp_f32 v247, v247
    v_exp_f32 v184, v184
    v_exp_f32 v185, v185
    v_smfmac_f32_32x32x32_bf16 a[200:215], a[124:127], v[240:247], v13
    v_exp_f32 v186, v186
    v_exp_f32 v187, v187
    v_exp_f32 v188, v188
    v_mfma_f32_32x32x4_2b_bf16 v[216:247], a[196:197], a[246:247], 0
    v_exp_f32 v189, v189
    v_exp_f32 v190, v190
    v_exp_f32 v191, v191
    v_exp_f32 v192, v192
    v_exp_f32 v193, v193
    v_exp_f32 v194, v194
    v_exp_f32 v195, v195
    v_exp_f32 v196, v196
    v_smfmac_f32_32x32x32_bf16 a[200:215], a[128:131], v[184:191], v13
    s_waitcnt vmcnt(12) lgkmcnt(0)
    ds_read_b64_tr_b16 v[24:25], v19 offset:4096
    ds_read_b64_tr_b16 v[26:27], v19 offset:4480
    ds_read_b64_tr_b16 v[28:29], v19 offset:4128
    v_exp_f32 v197, v197
    v_exp_f32 v198, v198
    v_exp_f32 v199, v199
    v_mfma_f32_16x16x32_bf16 v[148:151], v[56:59], a[232:235], v[148:151]
    v_exp_f32 v200, v200
    v_mfma_f32_16x16x32_bf16 v[152:155], v[60:63], a[232:235], v[152:155]
    v_exp_f32 v201, v201
    v_smfmac_f32_32x32x32_bf16 a[200:215], a[132:135], v[192:199], v13
    ds_read_b64_tr_b16 v[30:31], v19 offset:4512
    ds_read_b64_tr_b16 v[32:33], v19 offset:4160
    ds_read_b64_tr_b16 v[34:35], v19 offset:4544
    v_exp_f32 v202, v202
    v_exp_f32 v203, v203
    v_exp_f32 v204, v204
    v_mfma_f32_32x32x16_bf16 v[216:231], a[40:43], a[240:243], v[216:231]
    v_exp_f32 v205, v205
    v_exp_f32 v206, v206
    v_exp_f32 v207, v207
    v_mfma_f32_32x32x16_bf16 v[232:247], a[44:47], a[240:243], v[232:247]
    v_exp_f32 v208, v208
    v_exp_f32 v209, v209
    v_exp_f32 v210, v210
    v_smfmac_f32_32x32x32_bf16 a[200:215], a[136:139], v[200:207], v13
    s_waitcnt lgkmcnt(0)
    s_add_u32 s50, s50, 1024
    buffer_store_dwordx4 v[24:27], v1, s[16:19], s50 offen sc1
    v_exp_f32 v211, v211
    v_exp_f32 v212, v212
    v_exp_f32 v213, v213
    v_mfma_f32_16x16x32_bf16 v[156:159], v[64:67], a[232:235], v[156:159]
    v_exp_f32 v214, v214
    v_mfma_f32_16x16x32_bf16 v[160:163], v[68:71], a[232:235], v[160:163]
    v_exp_f32 v215, v215
    v_mfma_f32_16x16x32_bf16 v[164:167], v[72:75], a[232:235], v[164:167]
    v_exp_f32 v216, v216
    v_mfma_f32_16x16x32_bf16 v[168:171], v[76:79], a[232:235], v[168:171]
    v_exp_f32 v217, v217
    v_smfmac_f32_32x32x32_bf16 a[200:215], a[140:143], v[208:215], v13
    s_add_u32 s46, s50, s51
    buffer_store_dwordx4 v[28:31], v1, s[16:19], s46 offen sc1
    v_exp_f32 v218, v218
    v_exp_f32 v219, v219
    v_exp_f32 v220, v220
    v_mfma_f32_32x32x4_2b_bf16 v[184:215], a[198:199], a[244:245], 0
    v_exp_f32 v221, v221
    v_exp_f32 v222, v222
    v_exp_f32 v223, v223
    v_exp_f32 v224, v224
    v_exp_f32 v225, v225
    v_exp_f32 v226, v226
    v_exp_f32 v227, v227
    v_exp_f32 v228, v228
    v_smfmac_f32_32x32x32_bf16 a[200:215], a[144:147], v[216:223], v13
    s_add_u32 s46, s46, s51
    buffer_store_dwordx4 v[32:35], v1, s[16:19], s46 offen sc1
    v_exp_f32 v229, v229
    v_exp_f32 v230, v230
    v_exp_f32 v231, v231
    v_mfma_f32_16x16x32_bf16 v[172:175], v[80:83], a[232:235], v[172:175]
    v_exp_f32 v232, v232
    v_mfma_f32_16x16x32_bf16 v[176:179], v[84:87], a[232:235], v[176:179]
    v_exp_f32 v233, v233
    v_smfmac_f32_32x32x32_bf16 a[200:215], a[148:151], v[224:231], v13
    v_exp_f32 v234, v234
    v_exp_f32 v235, v235
    v_exp_f32 v236, v236
    v_mfma_f32_32x32x16_bf16 v[184:199], a[48:51], a[240:243], v[184:199]
    s_add_u32 s30, s27, 36864
    buffer_load_dwordx4 v[56:59], v1, s[20:23], s30 offen offset:0 sc1
    v_exp_f32 v237, v237
    v_exp_f32 v238, v238
    v_exp_f32 v239, v239
    v_mfma_f32_32x32x16_bf16 v[200:215], a[52:55], a[240:243], v[200:215]
    v_exp_f32 v240, v240
    v_exp_f32 v241, v241
    v_exp_f32 v242, v242
    v_smfmac_f32_32x32x32_bf16 a[200:215], a[152:155], v[232:239], v13
    s_waitcnt vmcnt(7)
    buffer_load_dwordx4 v[60:63], v1, s[20:23], s30 offen offset:1024 sc1
    v_exp_f32 v243, v243
    v_exp_f32 v244, v244
    v_exp_f32 v245, v245
    v_mfma_f32_16x16x32_bf16 v[180:183], v[88:91], a[232:235], v[180:183]
    v_exp_f32 v246, v246
    v_mfma_f32_16x16x32_bf16 v[148:151], v[92:95], a[236:239], v[148:151]
    v_exp_f32 v247, v247
    v_mfma_f32_16x16x32_bf16 v[152:155], v[96:99], a[236:239], v[152:155]
    v_exp_f32 v184, v184
    v_mfma_f32_16x16x32_bf16 v[156:159], v[100:103], a[236:239], v[156:159]
    v_exp_f32 v185, v185
    v_smfmac_f32_32x32x32_bf16 a[200:215], a[156:159], v[240:247], v13
    buffer_load_dwordx4 v[64:67], v1, s[20:23], s30 offen offset:2048 sc1
    v_exp_f32 v186, v186
    v_exp_f32 v187, v187
    v_exp_f32 v188, v188
    v_mfma_f32_32x32x4_2b_bf16 v[216:247], a[198:199], a[246:247], 0
    v_exp_f32 v189, v189
    v_exp_f32 v190, v190
    v_exp_f32 v191, v191
    v_exp_f32 v192, v192
    v_exp_f32 v193, v193
    v_exp_f32 v194, v194
    v_exp_f32 v195, v195
    v_exp_f32 v196, v196
    v_smfmac_f32_32x32x32_bf16 a[200:215], a[160:163], v[184:191], v13
    s_add_u32 s55, s55, 1
    buffer_load_dwordx4 v[68:71], v1, s[20:23], s30 offen offset:3072 sc1
    v_exp_f32 v197, v197
    v_exp_f32 v198, v198
    v_exp_f32 v199, v199
    v_mfma_f32_16x16x32_bf16 v[160:163], v[104:107], a[236:239], v[160:163]
    v_exp_f32 v200, v200
    v_mfma_f32_16x16x32_bf16 v[164:167], v[108:111], a[236:239], v[164:167]
    v_exp_f32 v201, v201
    v_smfmac_f32_32x32x32_bf16 a[200:215], a[164:167], v[192:199], v13
    s_mul_i32 s48, s55, s56
    s_lshr_b32 s44, s55, 2
    ds_read_b32 a244, v4 offset:3456
    ds_read_b32 a247, v4 offset:3456
    v_exp_f32 v202, v202
    v_exp_f32 v203, v203
    v_exp_f32 v204, v204
    v_mfma_f32_32x32x16_bf16 v[216:231], a[56:59], a[240:243], v[216:231]
    s_add_u32 s30, s27, 40960
    buffer_load_dwordx4 v[72:75], v1, s[20:23], s30 offen offset:0 sc1
    v_exp_f32 v205, v205
    v_exp_f32 v206, v206
    v_exp_f32 v207, v207
    v_mfma_f32_32x32x16_bf16 v[232:247], a[60:63], a[240:243], v[232:247]
    ds_read2_b32 a[240:241], v3 offset1:16
    ds_read2_b32 a[242:243], v146 offset1:16
    v_exp_f32 v208, v208
    v_add_u32 v3, 1152, v3
    v_add_u32 v146, 1152, v146
    v_exp_f32 v209, v209
    v_exp_f32 v210, v210
    v_smfmac_f32_32x32x32_bf16 a[200:215], a[168:171], v[200:207], v13
    s_mul_i32 s44, s44, s57
    buffer_load_dwordx4 v[76:79], v1, s[20:23], s30 offen offset:1024 sc1
    v_exp_f32 v211, v211
    v_exp_f32 v212, v212
    v_exp_f32 v213, v213
    v_mfma_f32_16x16x32_bf16 v[168:171], v[112:115], a[236:239], v[168:171]
    v_exp_f32 v214, v214
    v_mfma_f32_16x16x32_bf16 v[172:175], v[116:119], a[236:239], v[172:175]
    v_exp_f32 v215, v215
    v_exp_f32 v216, v216
    v_exp_f32 v217, v217
    v_smfmac_f32_32x32x32_bf16 a[200:215], a[172:175], v[208:215], v13
    s_waitcnt lgkmcnt(0)
    buffer_load_dwordx4 v[80:83], v1, s[20:23], s30 offen offset:2048 sc1
    v_exp_f32 v218, v218
    v_exp_f32 v219, v219
    v_exp_f32 v220, v220
    v_mfma_f32_32x32x4_2b_bf16 v[184:215], a[192:193], a[244:245], 0
    v_exp_f32 v221, v221
    v_exp_f32 v222, v222
    v_exp_f32 v223, v223
    v_exp_f32 v224, v224
    v_exp_f32 v225, v225
    v_exp_f32 v226, v226
    v_exp_f32 v227, v227
    v_exp_f32 v228, v228
    v_smfmac_f32_32x32x32_bf16 a[200:215], a[176:179], v[216:223], v13
    s_add_u32 s48, s48, s44
    buffer_load_dwordx4 v[84:87], v1, s[20:23], s30 offen offset:3072 sc1
    v_exp_f32 v229, v229
    v_exp_f32 v230, v230
    v_exp_f32 v231, v231
    v_mfma_f32_16x16x32_bf16 v[176:179], v[120:123], a[236:239], v[176:179]
    v_exp_f32 v232, v232
    v_mfma_f32_16x16x32_bf16 v[180:183], v[124:127], a[236:239], v[180:183]
    v_exp_f32 v233, v233
    v_smfmac_f32_32x32x32_bf16 a[200:215], a[180:183], v[224:231], v13
    s_cmp_eq_u32 s55, 17
    s_cselect_b32 s44, s58, 0
    v_exp_f32 v234, v234
    v_exp_f32 v235, v235
    v_exp_f32 v236, v236
    v_mfma_f32_32x32x16_bf16 v[184:199], a[0:3], a[240:243], v[184:199]
    s_add_u32 s30, s27, 45056
    buffer_load_dwordx4 v[88:91], v1, s[20:23], s30 offen offset:0 sc1
    v_exp_f32 v237, v237
    v_exp_f32 v238, v238
    v_exp_f32 v239, v239
    v_mfma_f32_32x32x16_bf16 v[200:215], a[4:7], a[240:243], v[200:215]
    v_exp_f32 v240, v240
    v_exp_f32 v241, v241
    v_exp_f32 v242, v242
    v_smfmac_f32_32x32x32_bf16 a[200:215], a[184:187], v[232:239], v13
    s_add_u32 s48, s48, s44
    s_add_u32 s48, s48, s59
    v_exp_f32 v243, v243
    v_exp_f32 v244, v244
    v_exp_f32 v245, v245
    v_exp_f32 v246, v246
    v_exp_f32 v247, v247
KM_it3:
    v_exp_f32 v184, v184
    v_exp_f32 v185, v185
    v_smfmac_f32_32x32x32_bf16 a[200:215], a[188:191], v[240:247], v13
    buffer_load_dwordx4 v[92:95], v1, s[20:23], s30 offen offset:1024 sc1
    v_exp_f32 v186, v186
    v_exp_f32 v187, v187
    v_exp_f32 v188, v188
    v_mfma_f32_32x32x4_2b_bf16 v[216:247], a[192:193], a[246:247], 0
    v_exp_f32 v189, v189
    v_exp_f32 v190, v190
    v_exp_f32 v191, v191
    v_exp_f32 v192, v192
    v_exp_f32 v193, v193
    v_exp_f32 v194, v194
    v_exp_f32 v195, v195
    v_exp_f32 v196, v196
    v_smfmac_f32_32x32x32_bf16 a[216:231], a[64:67], v[184:191], v13
    buffer_load_dwordx4 v[96:99], v1, s[20:23], s30 offen offset:2048 sc1
    v_exp_f32 v197, v197
    v_exp_f32 v198, v198
    v_exp_f32 v199, v199
    v_exp_f32 v200, v200
    v_exp_f32 v201, v201
    v_smfmac_f32_32x32x32_bf16 a[216:231], a[68:71], v[192:199], v13
    ds_write_b128 v5, a[200:203] offset:0
    v_exp_f32 v202, v202
    v_exp_f32 v203, v203
    v_exp_f32 v204, v204
    v_mfma_f32_32x32x16_bf16 v[216:231], a[8:11], a[240:243], v[216:231]
    buffer_load_dwordx4 v[100:103], v1, s[20:23], s30 offen offset:3072 sc1
    ds_write_b128 v5, a[204:207] offset:1024
    v_exp_f32 v205, v205
    v_exp_f32 v206, v206
    v_exp_f32 v207, v207
    v_mfma_f32_32x32x16_bf16 v[232:247], a[12:15], a[240:243], v[232:247]
    ds_write_b128 v5, a[208:211] offset:2048
    v_exp_f32 v208, v208
    v_exp_f32 v209, v209
    v_exp_f32 v210, v210
    v_smfmac_f32_32x32x32_bf16 a[216:231], a[72:75], v[200:207], v13
    s_add_u32 s30, s27, 49152
    buffer_load_dwordx4 v[104:107], v1, s[20:23], s30 offen offset:0 sc1
    v_exp_f32 v211, v211
    v_exp_f32 v212, v212
    v_exp_f32 v213, v213
    v_exp_f32 v214, v214
    v_exp_f32 v215, v215
    v_exp_f32 v216, v216
    v_exp_f32 v217, v217
    v_smfmac_f32_32x32x32_bf16 a[216:231], a[76:79], v[208:215], v13
    buffer_load_dwordx4 v[108:111], v1, s[20:23], s30 offen offset:1024 sc1
    v_exp_f32 v218, v218
    v_exp_f32 v219, v219
    v_exp_f32 v220, v220
    v_mfma_f32_32x32x4_2b_bf16 v[184:215], a[194:195], a[244:245], 0
    v_exp_f32 v221, v221
    v_exp_f32 v222, v222
    v_exp_f32 v223, v223
    v_exp_f32 v224, v224
    v_exp_f32 v225, v225
    v_exp_f32 v226, v226
    v_exp_f32 v227, v227
    v_exp_f32 v228, v228
    v_smfmac_f32_32x32x32_bf16 a[216:231], a[80:83], v[216:223], v13
    s_waitcnt lgkmcnt(0)
    s_barrier
    buffer_load_dwordx4 v[112:115], v1, s[20:23], s30 offen offset:2048 sc1
    v_exp_f32 v229, v229
    v_exp_f32 v230, v230
    v_exp_f32 v231, v231
    v_exp_f32 v232, v232
    v_exp_f32 v233, v233
    v_smfmac_f32_32x32x32_bf16 a[216:231], a[84:87], v[224:231], v13
    ds_read_b128 v[36:39], v6 offset:0
    ds_read_b128 v[40:43], v6 offset:3072
    v_exp_f32 v234, v234
    v_exp_f32 v235, v235
    v_exp_f32 v236, v236
    v_mfma_f32_32x32x16_bf16 v[184:199], a[16:19], a[240:243], v[184:199]
    buffer_load_dwordx4 v[116:119], v1, s[20:23], s30 offen offset:3072 sc1
    v_exp_f32 v237, v237
    v_exp_f32 v238, v238
    v_exp_f32 v239, v239
    v_mfma_f32_32x32x16_bf16 v[200:215], a[20:23], a[240:243], v[200:215]
    ds_read_b128 v[44:47], v6 offset:6144
    ds_read_b128 v[48:51], v6 offset:9216
    v_exp_f32 v240, v240
    v_exp_f32 v241, v241
    v_exp_f32 v242, v242
    v_smfmac_f32_32x32x32_bf16 a[216:231], a[88:91], v[232:239], v13
    s_add_u32 s30, s27, 53248
    buffer_load_dwordx4 v[120:123], v1, s[20:23], s30 offen offset:0 sc1
    v_exp_f32 v243, v243
    v_exp_f32 v244, v244
    v_exp_f32 v245, v245
    v_exp_f32 v246, v246
    v_exp_f32 v247, v247
    v_exp_f32 v184, v184
    v_exp_f32 v185, v185
    v_smfmac_f32_32x32x32_bf16 a[216:231], a[92:95], v[240:247], v13
    s_waitcnt lgkmcnt(0)
    buffer_load_dwordx4 v[124:127], v1, s[20:23], s30 offen offset:1024 sc1
    v_add_f32 v38, v38, v42
    v_add_f32 v36, v36, v40
    v_add_f32 v37, v37, v41
    v_add_f32 v39, v39, v43
    v_add_f32 v46, v46, v50
    v_add_f32 v44, v44, v48
    v_add_f32 v45, v45, v49
    v_add_f32 v47, v47, v51
    v_add_f32 v38, v38, v46
    v_exp_f32 v186, v186
    v_exp_f32 v187, v187
    v_exp_f32 v188, v188
    v_mfma_f32_32x32x4_2b_bf16 v[216:247], a[194:195], a[246:247], 0
    ds_bpermute_b32 v52, v7, v38
    v_add_f32 v36, v36, v44
    v_add_f32 v37, v37, v45
    v_add_f32 v39, v39, v47
    v_exp_f32 v189, v189
    v_exp_f32 v190, v190
    v_exp_f32 v191, v191
    v_exp_f32 v192, v192
    v_exp_f32 v193, v193
    v_exp_f32 v194, v194
    v_exp_f32 v195, v195
    v_exp_f32 v196, v196
    v_smfmac_f32_32x32x32_bf16 a[216:231], a[96:99], v[184:191], v13
    s_add_u32 m0, s49, 4096
    s_nop 0
    buffer_load_dwordx4 v16, s[12:15], s48 offen lds
    v_exp_f32 v197, v197
    v_exp_f32 v198, v198
    v_exp_f32 v199, v199
    v_exp_f32 v200, v200
    v_exp_f32 v201, v201
    v_smfmac_f32_32x32x32_bf16 a[216:231], a[100:103], v[192:199], v13
    s_waitcnt lgkmcnt(0)
    v_rcp_f32 v54, v52
    v_exp_f32 v202, v202
    v_mul_f32 v36, v36, v54
    v_mul_f32 v37, v37, v54
    v_mul_f32 v38, v38, v54
    v_mul_f32 v39, v39, v54
    v_max3_f32 v14, v14, v52, v54
    v_cvt_pk_bf16_f32 v36, v36, v37
    v_cvt_pk_bf16_f32 v37, v38, v39
    v_exp_f32 v203, v203
    v_exp_f32 v204, v204
    v_mfma_f32_32x32x16_bf16 v[216:231], a[24:27], a[240:243], v[216:231]
    s_add_u32 m0, s49, 5120
    s_nop 0
    buffer_load_dwordx4 v17, s[12:15], s48 offen lds
    v_exp_f32 v205, v205
    v_exp_f32 v206, v206
    v_exp_f32 v207, v207
    v_mfma_f32_32x32x16_bf16 v[232:247], a[28:31], a[240:243], v[232:247]
    ds_write_b32 v8, v36 offset:5120
    ds_write_b32 v9, v37 offset:5120
    v_exp_f32 v208, v208
    v_exp_f32 v209, v209
    v_exp_f32 v210, v210
    v_smfmac_f32_32x32x32_bf16 a[216:231], a[104:107], v[200:207], v13
    s_add_u32 m0, s49, 6144
    s_nop 0
    buffer_load_dwordx4 v18, s[12:15], s48 offen lds
    v_exp_f32 v211, v211
    v_exp_f32 v212, v212
    v_exp_f32 v213, v213
    v_mfma_f32_32x32x8_bf16 a[200:215], a[248:249], a[248:249], 0
    v_exp_f32 v214, v214
    v_exp_f32 v215, v215
    v_exp_f32 v216, v216
    v_exp_f32 v217, v217
    v_smfmac_f32_32x32x32_bf16 a[216:231], a[108:111], v[208:215], v13
    s_waitcnt lgkmcnt(0)
    s_barrier
    v_exp_f32 v218, v218
    v_exp_f32 v219, v219
    v_exp_f32 v220, v220
    v_mfma_f32_32x32x4_2b_bf16 v[184:215], a[196:197], a[244:245], 0
    v_exp_f32 v221, v221
    v_exp_f32 v222, v222
    v_exp_f32 v223, v223
    v_exp_f32 v224, v224
    v_exp_f32 v225, v225
    v_exp_f32 v226, v226
    v_exp_f32 v227, v227
    v_exp_f32 v228, v228
    v_smfmac_f32_32x32x32_bf16 a[216:231], a[112:115], v[216:223], v13
    ds_read_b128 a[232:235], v12 offset:5120
    ds_read_b128 a[236:239], v12 offset:6144
    v_exp_f32 v229, v229
    v_exp_f32 v230, v230
    v_exp_f32 v231, v231
    v_exp_f32 v232, v232
    v_exp_f32 v233, v233
    v_smfmac_f32_32x32x32_bf16 a[216:231], a[116:119], v[224:231], v13
    v_exp_f32 v234, v234
    v_exp_f32 v235, v235
    v_exp_f32 v236, v236
    v_mfma_f32_32x32x16_bf16 v[184:199], a[32:35], a[240:243], v[184:199]
    v_exp_f32 v237, v237
    v_exp_f32 v238, v238
    v_exp_f32 v239, v239
    v_mfma_f32_32x32x16_bf16 v[200:215], a[36:39], a[240:243], v[200:215]
    v_exp_f32 v240, v240
    v_exp_f32 v241, v241
    v_exp_f32 v242, v242
    v_smfmac_f32_32x32x32_bf16 a[216:231], a[120:123], v[232:239], v13
    v_exp_f32 v243, v243
    v_exp_f32 v244, v244
    v_exp_f32 v245, v245
    v_exp_f32 v246, v246
    v_exp_f32 v247, v247
    v_exp_f32 v184, v184
    v_exp_f32 v185, v185
    v_smfmac_f32_32x32x32_bf16 a[216:231], a[124:127], v[240:247], v13
    v_exp_f32 v186, v186
    v_exp_f32 v187, v187
    v_exp_f32 v188, v188
    v_mfma_f32_32x32x4_2b_bf16 v[216:247], a[196:197], a[246:247], 0
    v_exp_f32 v189, v189
    v_exp_f32 v190, v190
    v_exp_f32 v191, v191
    v_exp_f32 v192, v192
    v_exp_f32 v193, v193
    v_exp_f32 v194, v194
    v_exp_f32 v195, v195
    v_exp_f32 v196, v196
    v_smfmac_f32_32x32x32_bf16 a[216:231], a[128:131], v[184:191], v13
    s_waitcnt vmcnt(12) lgkmcnt(0)
    ds_read_b64_tr_b16 v[24:25], v19 offset:0
    ds_read_b64_tr_b16 v[26:27], v19 offset:384
    ds_read_b64_tr_b16 v[28:29], v19 offset:32
    v_exp_f32 v197, v197
    v_exp_f32 v198, v198
    v_exp_f32 v199, v199
    v_mfma_f32_16x16x32_bf16 v[148:151], v[56:59], a[232:235], v[148:151]
    v_exp_f32 v200, v200
    v_mfma_f32_16x16x32_bf16 v[152:155], v[60:63], a[232:235], v[152:155]
    v_exp_f32 v201, v201
    v_smfmac_f32_32x32x32_bf16 a[216:231], a[132:135], v[192:199], v13
    ds_read_b64_tr_b16 v[30:31], v19 offset:416
    ds_read_b64_tr_b16 v[32:33], v19 offset:64
    ds_read_b64_tr_b16 v[34:35], v19 offset:448
    v_exp_f32 v202, v202
    v_exp_f32 v203, v203
    v_exp_f32 v204, v204
    v_mfma_f32_32x32x16_bf16 v[216:231], a[40:43], a[240:243], v[216:231]
    v_exp_f32 v205, v205
    v_exp_f32 v206, v206
    v_exp_f32 v207, v207
    v_mfma_f32_32x32x16_bf16 v[232:247], a[44:47], a[240:243], v[232:247]
    v_exp_f32 v208, v208
    v_exp_f32 v209, v209
    v_exp_f32 v210, v210
    v_smfmac_f32_32x32x32_bf16 a[216:231], a[136:139], v[200:207], v13
    s_waitcnt lgkmcnt(0)
    s_add_u32 s50, s50, 1024
    buffer_store_dwordx4 v[24:27], v1, s[16:19], s50 offen sc1
    v_exp_f32 v211, v211
    v_exp_f32 v212, v212
    v_exp_f32 v213, v213
    v_mfma_f32_16x16x32_bf16 v[156:159], v[64:67], a[232:235], v[156:159]
    v_exp_f32 v214, v214
    v_mfma_f32_16x16x32_bf16 v[160:163], v[68:71], a[232:235], v[160:163]
    v_exp_f32 v215, v215
    v_mfma_f32_16x16x32_bf16 v[164:167], v[72:75], a[232:235], v[164:167]
    v_exp_f32 v216, v216
    v_mfma_f32_16x16x32_bf16 v[168:171], v[76:79], a[232:235], v[168:171]
    v_exp_f32 v217, v217
    v_smfmac_f32_32x32x32_bf16 a[216:231], a[140:143], v[208:215], v13
    s_add_u32 s46, s50, s51
    buffer_store_dwordx4 v[28:31], v1, s[16:19], s46 offen sc1
    v_exp_f32 v218, v218
    v_exp_f32 v219, v219
    v_exp_f32 v220, v220
    v_mfma_f32_32x32x4_2b_bf16 v[184:215], a[198:199], a[244:245], 0
    v_exp_f32 v221, v221
    v_exp_f32 v222, v222
    v_exp_f32 v223, v223
    v_exp_f32 v224, v224
    v_exp_f32 v225, v225
    v_exp_f32 v226, v226
    v_exp_f32 v227, v227
    v_exp_f32 v228, v228
    v_smfmac_f32_32x32x32_bf16 a[216:231], a[144:147], v[216:223], v13
    s_add_u32 s46, s46, s51
    buffer_store_dwordx4 v[32:35], v1, s[16:19], s46 offen sc1
    v_exp_f32 v229, v229
    v_exp_f32 v230, v230
    v_exp_f32 v231, v231
    v_mfma_f32_16x16x32_bf16 v[172:175], v[80:83], a[232:235], v[172:175]
    v_exp_f32 v232, v232
    v_mfma_f32_16x16x32_bf16 v[176:179], v[84:87], a[232:235], v[176:179]
    v_exp_f32 v233, v233
    v_smfmac_f32_32x32x32_bf16 a[216:231], a[148:151], v[224:231], v13
    v_exp_f32 v234, v234
    v_exp_f32 v235, v235
    v_exp_f32 v236, v236
    v_mfma_f32_32x32x16_bf16 v[184:199], a[48:51], a[240:243], v[184:199]
    buffer_load_dwordx4 v[56:59], v1, s[20:23], s30 offen offset:2048 sc1
    v_exp_f32 v237, v237
    v_exp_f32 v238, v238
    v_exp_f32 v239, v239
    v_mfma_f32_32x32x16_bf16 v[200:215], a[52:55], a[240:243], v[200:215]
    v_exp_f32 v240, v240
    v_exp_f32 v241, v241
    v_exp_f32 v242, v242
    v_smfmac_f32_32x32x32_bf16 a[216:231], a[152:155], v[232:239], v13
    s_waitcnt vmcnt(7)
    buffer_load_dwordx4 v[60:63], v1, s[20:23], s30 offen offset:3072 sc1
    v_exp_f32 v243, v243
    v_exp_f32 v244, v244
    v_exp_f32 v245, v245
    v_mfma_f32_16x16x32_bf16 v[180:183], v[88:91], a[232:235], v[180:183]
    v_exp_f32 v246, v246
    v_mfma_f32_16x16x32_bf16 v[148:151], v[92:95], a[236:239], v[148:151]
    v_exp_f32 v247, v247
    v_mfma_f32_16x16x32_bf16 v[152:155], v[96:99], a[236:239], v[152:155]
    v_exp_f32 v184, v184
    v_mfma_f32_16x16x32_bf16 v[156:159], v[100:103], a[236:239], v[156:159]
    v_exp_f32 v185, v185
    v_smfmac_f32_32x32x32_bf16 a[216:231], a[156:159], v[240:247], v13
    s_add_u32 s30, s27, 57344
    buffer_load_dwordx4 v[64:67], v1, s[20:23], s30 offen offset:0 sc1
    v_exp_f32 v186, v186
    v_exp_f32 v187, v187
    v_exp_f32 v188, v188
    v_mfma_f32_32x32x4_2b_bf16 v[216:247], a[198:199], a[246:247], 0
    v_exp_f32 v189, v189
    v_exp_f32 v190, v190
    v_exp_f32 v191, v191
    v_exp_f32 v192, v192
    v_exp_f32 v193, v193
    v_exp_f32 v194, v194
    v_exp_f32 v195, v195
    v_exp_f32 v196, v196
    v_smfmac_f32_32x32x32_bf16 a[216:231], a[160:163], v[184:191], v13
    s_add_u32 s55, s55, 1
    buffer_load_dwordx4 v[68:71], v1, s[20:23], s30 offen offset:1024 sc1
    v_exp_f32 v197, v197
    v_exp_f32 v198, v198
    v_exp_f32 v199, v199
    v_mfma_f32_16x16x32_bf16 v[160:163], v[104:107], a[236:239], v[160:163]
    v_exp_f32 v200, v200
    v_mfma_f32_16x16x32_bf16 v[164:167], v[108:111], a[236:239], v[164:167]
    v_exp_f32 v201, v201
    v_smfmac_f32_32x32x32_bf16 a[216:231], a[164:167], v[192:199], v13
    s_mul_i32 s48, s55, s56
    s_lshr_b32 s44, s55, 2
    ds_read_b32 a244, v4 offset:4608
    ds_read_b32 a247, v4 offset:4608
    v_exp_f32 v202, v202
    v_exp_f32 v203, v203
    v_exp_f32 v204, v204
    v_mfma_f32_32x32x16_bf16 v[216:231], a[56:59], a[240:243], v[216:231]
    buffer_load_dwordx4 v[72:75], v1, s[20:23], s30 offen offset:2048 sc1
    v_exp_f32 v205, v205
    v_exp_f32 v206, v206
    v_exp_f32 v207, v207
    v_mfma_f32_32x32x16_bf16 v[232:247], a[60:63], a[240:243], v[232:247]
    ds_read2_b32 a[240:241], v3 offset1:16
    ds_read2_b32 a[242:243], v146 offset1:16
    v_exp_f32 v208, v208
    v_add_u32 v3, 1152, v3
    v_add_u32 v146, 1152, v146
    v_exp_f32 v209, v209
    v_exp_f32 v210, v210
    v_smfmac_f32_32x32x32_bf16 a[216:231], a[168:171], v[200:207], v13
    s_mul_i32 s44, s44, s57
    buffer_load_dwordx4 v[76:79], v1, s[20:23], s30 offen offset:3072 sc1
    v_exp_f32 v211, v211
    v_exp_f32 v212, v212
    v_exp_f32 v213, v213
    v_mfma_f32_16x16x32_bf16 v[168:171], v[112:115], a[236:239], v[168:171]
    v_exp_f32 v214, v214
    v_mfma_f32_16x16x32_bf16 v[172:175], v[116:119], a[236:239], v[172:175]
    v_exp_f32 v215, v215
    v_exp_f32 v216, v216
    v_exp_f32 v217, v217
    v_smfmac_f32_32x32x32_bf16 a[216:231], a[172:175], v[208:215], v13
    s_waitcnt lgkmcnt(0)
    s_add_u32 s30, s27, 61440
    buffer_load_dwordx4 v[80:83], v1, s[20:23], s30 offen offset:0 sc1
    v_exp_f32 v218, v218
    v_exp_f32 v219, v219
    v_exp_f32 v220, v220
    v_mfma_f32_32x32x4_2b_bf16 v[184:215], a[192:193], a[244:245], 0
    v_exp_f32 v221, v221
    v_exp_f32 v222, v222
    v_exp_f32 v223, v223
    v_exp_f32 v224, v224
    v_exp_f32 v225, v225
    v_exp_f32 v226, v226
    v_exp_f32 v227, v227
    v_exp_f32 v228, v228
    v_smfmac_f32_32x32x32_bf16 a[216:231], a[176:179], v[216:223], v13
    s_add_u32 s48, s48, s44
    buffer_load_dwordx4 v[84:87], v1, s[20:23], s30 offen offset:1024 sc1
    v_exp_f32 v229, v229
    v_exp_f32 v230, v230
    v_exp_f32 v231, v231
    v_mfma_f32_16x16x32_bf16 v[176:179], v[120:123], a[236:239], v[176:179]
    v_exp_f32 v232, v232
    v_mfma_f32_16x16x32_bf16 v[180:183], v[124:127], a[236:239], v[180:183]
    v_exp_f32 v233, v233
    v_smfmac_f32_32x32x32_bf16 a[216:231], a[180:183], v[224:231], v13
    s_cmp_eq_u32 s55, 17
    s_cselect_b32 s44, s58, 0
    v_exp_f32 v234, v234
    v_exp_f32 v235, v235
    v_exp_f32 v236, v236
    v_mfma_f32_32x32x16_bf16 v[184:199], a[0:3], a[240:243], v[184:199]
    buffer_load_dwordx4 v[88:91], v1, s[20:23], s30 offen offset:2048 sc1
    v_exp_f32 v237, v237
    v_exp_f32 v238, v238
    v_exp_f32 v239, v239
    v_mfma_f32_32x32x16_bf16 v[200:215], a[4:7], a[240:243], v[200:215]
    s_branch KO_4
KP_4:
    s_branch KP_8
KO_4:
    v_exp_f32 v240, v240
    v_exp_f32 v241, v241
    v_exp_f32 v242, v242
    v_smfmac_f32_32x32x32_bf16 a[216:231], a[184:187], v[232:239], v13
    s_add_u32 s48, s48, s44
    s_add_u32 s48, s48, s59
    v_exp_f32 v243, v243
    v_exp_f32 v244, v244
    v_exp_f32 v245, v245
    v_exp_f32 v246, v246
    v_exp_f32 v247, v247
KM_it4:
    v_exp_f32 v184, v184
    v_exp_f32 v185, v185
    v_smfmac_f32_32x32x32_bf16 a[216:231], a[188:191], v[240:247], v13
    buffer_load_dwordx4 v[92:95], v1, s[20:23], s30 offen offset:3072 sc1
    v_exp_f32 v186, v186
    v_exp_f32 v187, v187
    v_exp_f32 v188, v188
    v_mfma_f32_32x32x4_2b_bf16 v[216:247], a[192:193], a[246:247], 0
    v_exp_f32 v189, v189
    v_exp_f32 v190, v190
    v_exp_f32 v191, v191
    v_exp_f32 v192, v192
    v_exp_f32 v193, v193
    v_exp_f32 v194, v194
    v_exp_f32 v195, v195
    v_exp_f32 v196, v196
    v_smfmac_f32_32x32x32_bf16 a[200:215], a[64:67], v[184:191], v13
    s_add_u32 s30, s27, 65536
    buffer_load_dwordx4 v[96:99], v1, s[20:23], s30 offen offset:0 sc1
    v_exp_f32 v197, v197
    v_exp_f32 v198, v198
    v_exp_f32 v199, v199
    v_exp_f32 v200, v200
    v_exp_f32 v201, v201
    v_smfmac_f32_32x32x32_bf16 a[200:215], a[68:71], v[192:199], v13
    ds_write_b128 v5, a[216:219] offset:0
    v_exp_f32 v202, v202
    v_exp_f32 v203, v203
    v_exp_f32 v204, v204
    v_mfma_f32_32x32x16_bf16 v[216:231], a[8:11], a[240:243], v[216:231]
    buffer_load_dwordx4 v[100:103], v1, s[20:23], s30 offen offset:1024 sc1
    ds_write_b128 v5, a[220:223] offset:1024
    v_exp_f32 v205, v205
    v_exp_f32 v206, v206
    v_exp_f32 v207, v207
    v_mfma_f32_32x32x16_bf16 v[232:247], a[12:15], a[240:243], v[232:247]
    ds_write_b128 v5, a[224:227] offset:2048
    v_exp_f32 v208, v208
    v_exp_f32 v209, v209
    v_exp_f32 v210, v210
    v_smfmac_f32_32x32x32_bf16 a[200:215], a[72:75], v[200:207], v13
    buffer_load_dwordx4 v[104:107], v1, s[20:23], s30 offen offset:2048 sc1
    v_exp_f32 v211, v211
    v_exp_f32 v212, v212
    v_exp_f32 v213, v213
    v_exp_f32 v214, v214
    v_exp_f32 v215, v215
    v_exp_f32 v216, v216
    v_exp_f32 v217, v217
    v_smfmac_f32_32x32x32_bf16 a[200:215], a[76:79], v[208:215], v13
    buffer_load_dwordx4 v[108:111], v1, s[20:23], s30 offen offset:3072 sc1
    v_exp_f32 v218, v218
    v_exp_f32 v219, v219
    v_exp_f32 v220, v220
    v_mfma_f32_32x32x4_2b_bf16 v[184:215], a[194:195], a[244:245], 0
    v_exp_f32 v221, v221
    v_exp_f32 v222, v222
    v_exp_f32 v223, v223
    v_exp_f32 v224, v224
    v_exp_f32 v225, v225
    v_exp_f32 v226, v226
    v_exp_f32 v227, v227
    v_exp_f32 v228, v228
    v_smfmac_f32_32x32x32_bf16 a[200:215], a[80:83], v[216:223], v13
    s_waitcnt lgkmcnt(0)
    s_barrier
    s_add_u32 s30, s27, 69632
    buffer_load_dwordx4 v[112:115], v1, s[20:23], s30 offen offset:0 sc1
    v_exp_f32 v229, v229
    v_exp_f32 v230, v230
    v_exp_f32 v231, v231
    v_exp_f32 v232, v232
    v_exp_f32 v233, v233
    v_smfmac_f32_32x32x32_bf16 a[200:215], a[84:87], v[224:231], v13
    ds_read_b128 v[36:39], v6 offset:0
    ds_read_b128 v[40:43], v6 offset:3072
    v_exp_f32 v234, v234
    v_exp_f32 v235, v235
    v_exp_f32 v236, v236
    v_mfma_f32_32x32x16_bf16 v[184:199], a[16:19], a[240:243], v[184:199]
    buffer_load_dwordx4 v[116:119], v1, s[20:23], s30 offen offset:1024 sc1
    v_exp_f32 v237, v237
    v_exp_f32 v238, v238
    v_exp_f32 v239, v239
    v_mfma_f32_32x32x16_bf16 v[200:215], a[20:23], a[240:243], v[200:215]
    ds_read_b128 v[44:47], v6 offset:6144
    ds_read_b128 v[48:51], v6 offset:9216
    v_exp_f32 v240, v240
    v_exp_f32 v241, v241
    v_exp_f32 v242, v242
    v_smfmac_f32_32x32x32_bf16 a[200:215], a[88:91], v[232:239], v13
    buffer_load_dwordx4 v[120:123], v1, s[20:23], s30 offen offset:2048 sc1
    v_exp_f32 v243, v243
    v_exp_f32 v244, v244
    v_exp_f32 v245, v245
    v_exp_f32 v246, v246
    v_exp_f32 v247, v247
    v_exp_f32 v184, v184
    v_exp_f32 v185, v185
    v_smfmac_f32_32x32x32_bf16 a[200:215], a[92:95], v[240:247], v13
    s_waitcnt lgkmcnt(0)
    buffer_load_dwordx4 v[124:127], v1, s[20:23], s30 offen offset:3072 sc1
    v_add_f32 v38, v38, v42
    v_add_f32 v36, v36, v40
    v_add_f32 v37, v37, v41
    v_add_f32 v39, v39, v43
    v_add_f32 v46, v46, v50
    v_add_f32 v44, v44, v48
    v_add_f32 v45, v45, v49
    v_add_f32 v47, v47, v51
    v_add_f32 v38, v38, v46
    v_exp_f32 v186, v186
    v_exp_f32 v187, v187
    v_exp_f32 v188, v188
    v_mfma_f32_32x32x4_2b_bf16 v[216:247], a[194:195], a[246:247], 0
    ds_bpermute_b32 v52, v7, v38
    v_add_f32 v36, v36, v44
    v_add_f32 v37, v37, v45
    v_add_f32 v39, v39, v47
    v_exp_f32 v189, v189
    v_exp_f32 v190, v190
    v_exp_f32 v191, v191
    v_exp_f32 v192, v192
    v_exp_f32 v193, v193
    v_exp_f32 v194, v194
    v_exp_f32 v195, v195
    v_exp_f32 v196, v196
    v_smfmac_f32_32x32x32_bf16 a[200:215], a[96:99], v[184:191], v13
    s_add_u32 m0, s49, 0
    s_nop 0
    buffer_load_dwordx4 v248, s[12:15], s48 offen lds
    v_exp_f32 v197, v197
    v_exp_f32 v198, v198
    v_exp_f32 v199, v199
    v_exp_f32 v200, v200
    v_exp_f32 v201, v201
    v_smfmac_f32_32x32x32_bf16 a[200:215], a[100:103], v[192:199], v13
    s_waitcnt lgkmcnt(0)
    v_rcp_f32 v54, v52
    v_exp_f32 v202, v202
    v_mul_f32 v36, v36, v54
    v_mul_f32 v37, v37, v54
    v_mul_f32 v38, v38, v54
    v_mul_f32 v39, v39, v54
    v_max3_f32 v14, v14, v52, v54
    v_cvt_pk_bf16_f32 v36, v36, v37
    v_cvt_pk_bf16_f32 v37, v38, v39
    v_exp_f32 v203, v203
    v_exp_f32 v204, v204
    v_mfma_f32_32x32x16_bf16 v[216:231], a[24:27], a[240:243], v[216:231]
    s_add_u32 m0, s49, 1024
    s_nop 0
    buffer_load_dwordx4 v249, s[12:15], s48 offen lds
    v_exp_f32 v205, v205
    v_exp_f32 v206, v206
    v_exp_f32 v207, v207
    v_mfma_f32_32x32x16_bf16 v[232:247], a[28:31], a[240:243], v[232:247]
    ds_write_b32 v8, v36 offset:7680
    ds_write_b32 v9, v37 offset:7680
    v_exp_f32 v208, v208
    v_exp_f32 v209, v209
    v_exp_f32 v210, v210
    v_smfmac_f32_32x32x32_bf16 a[200:215], a[104:107], v[200:207], v13
    s_add_u32 m0, s49, 2048
    s_nop 0
    buffer_load_dwordx4 v250, s[12:15], s48 offen lds
    v_exp_f32 v211, v211
    v_exp_f32 v212, v212
    v_exp_f32 v213, v213
    v_mfma_f32_32x32x8_bf16 a[216:231], a[248:249], a[248:249], 0
    v_exp_f32 v214, v214
    v_exp_f32 v215, v215
    v_exp_f32 v216, v216
    v_exp_f32 v217, v217
    v_smfmac_f32_32x32x32_bf16 a[200:215], a[108:111], v[208:215], v13
    s_waitcnt lgkmcnt(0)
    s_barrier
    v_exp_f32 v218, v218
    v_exp_f32 v219, v219
    v_exp_f32 v220, v220
    v_mfma_f32_32x32x4_2b_bf16 v[184:215], a[196:197], a[244:245], 0
    v_exp_f32 v221, v221
    v_exp_f32 v222, v222
    v_exp_f32 v223, v223
    v_exp_f32 v224, v224
    v_exp_f32 v225, v225
    v_exp_f32 v226, v226
    v_exp_f32 v227, v227
    v_exp_f32 v228, v228
    v_smfmac_f32_32x32x32_bf16 a[200:215], a[112:115], v[216:223], v13
    ds_read_b128 a[232:235], v12 offset:7680
    ds_read_b128 a[236:239], v12 offset:8704
    v_exp_f32 v229, v229
    v_exp_f32 v230, v230
    v_exp_f32 v231, v231
    v_exp_f32 v232, v232
    v_exp_f32 v233, v233
    v_smfmac_f32_32x32x32_bf16 a[200:215], a[116:119], v[224:231], v13
    v_exp_f32 v234, v234
    v_exp_f32 v235, v235
    v_exp_f32 v236, v236
    v_mfma_f32_32x32x16_bf16 v[184:199], a[32:35], a[240:243], v[184:199]
    v_exp_f32 v237, v237
    v_exp_f32 v238, v238
    v_exp_f32 v239, v239
    v_mfma_f32_32x32x16_bf16 v[200:215], a[36:39], a[240:243], v[200:215]
    v_exp_f32 v240, v240
    v_exp_f32 v241, v241
    v_exp_f32 v242, v242
    v_smfmac_f32_32x32x32_bf16 a[200:215], a[120:123], v[232:239], v13
    v_exp_f32 v243, v243
    v_exp_f32 v244, v244
    v_exp_f32 v245, v245
    v_exp_f32 v246, v246
    v_exp_f32 v247, v247
    v_exp_f32 v184, v184
    v_exp_f32 v185, v185
    v_smfmac_f32_32x32x32_bf16 a[200:215], a[124:127], v[240:247], v13
    v_exp_f32 v186, v186
    v_exp_f32 v187, v187
    v_exp_f32 v188, v188
    v_mfma_f32_32x32x4_2b_bf16 v[216:247], a[196:197], a[246:247], 0
    v_exp_f32 v189, v189
    v_exp_f32 v190, v190
    v_exp_f32 v191, v191
    v_exp_f32 v192, v192
    v_exp_f32 v193, v193
    v_exp_f32 v194, v194
    v_exp_f32 v195, v195
    v_exp_f32 v196, v196
    v_smfmac_f32_32x32x32_bf16 a[200:215], a[128:131], v[184:191], v13
    s_waitcnt vmcnt(12) lgkmcnt(0)
    ds_read_b64_tr_b16 v[24:25], v19 offset:4096
    ds_read_b64_tr_b16 v[26:27], v19 offset:4480
    ds_read_b64_tr_b16 v[28:29], v19 offset:4128
    v_exp_f32 v197, v197
    v_exp_f32 v198, v198
    v_exp_f32 v199, v199
    v_mfma_f32_16x16x32_bf16 v[148:151], v[56:59], a[232:235], v[148:151]
    v_exp_f32 v200, v200
    v_mfma_f32_16x16x32_bf16 v[152:155], v[60:63], a[232:235], v[152:155]
    v_exp_f32 v201, v201
    v_smfmac_f32_32x32x32_bf16 a[200:215], a[132:135], v[192:199], v13
    ds_read_b64_tr_b16 v[30:31], v19 offset:4512
    ds_read_b64_tr_b16 v[32:33], v19 offset:4160
    ds_read_b64_tr_b16 v[34:35], v19 offset:4544
    v_exp_f32 v202, v202
    v_exp_f32 v203, v203
    v_exp_f32 v204, v204
    v_mfma_f32_32x32x16_bf16 v[216:231], a[40:43], a[240:243], v[216:231]
    s_add_u32 s50, s50, s47
    v_exp_f32 v205, v205
    v_exp_f32 v206, v206
    v_exp_f32 v207, v207
    v_mfma_f32_32x32x16_bf16 v[232:247], a[44:47], a[240:243], v[232:247]
    v_exp_f32 v208, v208
    v_exp_f32 v209, v209
    v_exp_f32 v210, v210
    v_smfmac_f32_32x32x32_bf16 a[200:215], a[136:139], v[200:207], v13
    s_waitcnt lgkmcnt(0)
    s_add_u32 s50, s50, 1024
    buffer_store_dwordx4 v[24:27], v1, s[16:19], s50 offen sc1
    v_exp_f32 v211, v211
    v_exp_f32 v212, v212
    v_exp_f32 v213, v213
    v_mfma_f32_16x16x32_bf16 v[156:159], v[64:67], a[232:235], v[156:159]
    v_exp_f32 v214, v214
    v_mfma_f32_16x16x32_bf16 v[160:163], v[68:71], a[232:235], v[160:163]
    v_exp_f32 v215, v215
    v_mfma_f32_16x16x32_bf16 v[164:167], v[72:75], a[232:235], v[164:167]
    v_exp_f32 v216, v216
    v_mfma_f32_16x16x32_bf16 v[168:171], v[76:79], a[232:235], v[168:171]
    v_exp_f32 v217, v217
    v_smfmac_f32_32x32x32_bf16 a[200:215], a[140:143], v[208:215], v13
    s_add_u32 s46, s50, s51
    buffer_store_dwordx4 v[28:31], v1, s[16:19], s46 offen sc1
    v_exp_f32 v218, v218
    v_exp_f32 v219, v219
    v_exp_f32 v220, v220
    v_mfma_f32_32x32x4_2b_bf16 v[184:215], a[198:199], a[244:245], 0
    v_exp_f32 v221, v221
    v_exp_f32 v222, v222
    v_exp_f32 v223, v223
    v_exp_f32 v224, v224
    v_exp_f32 v225, v225
    v_exp_f32 v226, v226
    v_exp_f32 v227, v227
    v_exp_f32 v228, v228
    v_smfmac_f32_32x32x32_bf16 a[200:215], a[144:147], v[216:223], v13
    s_add_u32 s46, s46, s51
    buffer_store_dwordx4 v[32:35], v1, s[16:19], s46 offen sc1
    v_exp_f32 v229, v229
    v_exp_f32 v230, v230
    v_exp_f32 v231, v231
    v_mfma_f32_16x16x32_bf16 v[172:175], v[80:83], a[232:235], v[172:175]
    v_exp_f32 v232, v232
    v_mfma_f32_16x16x32_bf16 v[176:179], v[84:87], a[232:235], v[176:179]
    v_exp_f32 v233, v233
    v_smfmac_f32_32x32x32_bf16 a[200:215], a[148:151], v[224:231], v13
    v_exp_f32 v234, v234
    v_exp_f32 v235, v235
    v_exp_f32 v236, v236
    v_mfma_f32_32x32x16_bf16 v[184:199], a[48:51], a[240:243], v[184:199]
    s_add_u32 s30, s27, 73728
    buffer_load_dwordx4 v[56:59], v1, s[20:23], s30 offen offset:0 sc1
    v_exp_f32 v237, v237
    v_exp_f32 v238, v238
    v_exp_f32 v239, v239
    v_mfma_f32_32x32x16_bf16 v[200:215], a[52:55], a[240:243], v[200:215]
    v_exp_f32 v240, v240
    v_exp_f32 v241, v241
    v_exp_f32 v242, v242
    v_smfmac_f32_32x32x32_bf16 a[200:215], a[152:155], v[232:239], v13
    s_waitcnt vmcnt(7)
    buffer_load_dwordx4 v[60:63], v1, s[20:23], s30 offen offset:1024 sc1
    v_exp_f32 v243, v243
    v_exp_f32 v244, v244
    v_exp_f32 v245, v245
    v_mfma_f32_16x16x32_bf16 v[180:183], v[88:91], a[232:235], v[180:183]
    v_exp_f32 v246, v246
    v_mfma_f32_16x16x32_bf16 v[148:151], v[92:95], a[236:239], v[148:151]
    v_exp_f32 v247, v247
    v_mfma_f32_16x16x32_bf16 v[152:155], v[96:99], a[236:239], v[152:155]
    v_exp_f32 v184, v184
    v_mfma_f32_16x16x32_bf16 v[156:159], v[100:103], a[236:239], v[156:159]
    v_exp_f32 v185, v185
    v_smfmac_f32_32x32x32_bf16 a[200:215], a[156:159], v[240:247], v13
    buffer_load_dwordx4 v[64:67], v1, s[20:23], s30 offen offset:2048 sc1
    v_exp_f32 v186, v186
    v_exp_f32 v187, v187
    v_exp_f32 v188, v188
    v_mfma_f32_32x32x4_2b_bf16 v[216:247], a[198:199], a[246:247], 0
    v_exp_f32 v189, v189
    v_exp_f32 v190, v190
    v_exp_f32 v191, v191
    v_exp_f32 v192, v192
    v_exp_f32 v193, v193
    v_exp_f32 v194, v194
    v_exp_f32 v195, v195
    v_exp_f32 v196, v196
    v_smfmac_f32_32x32x32_bf16 a[200:215], a[160:163], v[184:191], v13
    s_add_u32 s55, s55, 1
    buffer_load_dwordx4 v[68:71], v1, s[20:23], s30 offen offset:3072 sc1
    v_exp_f32 v197, v197
    v_exp_f32 v198, v198
    v_exp_f32 v199, v199
    v_mfma_f32_16x16x32_bf16 v[160:163], v[104:107], a[236:239], v[160:163]
    v_exp_f32 v200, v200
    v_mfma_f32_16x16x32_bf16 v[164:167], v[108:111], a[236:239], v[164:167]
    v_exp_f32 v201, v201
    v_smfmac_f32_32x32x32_bf16 a[200:215], a[164:167], v[192:199], v13
    s_mul_i32 s48, s55, s56
    s_lshr_b32 s44, s55, 2
    ds_read_b32 a244, v4 offset:5760
    ds_read_b32 a247, v4 offset:5760
    v_exp_f32 v202, v202
    v_exp_f32 v203, v203
    v_exp_f32 v204, v204
    v_mfma_f32_32x32x16_bf16 v[216:231], a[56:59], a[240:243], v[216:231]
    s_add_u32 s30, s27, 77824
    buffer_load_dwordx4 v[72:75], v1, s[20:23], s30 offen offset:0 sc1
    v_exp_f32 v205, v205
    v_exp_f32 v206, v206
    v_exp_f32 v207, v207
    v_mfma_f32_32x32x16_bf16 v[232:247], a[60:63], a[240:243], v[232:247]
    ds_read2_b32 a[240:241], v3 offset1:16
    ds_read2_b32 a[242:243], v146 offset1:16
    v_exp_f32 v208, v208
    v_add_u32 v3, 1152, v3
    v_add_u32 v146, 1152, v146
    v_exp_f32 v209, v209
    v_exp_f32 v210, v210
    v_smfmac_f32_32x32x32_bf16 a[200:215], a[168:171], v[200:207], v13
    s_mul_i32 s44, s44, s57
    buffer_load_dwordx4 v[76:79], v1, s[20:23], s30 offen offset:1024 sc1
    v_exp_f32 v211, v211
    v_exp_f32 v212, v212
    v_exp_f32 v213, v213
    v_mfma_f32_16x16x32_bf16 v[168:171], v[112:115], a[236:239], v[168:171]
    v_exp_f32 v214, v214
    v_mfma_f32_16x16x32_bf16 v[172:175], v[116:119], a[236:239], v[172:175]
    v_exp_f32 v215, v215
    v_exp_f32 v216, v216
    v_exp_f32 v217, v217
    v_smfmac_f32_32x32x32_bf16 a[200:215], a[172:175], v[208:215], v13
    s_waitcnt lgkmcnt(0)
    buffer_load_dwordx4 v[80:83], v1, s[20:23], s30 offen offset:2048 sc1
    v_exp_f32 v218, v218
    v_exp_f32 v219, v219
    v_exp_f32 v220, v220
    v_mfma_f32_32x32x4_2b_bf16 v[184:215], a[192:193], a[244:245], 0
    v_exp_f32 v221, v221
    v_exp_f32 v222, v222
    v_exp_f32 v223, v223
    v_exp_f32 v224, v224
    v_exp_f32 v225, v225
    v_exp_f32 v226, v226
    v_exp_f32 v227, v227
    v_exp_f32 v228, v228
    v_smfmac_f32_32x32x32_bf16 a[200:215], a[176:179], v[216:223], v13
    s_add_u32 s48, s48, s44
    buffer_load_dwordx4 v[84:87], v1, s[20:23], s30 offen offset:3072 sc1
    v_exp_f32 v229, v229
    v_exp_f32 v230, v230
    v_exp_f32 v231, v231
    v_mfma_f32_16x16x32_bf16 v[176:179], v[120:123], a[236:239], v[176:179]
    v_exp_f32 v232, v232
    v_mfma_f32_16x16x32_bf16 v[180:183], v[124:127], a[236:239], v[180:183]
    v_exp_f32 v233, v233
    v_smfmac_f32_32x32x32_bf16 a[200:215], a[180:183], v[224:231], v13
    s_cmp_eq_u32 s55, 17
    s_cselect_b32 s44, s58, 0
    v_exp_f32 v234, v234
    v_exp_f32 v235, v235
    v_exp_f32 v236, v236
    v_mfma_f32_32x32x16_bf16 v[184:199], a[0:3], a[240:243], v[184:199]
    s_add_u32 s30, s27, 81920
    buffer_load_dwordx4 v[88:91], v1, s[20:23], s30 offen offset:0 sc1
    v_exp_f32 v237, v237
    v_exp_f32 v238, v238
    v_exp_f32 v239, v239
    v_mfma_f32_32x32x16_bf16 v[200:215], a[4:7], a[240:243], v[200:215]
    v_exp_f32 v240, v240
    v_exp_f32 v241, v241
    v_exp_f32 v242, v242
    v_smfmac_f32_32x32x32_bf16 a[200:215], a[184:187], v[232:239], v13
    s_add_u32 s48, s48, s44
    s_add_u32 s48, s48, s59
    v_exp_f32 v243, v243
    v_exp_f32 v244, v244
    v_exp_f32 v245, v245
    v_exp_f32 v246, v246
    v_exp_f32 v247, v247
KM_it5:
    v_exp_f32 v184, v184
    v_exp_f32 v185, v185
    v_smfmac_f32_32x32x32_bf16 a[200:215], a[188:191], v[240:247], v13
    buffer_load_dwordx4 v[92:95], v1, s[20:23], s30 offen offset:1024 sc1
    v_exp_f32 v186, v186
    v_exp_f32 v187, v187
    v_exp_f32 v188, v188
    v_mfma_f32_32x32x4_2b_bf16 v[216:247], a[192:193], a[246:247], 0
    v_exp_f32 v189, v189
    v_exp_f32 v190, v190
    v_exp_f32 v191, v191
    v_exp_f32 v192, v192
    v_exp_f32 v193, v193
    v_exp_f32 v194, v194
    v_exp_f32 v195, v195
    v_exp_f32 v196, v196
    v_smfmac_f32_32x32x32_bf16 a[216:231], a[64:67], v[184:191], v13
    buffer_load_dwordx4 v[96:99], v1, s[20:23], s30 offen offset:2048 sc1
    v_exp_f32 v197, v197
    v_exp_f32 v198, v198
    v_exp_f32 v199, v199
    v_exp_f32 v200, v200
    v_exp_f32 v201, v201
    v_smfmac_f32_32x32x32_bf16 a[216:231], a[68:71], v[192:199], v13
    s_mul_i32 s55, s25, 36
    s_add_u32 s55, s55, s26
    ds_write_b128 v5, a[200:203] offset:0
    v_exp_f32 v202, v202
    v_exp_f32 v203, v203
    v_exp_f32 v204, v204
    v_mfma_f32_32x32x16_bf16 v[216:231], a[8:11], a[240:243], v[216:231]
    buffer_load_dwordx4 v[100:103], v1, s[20:23], s30 offen offset:3072 sc1
    ds_write_b128 v5, a[204:207] offset:1024
    v_exp_f32 v205, v205
    v_exp_f32 v206, v206
    v_exp_f32 v207, v207
    v_mfma_f32_32x32x16_bf16 v[232:247], a[12:15], a[240:243], v[232:247]
    ds_write_b128 v5, a[208:211] offset:2048
    v_exp_f32 v208, v208
    v_exp_f32 v209, v209
    v_exp_f32 v210, v210
    v_smfmac_f32_32x32x32_bf16 a[216:231], a[72:75], v[200:207], v13
    s_add_u32 s30, s27, 86016
    buffer_load_dwordx4 v[104:107], v1, s[20:23], s30 offen offset:0 sc1
    v_exp_f32 v211, v211
    v_exp_f32 v212, v212
    v_exp_f32 v213, v213
    v_exp_f32 v214, v214
    v_exp_f32 v215, v215
    v_exp_f32 v216, v216
    v_exp_f32 v217, v217
    v_smfmac_f32_32x32x32_bf16 a[216:231], a[76:79], v[208:215], v13
    buffer_load_dwordx4 v[108:111], v1, s[20:23], s30 offen offset:1024 sc1
    v_exp_f32 v218, v218
    v_exp_f32 v219, v219
    v_exp_f32 v220, v220
    v_mfma_f32_32x32x4_2b_bf16 v[184:215], a[194:195], a[244:245], 0
    v_exp_f32 v221, v221
    v_exp_f32 v222, v222
    v_exp_f32 v223, v223
    v_exp_f32 v224, v224
    v_exp_f32 v225, v225
    v_exp_f32 v226, v226
    v_exp_f32 v227, v227
    v_exp_f32 v228, v228
    v_smfmac_f32_32x32x32_bf16 a[216:231], a[80:83], v[216:223], v13
    s_waitcnt lgkmcnt(0)
    s_barrier
    buffer_load_dwordx4 v[112:115], v1, s[20:23], s30 offen offset:2048 sc1
    v_exp_f32 v229, v229
    v_exp_f32 v230, v230
    v_exp_f32 v231, v231
    v_exp_f32 v232, v232
    v_exp_f32 v233, v233
    v_smfmac_f32_32x32x32_bf16 a[216:231], a[84:87], v[224:231], v13
    s_mul_i32 s55, s55, 37888
    s_add_u32 s55, s55, 6291456
    ds_read_b128 v[36:39], v6 offset:0
    ds_read_b128 v[40:43], v6 offset:3072
    v_exp_f32 v234, v234
    v_exp_f32 v235, v235
    v_exp_f32 v236, v236
    v_mfma_f32_32x32x16_bf16 v[184:199], a[16:19], a[240:243], v[184:199]
    buffer_load_dwordx4 v[116:119], v1, s[20:23], s30 offen offset:3072 sc1
    v_exp_f32 v237, v237
    v_exp_f32 v238, v238
    v_exp_f32 v239, v239
    v_mfma_f32_32x32x16_bf16 v[200:215], a[20:23], a[240:243], v[200:215]
    ds_read_b128 v[44:47], v6 offset:6144
    ds_read_b128 v[48:51], v6 offset:9216
    v_exp_f32 v240, v240
    v_exp_f32 v241, v241
    v_exp_f32 v242, v242
    v_smfmac_f32_32x32x32_bf16 a[216:231], a[88:91], v[232:239], v13
    s_add_u32 s30, s27, 90112
    buffer_load_dwordx4 v[120:123], v1, s[20:23], s30 offen offset:0 sc1
    v_exp_f32 v243, v243
    v_exp_f32 v244, v244
    v_exp_f32 v245, v245
    v_exp_f32 v246, v246
    v_exp_f32 v247, v247
    v_exp_f32 v184, v184
    v_exp_f32 v185, v185
    v_smfmac_f32_32x32x32_bf16 a[216:231], a[92:95], v[240:247], v13
    s_waitcnt lgkmcnt(0)
    buffer_load_dwordx4 v[124:127], v1, s[20:23], s30 offen offset:1024 sc1
    v_add_f32 v38, v38, v42
    v_add_f32 v36, v36, v40
    v_add_f32 v37, v37, v41
    v_add_f32 v39, v39, v43
    v_add_f32 v46, v46, v50
    v_add_f32 v44, v44, v48
    v_add_f32 v45, v45, v49
    v_add_f32 v47, v47, v51
    v_add_f32 v38, v38, v46
    v_exp_f32 v186, v186
    v_exp_f32 v187, v187
    v_exp_f32 v188, v188
    v_mfma_f32_32x32x4_2b_bf16 v[216:247], a[194:195], a[246:247], 0
    ds_bpermute_b32 v52, v7, v38
    v_add_f32 v36, v36, v44
    v_add_f32 v37, v37, v45
    v_add_f32 v39, v39, v47
    v_exp_f32 v189, v189
    v_exp_f32 v190, v190
    v_exp_f32 v191, v191
    v_exp_f32 v192, v192
    v_exp_f32 v193, v193
    v_exp_f32 v194, v194
    v_exp_f32 v195, v195
    v_exp_f32 v196, v196
    v_smfmac_f32_32x32x32_bf16 a[216:231], a[96:99], v[184:191], v13
    s_add_u32 m0, s49, 4096
    s_nop 0
    buffer_load_dwordx4 v248, s[12:15], s48 offen lds
    v_exp_f32 v197, v197
    v_exp_f32 v198, v198
    v_exp_f32 v199, v199
    v_exp_f32 v200, v200
    v_exp_f32 v201, v201
    v_smfmac_f32_32x32x32_bf16 a[216:231], a[100:103], v[192:199], v13
    s_waitcnt lgkmcnt(0)
    v_rcp_f32 v54, v52
    v_exp_f32 v202, v202
    v_mul_f32 v36, v36, v54
    v_mul_f32 v37, v37, v54
    v_mul_f32 v38, v38, v54
    v_mul_f32 v39, v39, v54
    v_max3_f32 v14, v14, v52, v54
    v_cvt_pk_bf16_f32 v36, v36, v37
    v_cvt_pk_bf16_f32 v37, v38, v39
    v_exp_f32 v203, v203
    v_exp_f32 v204, v204
    v_mfma_f32_32x32x16_bf16 v[216:231], a[24:27], a[240:243], v[216:231]
    s_add_u32 m0, s49, 5120
    s_nop 0
    buffer_load_dwordx4 v249, s[12:15], s48 offen lds
    v_exp_f32 v205, v205
    v_exp_f32 v206, v206
    v_exp_f32 v207, v207
    v_mfma_f32_32x32x16_bf16 v[232:247], a[28:31], a[240:243], v[232:247]
    ds_write_b32 v8, v36 offset:10240
    ds_write_b32 v9, v37 offset:10240
    v_exp_f32 v208, v208
    v_exp_f32 v209, v209
    v_exp_f32 v210, v210
    v_smfmac_f32_32x32x32_bf16 a[216:231], a[104:107], v[200:207], v13
    s_add_u32 m0, s49, 6144
    s_nop 0
    buffer_load_dwordx4 v250, s[12:15], s48 offen lds
    v_exp_f32 v211, v211
    v_exp_f32 v212, v212
    v_exp_f32 v213, v213
    v_mfma_f32_32x32x8_bf16 a[200:215], a[248:249], a[248:249], 0
    v_exp_f32 v214, v214
    v_exp_f32 v215, v215
    v_exp_f32 v216, v216
    v_exp_f32 v217, v217
    v_smfmac_f32_32x32x32_bf16 a[216:231], a[108:111], v[208:215], v13
    s_waitcnt lgkmcnt(0)
    s_barrier
    v_exp_f32 v218, v218
    v_exp_f32 v219, v219
    v_exp_f32 v220, v220
    v_mfma_f32_32x32x4_2b_bf16 v[184:215], a[196:197], a[244:245], 0
    v_exp_f32 v221, v221
    v_exp_f32 v222, v222
    v_exp_f32 v223, v223
    v_exp_f32 v224, v224
    v_exp_f32 v225, v225
    v_exp_f32 v226, v226
    v_exp_f32 v227, v227
    v_exp_f32 v228, v228
    v_smfmac_f32_32x32x32_bf16 a[216:231], a[112:115], v[216:223], v13
    s_mul_i32 s44, s24, 256
    s_lshr_b32 s44, s44, 8
    ds_read_b128 a[232:235], v12 offset:10240
    ds_read_b128 a[236:239], v12 offset:11264
    v_exp_f32 v229, v229
    v_exp_f32 v230, v230
    v_exp_f32 v231, v231
    v_exp_f32 v232, v232
    v_exp_f32 v233, v233
    v_smfmac_f32_32x32x32_bf16 a[216:231], a[116:119], v[224:231], v13
    s_mul_i32 s44, s44, 1
    s_sub_u32 s44, s24, s44
    v_exp_f32 v234, v234
    v_exp_f32 v235, v235
    v_exp_f32 v236, v236
    v_mfma_f32_32x32x16_bf16 v[184:199], a[32:35], a[240:243], v[184:199]
    s_mul_i32 s32, s44, 36864
    v_exp_f32 v237, v237
    v_exp_f32 v238, v238
    v_exp_f32 v239, v239
    v_mfma_f32_32x32x16_bf16 v[200:215], a[36:39], a[240:243], v[200:215]
    s_add_u32 s52, s32, 6144
    v_exp_f32 v240, v240
    v_exp_f32 v241, v241
    v_exp_f32 v242, v242
    v_smfmac_f32_32x32x32_bf16 a[216:231], a[120:123], v[232:239], v13
    s_cmp_eq_u32 s52, 36864
    s_cselect_b32 s52, 0, s52
    v_exp_f32 v243, v243
    v_exp_f32 v244, v244
    v_exp_f32 v245, v245
    v_exp_f32 v246, v246
    v_exp_f32 v247, v247
    v_exp_f32 v184, v184
    v_exp_f32 v185, v185
    v_smfmac_f32_32x32x32_bf16 a[216:231], a[124:127], v[240:247], v13
    s_add_u32 s53, s52, 6144
    v_exp_f32 v186, v186
    v_exp_f32 v187, v187
    v_exp_f32 v188, v188
    v_mfma_f32_32x32x4_2b_bf16 v[216:247], a[196:197], a[246:247], 0
    v_exp_f32 v189, v189
    v_exp_f32 v190, v190
    v_exp_f32 v191, v191
    v_exp_f32 v192, v192
    v_exp_f32 v193, v193
    v_exp_f32 v194, v194
    v_exp_f32 v195, v195
    v_exp_f32 v196, v196
    v_smfmac_f32_32x32x32_bf16 a[216:231], a[128:131], v[184:191], v13
    s_waitcnt vmcnt(12) lgkmcnt(0)
    ds_read_b64_tr_b16 v[24:25], v19 offset:0
    ds_read_b64_tr_b16 v[26:27], v19 offset:384
    ds_read_b64_tr_b16 v[28:29], v19 offset:32
    v_exp_f32 v197, v197
    v_exp_f32 v198, v198
    v_exp_f32 v199, v199
    v_mfma_f32_16x16x32_bf16 v[148:151], v[56:59], a[232:235], v[148:151]
    v_exp_f32 v200, v200
    v_mfma_f32_16x16x32_bf16 v[152:155], v[60:63], a[232:235], v[152:155]
    v_exp_f32 v201, v201
    v_smfmac_f32_32x32x32_bf16 a[216:231], a[132:135], v[192:199], v13
    s_cmp_eq_u32 s53, 36864
    s_cselect_b32 s53, 0, s53
    ds_read_b64_tr_b16 v[30:31], v19 offset:416
    ds_read_b64_tr_b16 v[32:33], v19 offset:64
    ds_read_b64_tr_b16 v[34:35], v19 offset:448
    v_exp_f32 v202, v202
    v_exp_f32 v203, v203
    v_exp_f32 v204, v204
    v_mfma_f32_32x32x16_bf16 v[216:231], a[40:43], a[240:243], v[216:231]
    s_add_u32 s97, s53, 6144
    v_exp_f32 v205, v205
    v_exp_f32 v206, v206
    v_exp_f32 v207, v207
    v_mfma_f32_32x32x16_bf16 v[232:247], a[44:47], a[240:243], v[232:247]
    v_exp_f32 v208, v208
    v_exp_f32 v209, v209
    v_exp_f32 v210, v210
    v_smfmac_f32_32x32x32_bf16 a[216:231], a[136:139], v[200:207], v13
    s_waitcnt lgkmcnt(0)
    s_add_u32 s50, s50, 1024
    buffer_store_dwordx4 v[24:27], v1, s[16:19], s50 offen sc1
    v_exp_f32 v211, v211
    v_exp_f32 v212, v212
    v_exp_f32 v213, v213
    v_mfma_f32_16x16x32_bf16 v[156:159], v[64:67], a[232:235], v[156:159]
    v_exp_f32 v214, v214
    v_mfma_f32_16x16x32_bf16 v[160:163], v[68:71], a[232:235], v[160:163]
    v_exp_f32 v215, v215
    v_mfma_f32_16x16x32_bf16 v[164:167], v[72:75], a[232:235], v[164:167]
    v_exp_f32 v216, v216
    v_mfma_f32_16x16x32_bf16 v[168:171], v[76:79], a[232:235], v[168:171]
    v_exp_f32 v217, v217
    v_smfmac_f32_32x32x32_bf16 a[216:231], a[140:143], v[208:215], v13
    s_add_u32 s46, s50, s51
    buffer_store_dwordx4 v[28:31], v1, s[16:19], s46 offen sc1
    v_exp_f32 v218, v218
    v_exp_f32 v219, v219
    v_exp_f32 v220, v220
    v_mfma_f32_32x32x4_2b_bf16 v[184:215], a[198:199], a[244:245], 0
    v_exp_f32 v221, v221
    v_exp_f32 v222, v222
    v_exp_f32 v223, v223
    v_exp_f32 v224, v224
    v_exp_f32 v225, v225
    v_exp_f32 v226, v226
    v_exp_f32 v227, v227
    v_exp_f32 v228, v228
    v_smfmac_f32_32x32x32_bf16 a[216:231], a[144:147], v[216:223], v13
    s_add_u32 s46, s46, s51
    buffer_store_dwordx4 v[32:35], v1, s[16:19], s46 offen sc1
    v_exp_f32 v229, v229
    v_exp_f32 v230, v230
    v_exp_f32 v231, v231
    v_mfma_f32_16x16x32_bf16 v[172:175], v[80:83], a[232:235], v[172:175]
    v_exp_f32 v232, v232
    v_mfma_f32_16x16x32_bf16 v[176:179], v[84:87], a[232:235], v[176:179]
    v_exp_f32 v233, v233
    v_smfmac_f32_32x32x32_bf16 a[216:231], a[148:151], v[224:231], v13
    s_cmp_eq_u32 s97, 36864
    s_cselect_b32 s97, 0, s97
    v_exp_f32 v234, v234
    v_exp_f32 v235, v235
    v_exp_f32 v236, v236
    v_mfma_f32_32x32x16_bf16 v[184:199], a[48:51], a[240:243], v[184:199]
    buffer_load_dwordx4 v[56:59], v1, s[20:23], s30 offen offset:2048 sc1
    v_exp_f32 v237, v237
    v_exp_f32 v238, v238
    v_exp_f32 v239, v239
    v_mfma_f32_32x32x16_bf16 v[200:215], a[52:55], a[240:243], v[200:215]
    s_add_u32 s98, s97, 6144
    v_exp_f32 v240, v240
    v_exp_f32 v241, v241
    v_exp_f32 v242, v242
    v_smfmac_f32_32x32x32_bf16 a[216:231], a[152:155], v[232:239], v13
    s_waitcnt vmcnt(7)
    buffer_load_dwordx4 v[60:63], v1, s[20:23], s30 offen offset:3072 sc1
    v_exp_f32 v243, v243
    v_exp_f32 v244, v244
    v_exp_f32 v245, v245
    v_mfma_f32_16x16x32_bf16 v[180:183], v[88:91], a[232:235], v[180:183]
    s_branch KO_5
KP_5:
    s_branch KP_9
KO_5:
    v_exp_f32 v246, v246
    v_mfma_f32_16x16x32_bf16 v[148:151], v[92:95], a[236:239], v[148:151]
    v_exp_f32 v247, v247
    v_mfma_f32_16x16x32_bf16 v[152:155], v[96:99], a[236:239], v[152:155]
    v_exp_f32 v184, v184
    v_mfma_f32_16x16x32_bf16 v[156:159], v[100:103], a[236:239], v[156:159]
    v_exp_f32 v185, v185
    v_smfmac_f32_32x32x32_bf16 a[216:231], a[156:159], v[240:247], v13
    s_add_u32 s30, s27, 94208
    buffer_load_dwordx4 v[64:67], v1, s[20:23], s30 offen offset:0 sc1
    v_exp_f32 v186, v186
    v_exp_f32 v187, v187
    v_exp_f32 v188, v188
    v_mfma_f32_32x32x4_2b_bf16 v[216:247], a[198:199], a[246:247], 0
    v_exp_f32 v189, v189
    v_exp_f32 v190, v190
    v_exp_f32 v191, v191
    v_exp_f32 v192, v192
    v_exp_f32 v193, v193
    v_exp_f32 v194, v194
    v_exp_f32 v195, v195
    v_exp_f32 v196, v196
    v_smfmac_f32_32x32x32_bf16 a[216:231], a[160:163], v[184:191], v13
    buffer_load_dwordx4 v[68:71], v1, s[20:23], s30 offen offset:1024 sc1
    v_exp_f32 v197, v197
    v_exp_f32 v198, v198
    v_exp_f32 v199, v199
    v_mfma_f32_16x16x32_bf16 v[160:163], v[104:107], a[236:239], v[160:163]
    v_exp_f32 v200, v200
    v_mfma_f32_16x16x32_bf16 v[164:167], v[108:111], a[236:239], v[164:167]
    v_exp_f32 v201, v201
    v_smfmac_f32_32x32x32_bf16 a[216:231], a[164:167], v[192:199], v13
    s_cmp_eq_u32 s98, 36864
    s_cselect_b32 s98, 0, s98
    ds_read_b32 a244, v4 offset:6912
    ds_read_b32 a247, v4 offset:6912
    v_exp_f32 v202, v202
    v_exp_f32 v203, v203
    v_exp_f32 v204, v204
    v_mfma_f32_32x32x16_bf16 v[216:231], a[56:59], a[240:243], v[216:231]
    buffer_load_dwordx4 v[72:75], v1, s[20:23], s30 offen offset:2048 sc1
    v_exp_f32 v205, v205
    v_exp_f32 v206, v206
    v_exp_f32 v207, v207
    v_mfma_f32_32x32x16_bf16 v[232:247], a[60:63], a[240:243], v[232:247]
    s_add_u32 s99, s98, 6144
    ds_read2_b32 a[240:241], v3 offset1:16
    ds_read2_b32 a[242:243], v146 offset1:16
    v_exp_f32 v208, v208
    v_add_u32 v3, 1152, v3
    v_add_u32 v146, 1152, v146
    v_exp_f32 v209, v209
    v_exp_f32 v210, v210
    v_smfmac_f32_32x32x32_bf16 a[216:231], a[168:171], v[200:207], v13
    buffer_load_dwordx4 v[76:79], v1, s[20:23], s30 offen offset:3072 sc1
    v_exp_f32 v211, v211
    v_exp_f32 v212, v212
    v_exp_f32 v213, v213
    v_mfma_f32_16x16x32_bf16 v[168:171], v[112:115], a[236:239], v[168:171]
    v_exp_f32 v214, v214
    v_mfma_f32_16x16x32_bf16 v[172:175], v[116:119], a[236:239], v[172:175]
    v_exp_f32 v215, v215
    v_exp_f32 v216, v216
    v_exp_f32 v217, v217
    v_smfmac_f32_32x32x32_bf16 a[216:231], a[172:175], v[208:215], v13
    s_waitcnt lgkmcnt(0)
    s_add_u32 s30, s27, 98304
    buffer_load_dwordx4 v[80:83], v1, s[20:23], s30 offen offset:0 sc1
    v_exp_f32 v218, v218
    v_exp_f32 v219, v219
    v_exp_f32 v220, v220
    v_mfma_f32_32x32x4_2b_bf16 v[184:215], a[192:193], a[244:245], 0
    v_exp_f32 v221, v221
    v_exp_f32 v222, v222
    v_exp_f32 v223, v223
    v_exp_f32 v224, v224
    v_exp_f32 v225, v225
    v_exp_f32 v226, v226
    v_exp_f32 v227, v227
    v_exp_f32 v228, v228
    v_smfmac_f32_32x32x32_bf16 a[216:231], a[176:179], v[216:223], v13
    buffer_load_dwordx4 v[84:87], v1, s[20:23], s30 offen offset:1024 sc1
    v_exp_f32 v229, v229
    v_exp_f32 v230, v230
    v_exp_f32 v231, v231
    v_mfma_f32_16x16x32_bf16 v[176:179], v[120:123], a[236:239], v[176:179]
    v_exp_f32 v232, v232
    v_mfma_f32_16x16x32_bf16 v[180:183], v[124:127], a[236:239], v[180:183]
    v_exp_f32 v233, v233
    v_smfmac_f32_32x32x32_bf16 a[216:231], a[180:183], v[224:231], v13
    s_cmp_eq_u32 s99, 36864
    s_cselect_b32 s99, 0, s99
    v_exp_f32 v234, v234
    v_exp_f32 v235, v235
    v_exp_f32 v236, v236
    v_mfma_f32_32x32x16_bf16 v[184:199], a[0:3], a[240:243], v[184:199]
    buffer_load_dwordx4 v[88:91], v1, s[20:23], s30 offen offset:2048 sc1
    v_exp_f32 v237, v237
    v_exp_f32 v238, v238
    v_exp_f32 v239, v239
    v_mfma_f32_32x32x16_bf16 v[200:215], a[4:7], a[240:243], v[200:215]
    v_exp_f32 v240, v240
    v_exp_f32 v241, v241
    v_exp_f32 v242, v242
    v_smfmac_f32_32x32x32_bf16 a[216:231], a[184:187], v[232:239], v13
    s_and_b32 s44, s24, 0
    s_mul_i32 s44, s44, 4
    v_exp_f32 v243, v243
    v_exp_f32 v244, v244
    v_exp_f32 v245, v245
    v_exp_f32 v246, v246
    v_exp_f32 v247, v247
KM_it6:
    v_exp_f32 v184, v184
    v_exp_f32 v185, v185
    v_smfmac_f32_32x32x32_bf16 a[216:231], a[188:191], v[240:247], v13
    buffer_load_dwordx4 v[92:95], v1, s[20:23], s30 offen offset:3072 sc1
    v_exp_f32 v186, v186
    v_exp_f32 v187, v187
    v_exp_f32 v188, v188
    v_mfma_f32_32x32x4_2b_bf16 v[216:247], a[192:193], a[246:247], 0
    v_exp_f32 v189, v189
    v_exp_f32 v190, v190
    v_exp_f32 v191, v191
    v_exp_f32 v192, v192
    v_exp_f32 v193, v193
    v_exp_f32 v194, v194
    v_exp_f32 v195, v195
    v_exp_f32 v196, v196
    v_smfmac_f32_32x32x32_bf16 a[200:215], a[64:67], v[184:191], v13
    s_add_u32 s30, s27, 102400
    buffer_load_dwordx4 v[96:99], v1, s[20:23], s30 offen offset:0 sc1
    v_exp_f32 v197, v197
    v_exp_f32 v198, v198
    v_exp_f32 v199, v199
    v_exp_f32 v200, v200
    v_exp_f32 v201, v201
    v_smfmac_f32_32x32x32_bf16 a[200:215], a[68:71], v[192:199], v13
    s_add_u32 s56, s44, 0
    s_and_b32 s56, s56, 3
    ds_write_b128 v5, a[216:219] offset:0
    v_exp_f32 v202, v202
    v_exp_f32 v203, v203
    v_exp_f32 v204, v204
    v_mfma_f32_32x32x16_bf16 v[216:231], a[8:11], a[240:243], v[216:231]
    buffer_load_dwordx4 v[100:103], v1, s[20:23], s30 offen offset:1024 sc1
    ds_write_b128 v5, a[220:223] offset:1024
    v_exp_f32 v205, v205
    v_exp_f32 v206, v206
    v_exp_f32 v207, v207
    v_mfma_f32_32x32x16_bf16 v[232:247], a[12:15], a[240:243], v[232:247]
    s_mul_i32 s56, s56, 3072
    ds_write_b128 v5, a[224:227] offset:2048
    v_exp_f32 v208, v208
    v_exp_f32 v209, v209
    v_exp_f32 v210, v210
    v_smfmac_f32_32x32x32_bf16 a[200:215], a[72:75], v[200:207], v13
    buffer_load_dwordx4 v[104:107], v1, s[20:23], s30 offen offset:2048 sc1
    v_exp_f32 v211, v211
    v_exp_f32 v212, v212
    v_exp_f32 v213, v213
    v_exp_f32 v214, v214
    v_exp_f32 v215, v215
    v_exp_f32 v216, v216
    v_exp_f32 v217, v217
    v_smfmac_f32_32x32x32_bf16 a[200:215], a[76:79], v[208:215], v13
    buffer_load_dwordx4 v[108:111], v1, s[20:23], s30 offen offset:3072 sc1
    v_exp_f32 v218, v218
    v_exp_f32 v219, v219
    v_exp_f32 v220, v220
    v_mfma_f32_32x32x4_2b_bf16 v[184:215], a[194:195], a[244:245], 0
    v_exp_f32 v221, v221
    v_exp_f32 v222, v222
    v_exp_f32 v223, v223
    v_exp_f32 v224, v224
    v_exp_f32 v225, v225
    v_exp_f32 v226, v226
    v_exp_f32 v227, v227
    v_exp_f32 v228, v228
    v_smfmac_f32_32x32x32_bf16 a[200:215], a[80:83], v[216:223], v13
    s_waitcnt lgkmcnt(0)
    s_barrier
    s_add_u32 s30, s27, 106496
    buffer_load_dwordx4 v[112:115], v1, s[20:23], s30 offen offset:0 sc1
    v_exp_f32 v229, v229
    v_exp_f32 v230, v230
    v_exp_f32 v231, v231
    v_exp_f32 v232, v232
    v_exp_f32 v233, v233
    v_smfmac_f32_32x32x32_bf16 a[200:215], a[84:87], v[224:231], v13
    s_add_u32 s57, s44, 1
    s_and_b32 s57, s57, 3
    ds_read_b128 v[36:39], v6 offset:0
    ds_read_b128 v[40:43], v6 offset:3072
    v_exp_f32 v234, v234
    v_exp_f32 v235, v235
    v_exp_f32 v236, v236
    v_mfma_f32_32x32x16_bf16 v[184:199], a[16:19], a[240:243], v[184:199]
    buffer_load_dwordx4 v[116:119], v1, s[20:23], s30 offen offset:1024 sc1
    v_exp_f32 v237, v237
    v_exp_f32 v238, v238
    v_exp_f32 v239, v239
    v_mfma_f32_32x32x16_bf16 v[200:215], a[20:23], a[240:243], v[200:215]
    s_mul_i32 s57, s57, 3072
    ds_read_b128 v[44:47], v6 offset:6144
    ds_read_b128 v[48:51], v6 offset:9216
    v_exp_f32 v240, v240
    v_exp_f32 v241, v241
    v_exp_f32 v242, v242
    v_smfmac_f32_32x32x32_bf16 a[200:215], a[88:91], v[232:239], v13
    buffer_load_dwordx4 v[120:123], v1, s[20:23], s30 offen offset:2048 sc1
    v_exp_f32 v243, v243
    v_exp_f32 v244, v244
    v_exp_f32 v245, v245
    v_exp_f32 v246, v246
    v_exp_f32 v247, v247
    v_exp_f32 v184, v184
    v_exp_f32 v185, v185
    v_smfmac_f32_32x32x32_bf16 a[200:215], a[92:95], v[240:247], v13
    s_waitcnt lgkmcnt(0)
    buffer_load_dwordx4 v[124:127], v1, s[20:23], s30 offen offset:3072 sc1
    v_add_f32 v38, v38, v42
    v_add_f32 v36, v36, v40
    v_add_f32 v37, v37, v41
    v_add_f32 v39, v39, v43
    v_add_f32 v46, v46, v50
    v_add_f32 v44, v44, v48
    v_add_f32 v45, v45, v49
    v_add_f32 v47, v47, v51
    v_add_f32 v38, v38, v46
    v_exp_f32 v186, v186
    v_exp_f32 v187, v187
    v_exp_f32 v188, v188
    v_mfma_f32_32x32x4_2b_bf16 v[216:247], a[194:195], a[246:247], 0
    ds_bpermute_b32 v52, v7, v38
    v_add_f32 v36, v36, v44
    v_add_f32 v37, v37, v45
    v_add_f32 v39, v39, v47
    v_exp_f32 v189, v189
    v_exp_f32 v190, v190
    v_exp_f32 v191, v191
    v_exp_f32 v192, v192
    v_exp_f32 v193, v193
    v_exp_f32 v194, v194
    v_exp_f32 v195, v195
    v_exp_f32 v196, v196
    v_smfmac_f32_32x32x32_bf16 a[200:215], a[96:99], v[184:191], v13
    buffer_store_dwordx4 v[252:255], v1, s[20:23], s37 offen offset:0 sc1
    v_exp_f32 v197, v197
    v_exp_f32 v198, v198
    v_exp_f32 v199, v199
    v_exp_f32 v200, v200
    v_exp_f32 v201, v201
    v_smfmac_f32_32x32x32_bf16 a[200:215], a[100:103], v[192:199], v13
    s_waitcnt lgkmcnt(0)
    v_rcp_f32 v54, v52
    v_exp_f32 v202, v202
    v_mul_f32 v36, v36, v54
    v_mul_f32 v37, v37, v54
    v_mul_f32 v38, v38, v54
    v_mul_f32 v39, v39, v54
    v_max3_f32 v14, v14, v52, v54
    v_cvt_pk_bf16_f32 v36, v36, v37
    v_cvt_pk_bf16_f32 v37, v38, v39
    v_exp_f32 v203, v203
    v_exp_f32 v204, v204
    v_mfma_f32_32x32x16_bf16 v[216:231], a[24:27], a[240:243], v[216:231]
    buffer_store_dwordx4 v[252:255], v1, s[20:23], s37 offen offset:1024 sc1
    v_exp_f32 v205, v205
    v_exp_f32 v206, v206
    v_exp_f32 v207, v207
    v_mfma_f32_32x32x16_bf16 v[232:247], a[28:31], a[240:243], v[232:247]
    ds_write_b32 v8, v36 offset:12800
    ds_write_b32 v9, v37 offset:12800
    v_exp_f32 v208, v208
    v_exp_f32 v209, v209
    v_exp_f32 v210, v210
    v_smfmac_f32_32x32x32_bf16 a[200:215], a[104:107], v[200:207], v13
    v_exp_f32 v211, v211
    v_exp_f32 v212, v212
    v_exp_f32 v213, v213
    v_mfma_f32_32x32x8_bf16 a[216:231], a[248:249], a[248:249], 0
    v_exp_f32 v214, v214
    v_exp_f32 v215, v215
    v_exp_f32 v216, v216
    v_exp_f32 v217, v217
    v_smfmac_f32_32x32x32_bf16 a[200:215], a[108:111], v[208:215], v13
    s_waitcnt lgkmcnt(0)
    s_barrier
    buffer_store_dwordx4 v[252:255], v1, s[20:23], s38 offen offset:0 sc1
    v_exp_f32 v218, v218
    v_exp_f32 v219, v219
    v_exp_f32 v220, v220
    v_mfma_f32_32x32x4_2b_bf16 v[184:215], a[196:197], a[244:245], 0
    v_exp_f32 v221, v221
    v_exp_f32 v222, v222
    v_exp_f32 v223, v223
    v_exp_f32 v224, v224
    v_exp_f32 v225, v225
    v_exp_f32 v226, v226
    v_exp_f32 v227, v227
    v_exp_f32 v228, v228
    v_smfmac_f32_32x32x32_bf16 a[200:215], a[112:115], v[216:223], v13
    s_add_u32 s58, s44, 2
    s_and_b32 s58, s58, 3
    buffer_store_dwordx4 v[252:255], v1, s[20:23], s38 offen offset:1024 sc1
    ds_read_b128 a[232:235], v12 offset:12800
    ds_read_b128 a[236:239], v12 offset:13824
    v_exp_f32 v229, v229
    v_exp_f32 v230, v230
    v_exp_f32 v231, v231
    v_exp_f32 v232, v232
    v_exp_f32 v233, v233
    v_smfmac_f32_32x32x32_bf16 a[200:215], a[116:119], v[224:231], v13
    s_mul_i32 s58, s58, 3072
    v_exp_f32 v234, v234
    v_exp_f32 v235, v235
    v_exp_f32 v236, v236
    v_mfma_f32_32x32x16_bf16 v[184:199], a[32:35], a[240:243], v[184:199]
    v_exp_f32 v237, v237
    v_exp_f32 v238, v238
    v_exp_f32 v239, v239
    v_mfma_f32_32x32x16_bf16 v[200:215], a[36:39], a[240:243], v[200:215]
    v_exp_f32 v240, v240
    v_exp_f32 v241, v241
    v_exp_f32 v242, v242
    v_smfmac_f32_32x32x32_bf16 a[200:215], a[120:123], v[232:239], v13
    s_add_u32 s59, s44, 3
    s_and_b32 s59, s59, 3
    buffer_store_dwordx4 v[252:255], v1, s[20:23], s39 offen offset:0 sc1
    v_exp_f32 v243, v243
    v_exp_f32 v244, v244
    v_exp_f32 v245, v245
    v_exp_f32 v246, v246
    v_exp_f32 v247, v247
    v_exp_f32 v184, v184
    v_exp_f32 v185, v185
    v_smfmac_f32_32x32x32_bf16 a[200:215], a[124:127], v[240:247], v13
    s_mul_i32 s59, s59, 3072
    buffer_store_dwordx4 v[252:255], v1, s[20:23], s39 offen offset:1024 sc1
    v_exp_f32 v186, v186
    v_exp_f32 v187, v187
    v_exp_f32 v188, v188
    v_mfma_f32_32x32x4_2b_bf16 v[216:247], a[196:197], a[246:247], 0
    v_exp_f32 v189, v189
    v_exp_f32 v190, v190
    v_exp_f32 v191, v191
    v_exp_f32 v192, v192
    v_exp_f32 v193, v193
    v_exp_f32 v194, v194
    v_exp_f32 v195, v195
    v_exp_f32 v196, v196
    v_smfmac_f32_32x32x32_bf16 a[200:215], a[128:131], v[184:191], v13
    s_waitcnt vmcnt(15) lgkmcnt(0)
    ds_read_b64_tr_b16 v[24:25], v19 offset:4096
    ds_read_b64_tr_b16 v[26:27], v19 offset:4480
    ds_read_b64_tr_b16 v[28:29], v19 offset:4128
    v_exp_f32 v197, v197
    v_exp_f32 v198, v198
    v_exp_f32 v199, v199
    v_mfma_f32_16x16x32_bf16 v[148:151], v[56:59], a[232:235], v[148:151]
    v_exp_f32 v200, v200
    v_mfma_f32_16x16x32_bf16 v[152:155], v[60:63], a[232:235], v[152:155]
    v_exp_f32 v201, v201
    v_smfmac_f32_32x32x32_bf16 a[200:215], a[132:135], v[192:199], v13
    ds_read_b64_tr_b16 v[30:31], v19 offset:4512
    ds_read_b64_tr_b16 v[32:33], v19 offset:4160
    ds_read_b64_tr_b16 v[34:35], v19 offset:4544
    v_exp_f32 v202, v202
    v_exp_f32 v203, v203
    v_exp_f32 v204, v204
    v_mfma_f32_32x32x16_bf16 v[216:231], a[40:43], a[240:243], v[216:231]
    v_exp_f32 v205, v205
    v_exp_f32 v206, v206
    v_exp_f32 v207, v207
    v_mfma_f32_32x32x16_bf16 v[232:247], a[44:47], a[240:243], v[232:247]
    v_exp_f32 v208, v208
    v_exp_f32 v209, v209
    v_exp_f32 v210, v210
    v_smfmac_f32_32x32x32_bf16 a[200:215], a[136:139], v[200:207], v13
    s_waitcnt lgkmcnt(0)
    s_add_u32 s50, s50, 1024
    buffer_store_dwordx4 v[24:27], v1, s[16:19], s50 offen sc1
    v_exp_f32 v211, v211
    v_exp_f32 v212, v212
    v_exp_f32 v213, v213
    v_mfma_f32_16x16x32_bf16 v[156:159], v[64:67], a[232:235], v[156:159]
    v_exp_f32 v214, v214
    v_mfma_f32_16x16x32_bf16 v[160:163], v[68:71], a[232:235], v[160:163]
    v_exp_f32 v215, v215
    v_mfma_f32_16x16x32_bf16 v[164:167], v[72:75], a[232:235], v[164:167]
    v_exp_f32 v216, v216
    v_mfma_f32_16x16x32_bf16 v[168:171], v[76:79], a[232:235], v[168:171]
    v_exp_f32 v217, v217
    v_smfmac_f32_32x32x32_bf16 a[200:215], a[140:143], v[208:215], v13
    s_add_u32 s46, s50, s51
    buffer_store_dwordx4 v[28:31], v1, s[16:19], s46 offen sc1
    v_exp_f32 v218, v218
    v_exp_f32 v219, v219
    v_exp_f32 v220, v220
    v_mfma_f32_32x32x4_2b_bf16 v[184:215], a[198:199], a[244:245], 0
    v_exp_f32 v221, v221
    v_exp_f32 v222, v222
    v_exp_f32 v223, v223
    v_exp_f32 v224, v224
    v_exp_f32 v225, v225
    v_exp_f32 v226, v226
    v_exp_f32 v227, v227
    v_exp_f32 v228, v228
    v_smfmac_f32_32x32x32_bf16 a[200:215], a[144:147], v[216:223], v13
    s_add_u32 s46, s46, s51
    buffer_store_dwordx4 v[32:35], v1, s[16:19], s46 offen sc1
    v_exp_f32 v229, v229
    v_exp_f32 v230, v230
    v_exp_f32 v231, v231
    v_mfma_f32_16x16x32_bf16 v[172:175], v[80:83], a[232:235], v[172:175]
    v_exp_f32 v232, v232
    v_mfma_f32_16x16x32_bf16 v[176:179], v[84:87], a[232:235], v[176:179]
    v_exp_f32 v233, v233
    v_smfmac_f32_32x32x32_bf16 a[200:215], a[148:151], v[224:231], v13
    v_exp_f32 v234, v234
    v_exp_f32 v235, v235
    v_exp_f32 v236, v236
    v_mfma_f32_32x32x16_bf16 v[184:199], a[48:51], a[240:243], v[184:199]
    s_add_u32 s30, s27, 110592
    buffer_load_dwordx4 v[56:59], v1, s[20:23], s30 offen offset:0 sc1
    v_exp_f32 v237, v237
    v_exp_f32 v238, v238
    v_exp_f32 v239, v239
    v_mfma_f32_32x32x16_bf16 v[200:215], a[52:55], a[240:243], v[200:215]
    v_exp_f32 v240, v240
    v_exp_f32 v241, v241
    v_exp_f32 v242, v242
    v_smfmac_f32_32x32x32_bf16 a[200:215], a[152:155], v[232:239], v13
    s_waitcnt vmcnt(10)
    buffer_load_dwordx4 v[60:63], v1, s[20:23], s30 offen offset:1024 sc1
    v_exp_f32 v243, v243
    v_exp_f32 v244, v244
    v_exp_f32 v245, v245
    v_mfma_f32_16x16x32_bf16 v[180:183], v[88:91], a[232:235], v[180:183]
    v_exp_f32 v246, v246
    v_mfma_f32_16x16x32_bf16 v[148:151], v[92:95], a[236:239], v[148:151]
    v_exp_f32 v247, v247
    v_mfma_f32_16x16x32_bf16 v[152:155], v[96:99], a[236:239], v[152:155]
    v_exp_f32 v184, v184
    v_mfma_f32_16x16x32_bf16 v[156:159], v[100:103], a[236:239], v[156:159]
    v_exp_f32 v185, v185
    v_smfmac_f32_32x32x32_bf16 a[200:215], a[156:159], v[240:247], v13
    buffer_load_dwordx4 v[64:67], v1, s[20:23], s30 offen offset:2048 sc1
    v_exp_f32 v186, v186
    v_exp_f32 v187, v187
    v_exp_f32 v188, v188
    v_mfma_f32_32x32x4_2b_bf16 v[216:247], a[198:199], a[246:247], 0
    v_exp_f32 v189, v189
    v_exp_f32 v190, v190
    v_exp_f32 v191, v191
    v_exp_f32 v192, v192
    v_exp_f32 v193, v193
    v_exp_f32 v194, v194
    v_exp_f32 v195, v195
    v_exp_f32 v196, v196
    v_smfmac_f32_32x32x32_bf16 a[200:215], a[160:163], v[184:191], v13
    buffer_load_dwordx4 v[68:71], v1, s[20:23], s30 offen offset:3072 sc1
    v_exp_f32 v197, v197
    v_exp_f32 v198, v198
    v_exp_f32 v199, v199
    v_mfma_f32_16x16x32_bf16 v[160:163], v[104:107], a[236:239], v[160:163]
    v_exp_f32 v200, v200
    v_mfma_f32_16x16x32_bf16 v[164:167], v[108:111], a[236:239], v[164:167]
    v_exp_f32 v201, v201
    v_smfmac_f32_32x32x32_bf16 a[200:215], a[164:167], v[192:199], v13
    ds_read_b32 a244, v4 offset:8064
    ds_read_b32 a247, v4 offset:8064
    v_exp_f32 v202, v202
    v_exp_f32 v203, v203
    v_exp_f32 v204, v204
    v_mfma_f32_32x32x16_bf16 v[216:231], a[56:59], a[240:243], v[216:231]
    s_add_u32 s30, s27, 114688
    buffer_load_dwordx4 v[72:75], v1, s[20:23], s30 offen offset:0 sc1
    v_exp_f32 v205, v205
    v_exp_f32 v206, v206
    v_exp_f32 v207, v207
    v_mfma_f32_32x32x16_bf16 v[232:247], a[60:63], a[240:243], v[232:247]
    ds_read2_b32 a[240:241], v3 offset1:16
    ds_read2_b32 a[242:243], v146 offset1:16
    v_exp_f32 v208, v208
    v_exp_f32 v209, v209
    v_exp_f32 v210, v210
    v_smfmac_f32_32x32x32_bf16 a[200:215], a[168:171], v[200:207], v13
    buffer_load_dwordx4 v[76:79], v1, s[20:23], s30 offen offset:1024 sc1
    v_exp_f32 v211, v211
    v_exp_f32 v212, v212
    v_exp_f32 v213, v213
    v_mfma_f32_16x16x32_bf16 v[168:171], v[112:115], a[236:239], v[168:171]
    v_exp_f32 v214, v214
    v_mfma_f32_16x16x32_bf16 v[172:175], v[116:119], a[236:239], v[172:175]
    v_exp_f32 v215, v215
    v_exp_f32 v216, v216
    v_exp_f32 v217, v217
    v_smfmac_f32_32x32x32_bf16 a[200:215], a[172:175], v[208:215], v13
    s_waitcnt lgkmcnt(0)
    buffer_load_dwordx4 v[80:83], v1, s[20:23], s30 offen offset:2048 sc1
    v_exp_f32 v218, v218
    v_exp_f32 v219, v219
    v_exp_f32 v220, v220
    v_mfma_f32_32x32x4_2b_bf16 v[184:215], a[192:193], a[244:245], 0
    v_exp_f32 v221, v221
    v_exp_f32 v222, v222
    v_exp_f32 v223, v223
    v_exp_f32 v224, v224
    v_exp_f32 v225, v225
    v_exp_f32 v226, v226
    v_exp_f32 v227, v227
    v_exp_f32 v228, v228
    v_smfmac_f32_32x32x32_bf16 a[200:215], a[176:179], v[216:223], v13
    buffer_load_dwordx4 v[84:87], v1, s[20:23], s30 offen offset:3072 sc1
    v_exp_f32 v229, v229
    v_exp_f32 v230, v230
    v_exp_f32 v231, v231
    v_mfma_f32_16x16x32_bf16 v[176:179], v[120:123], a[236:239], v[176:179]
    v_exp_f32 v232, v232
    v_mfma_f32_16x16x32_bf16 v[180:183], v[124:127], a[236:239], v[180:183]
    v_exp_f32 v233, v233
    v_smfmac_f32_32x32x32_bf16 a[200:215], a[180:183], v[224:231], v13
    v_exp_f32 v234, v234
    v_exp_f32 v235, v235
    v_exp_f32 v236, v236
    v_mfma_f32_32x32x16_bf16 v[184:199], a[0:3], a[240:243], v[184:199]
    s_add_u32 s30, s27, 118784
    buffer_load_dwordx4 v[88:91], v1, s[20:23], s30 offen offset:0 sc1
    v_exp_f32 v237, v237
    v_exp_f32 v238, v238
    v_exp_f32 v239, v239
    v_mfma_f32_32x32x16_bf16 v[200:215], a[4:7], a[240:243], v[200:215]
    v_exp_f32 v240, v240
    v_exp_f32 v241, v241
    v_exp_f32 v242, v242
    v_smfmac_f32_32x32x32_bf16 a[200:215], a[184:187], v[232:239], v13
    v_exp_f32 v243, v243
    v_exp_f32 v244, v244
    v_exp_f32 v245, v245
    v_exp_f32 v246, v246
    v_exp_f32 v247, v247
KM_it7:
    v_exp_f32 v184, v184
    v_exp_f32 v185, v185
    v_smfmac_f32_32x32x32_bf16 a[200:215], a[188:191], v[240:247], v13
    buffer_load_dwordx4 v[92:95], v1, s[20:23], s30 offen offset:1024 sc1
    v_exp_f32 v186, v186
    v_exp_f32 v187, v187
    v_exp_f32 v188, v188
    v_mfma_f32_32x32x4_2b_bf16 v[216:247], a[192:193], a[246:247], 0
    buffer_load_dwordx4 v[96:99], v1, s[20:23], s30 offen offset:2048 sc1
    v_exp_f32 v189, v189
    v_exp_f32 v190, v190
    v_exp_f32 v191, v191
    v_exp_f32 v192, v192
    v_exp_f32 v193, v193
    v_exp_f32 v194, v194
    v_exp_f32 v195, v195
    v_exp_f32 v196, v196
    v_smfmac_f32_32x32x32_bf16 a[216:231], a[64:67], v[184:191], v13
    buffer_load_dwordx4 v[100:103], v1, s[20:23], s30 offen offset:3072 sc1
    v_exp_f32 v197, v197
    v_exp_f32 v198, v198
    v_exp_f32 v199, v199
    v_exp_f32 v200, v200
    v_exp_f32 v201, v201
    v_smfmac_f32_32x32x32_bf16 a[216:231], a[68:71], v[192:199], v13
    s_add_u32 s30, s27, 122880
    buffer_load_dwordx4 v[104:107], v1, s[20:23], s30 offen offset:0 sc1
    ds_write_b128 v5, a[200:203] offset:0
    v_exp_f32 v202, v202
    v_exp_f32 v203, v203
    v_exp_f32 v204, v204
    v_mfma_f32_32x32x16_bf16 v[216:231], a[8:11], a[240:243], v[216:231]
    ds_write_b128 v5, a[204:207] offset:1024
    v_exp_f32 v205, v205
    v_exp_f32 v206, v206
    v_exp_f32 v207, v207
    v_mfma_f32_32x32x16_bf16 v[232:247], a[12:15], a[240:243], v[232:247]
    buffer_load_dwordx4 v[108:111], v1, s[20:23], s30 offen offset:1024 sc1
    ds_write_b128 v5, a[208:211] offset:2048
    v_exp_f32 v208, v208
    v_exp_f32 v209, v209
    v_exp_f32 v210, v210
    v_smfmac_f32_32x32x32_bf16 a[216:231], a[72:75], v[200:207], v13
    buffer_load_dwordx4 v[112:115], v1, s[20:23], s30 offen offset:2048 sc1
    v_exp_f32 v211, v211
    v_exp_f32 v212, v212
    v_exp_f32 v213, v213
    v_exp_f32 v214, v214
    v_exp_f32 v215, v215
    v_exp_f32 v216, v216
    v_exp_f32 v217, v217
    v_smfmac_f32_32x32x32_bf16 a[216:231], a[76:79], v[208:215], v13
    buffer_load_dwordx4 v[116:119], v1, s[20:23], s30 offen offset:3072 sc1
    v_exp_f32 v218, v218
    v_exp_f32 v219, v219
    v_exp_f32 v220, v220
    v_mfma_f32_32x32x4_2b_bf16 v[184:215], a[194:195], a[244:245], 0
    s_add_u32 s30, s27, 126976
    buffer_load_dwordx4 v[120:123], v1, s[20:23], s30 offen offset:0 sc1
    v_exp_f32 v221, v221
    v_exp_f32 v222, v222
    v_exp_f32 v223, v223
    v_exp_f32 v224, v224
    v_exp_f32 v225, v225
    v_exp_f32 v226, v226
    v_exp_f32 v227, v227
    v_exp_f32 v228, v228
    v_smfmac_f32_32x32x32_bf16 a[216:231], a[80:83], v[216:223], v13
    s_waitcnt vmcnt(17) lgkmcnt(0)
    s_barrier
    buffer_load_dwordx4 v[124:127], v1, s[20:23], s30 offen offset:1024 sc1
    v_exp_f32 v229, v229
    v_exp_f32 v230, v230
    v_exp_f32 v231, v231
    v_exp_f32 v232, v232
    v_exp_f32 v233, v233
    v_smfmac_f32_32x32x32_bf16 a[216:231], a[84:87], v[224:231], v13
    s_add_u32 s30, s27, 147456
    buffer_load_dwordx4 a[0:3], v1, s[20:23], s30 offen offset:0 sc1
    ds_read_b128 v[36:39], v6 offset:0
    ds_read_b128 v[40:43], v6 offset:3072
    v_exp_f32 v234, v234
    v_exp_f32 v235, v235
    v_exp_f32 v236, v236
    v_mfma_f32_32x32x16_bf16 v[184:199], a[16:19], a[240:243], v[184:199]
    v_exp_f32 v237, v237
    v_exp_f32 v238, v238
    v_exp_f32 v239, v239
    v_mfma_f32_32x32x16_bf16 v[200:215], a[20:23], a[240:243], v[200:215]
    buffer_load_dwordx4 a[4:7], v1, s[20:23], s30 offen offset:1024 sc1
    ds_read_b128 v[44:47], v6 offset:6144
    ds_read_b128 v[48:51], v6 offset:9216
    v_exp_f32 v240, v240
    v_exp_f32 v241, v241
    v_exp_f32 v242, v242
    v_smfmac_f32_32x32x32_bf16 a[216:231], a[88:91], v[232:239], v13
    s_cmp_lg_u32 s26, 0
    s_cbranch_scc1 KM_nofl
    s_lshl_b32 s43, s2, 12
    s_add_u32 s43, s43, 41943040
    v_mov_b32 v20, s0
    v_mov_b32 v21, s1
    s_mov_b64 exec, 0xff
    buffer_store_dwordx4 v[20:23], v1, s[20:23], s43 offen sc1
    s_mov_b64 exec, -1
    s_nop 0
KM_nofl:
    buffer_load_dwordx4 a[64:67], v1, s[20:23], s30 offen offset:2048 sc1
    v_exp_f32 v243, v243
    v_exp_f32 v244, v244
    v_exp_f32 v245, v245
    v_exp_f32 v246, v246
    v_exp_f32 v247, v247
    v_exp_f32 v184, v184
    v_exp_f32 v185, v185
    v_smfmac_f32_32x32x32_bf16 a[216:231], a[92:95], v[240:247], v13
    s_waitcnt lgkmcnt(0)
    buffer_load_dwordx4 a[68:71], v1, s[20:23], s30 offen offset:3072 sc1
    v_add_f32 v38, v38, v42
    v_add_f32 v36, v36, v40
    v_add_f32 v37, v37, v41
    v_add_f32 v39, v39, v43
    v_add_f32 v46, v46, v50
    v_add_f32 v44, v44, v48
    v_add_f32 v45, v45, v49
    v_add_f32 v47, v47, v51
    v_add_f32 v38, v38, v46
    v_exp_f32 v186, v186
    v_exp_f32 v187, v187
    v_exp_f32 v188, v188
    v_mfma_f32_32x32x4_2b_bf16 v[216:247], a[194:195], a[246:247], 0
    s_add_u32 s30, s27, 151552
    buffer_load_dwordx4 a[8:11], v1, s[20:23], s30 offen offset:0 sc1
    ds_bpermute_b32 v52, v7, v38
    v_add_f32 v36, v36, v44
    v_add_f32 v37, v37, v45
    v_add_f32 v39, v39, v47
    v_exp_f32 v189, v189
    v_exp_f32 v190, v190
    v_exp_f32 v191, v191
    v_exp_f32 v192, v192
    v_exp_f32 v193, v193
    v_exp_f32 v194, v194
    v_exp_f32 v195, v195
    v_exp_f32 v196, v196
    v_smfmac_f32_32x32x32_bf16 a[216:231], a[96:99], v[184:191], v13
    buffer_load_dwordx4 a[12:15], v1, s[20:23], s30 offen offset:1024 sc1
    v_exp_f32 v197, v197
    v_exp_f32 v198, v198
    v_exp_f32 v199, v199
    v_exp_f32 v200, v200
    v_exp_f32 v201, v201
    v_smfmac_f32_32x32x32_bf16 a[216:231], a[100:103], v[192:199], v13
    s_waitcnt lgkmcnt(0)
    buffer_load_dwordx4 a[72:75], v1, s[20:23], s30 offen offset:2048 sc1
    v_rcp_f32 v54, v52
    v_exp_f32 v202, v202
    v_mul_f32 v36, v36, v54
    v_mul_f32 v37, v37, v54
    v_mul_f32 v38, v38, v54
    v_mul_f32 v39, v39, v54
    v_max3_f32 v14, v14, v52, v54
    v_cvt_pk_bf16_f32 v36, v36, v37
    v_cvt_pk_bf16_f32 v37, v38, v39
    v_exp_f32 v203, v203
    v_exp_f32 v204, v204
    v_mfma_f32_32x32x16_bf16 v[216:231], a[24:27], a[240:243], v[216:231]
    v_exp_f32 v205, v205
    v_exp_f32 v206, v206
    v_exp_f32 v207, v207
    v_mfma_f32_32x32x16_bf16 v[232:247], a[28:31], a[240:243], v[232:247]
    buffer_load_dwordx4 a[76:79], v1, s[20:23], s30 offen offset:3072 sc1
    ds_write_b32 v8, v36 offset:15360
    ds_write_b32 v9, v37 offset:15360
    v_exp_f32 v208, v208
    v_exp_f32 v209, v209
    v_exp_f32 v210, v210
    v_smfmac_f32_32x32x32_bf16 a[216:231], a[104:107], v[200:207], v13
    s_add_u32 s30, s27, 155648
    buffer_load_dwordx4 a[80:83], v1, s[20:23], s30 offen offset:0 sc1
    v_exp_f32 v211, v211
    v_exp_f32 v212, v212
    v_exp_f32 v213, v213
    v_exp_f32 v214, v214
    v_exp_f32 v215, v215
    v_exp_f32 v216, v216
    v_exp_f32 v217, v217
    v_smfmac_f32_32x32x32_bf16 a[216:231], a[108:111], v[208:215], v13
    s_waitcnt lgkmcnt(0)
    s_barrier
    buffer_load_dwordx4 a[84:87], v1, s[20:23], s30 offen offset:1024 sc1
    v_exp_f32 v218, v218
    v_exp_f32 v219, v219
    v_exp_f32 v220, v220
    v_mfma_f32_32x32x4_2b_bf16 v[184:215], a[196:197], a[244:245], 0
    buffer_load_dwordx4 a[16:19], v1, s[20:23], s30 offen offset:2048 sc1
    v_exp_f32 v221, v221
    v_exp_f32 v222, v222
    v_exp_f32 v223, v223
    v_exp_f32 v224, v224
    v_exp_f32 v225, v225
    v_exp_f32 v226, v226
    v_exp_f32 v227, v227
    v_exp_f32 v228, v228
    v_smfmac_f32_32x32x32_bf16 a[216:231], a[112:115], v[216:223], v13
    buffer_load_dwordx4 a[20:23], v1, s[20:23], s30 offen offset:3072 sc1
    ds_read_b128 a[232:235], v12 offset:15360
    ds_read_b128 a[236:239], v12 offset:16384
    v_exp_f32 v229, v229
    v_exp_f32 v230, v230
    v_exp_f32 v231, v231
    v_exp_f32 v232, v232
    v_exp_f32 v233, v233
    v_smfmac_f32_32x32x32_bf16 a[216:231], a[116:119], v[224:231], v13
    s_add_u32 s30, s27, 159744
    buffer_load_dwordx4 a[88:91], v1, s[20:23], s30 offen offset:0 sc1
    v_exp_f32 v234, v234
    v_exp_f32 v235, v235
    v_exp_f32 v236, v236
    v_mfma_f32_32x32x16_bf16 v[184:199], a[32:35], a[240:243], v[184:199]
    v_exp_f32 v237, v237
    v_exp_f32 v238, v238
    v_exp_f32 v239, v239
    v_mfma_f32_32x32x16_bf16 v[200:215], a[36:39], a[240:243], v[200:215]
    buffer_load_dwordx4 a[92:95], v1, s[20:23], s30 offen offset:1024 sc1
    v_exp_f32 v240, v240
    v_exp_f32 v241, v241
    v_exp_f32 v242, v242
    v_smfmac_f32_32x32x32_bf16 a[216:231], a[120:123], v[232:239], v13
    s_branch KO_6
KP_6:
    s_branch KP_10
KO_6:
    buffer_load_dwordx4 a[96:99], v1, s[20:23], s30 offen offset:2048 sc1
    v_exp_f32 v243, v243
    v_exp_f32 v244, v244
    v_exp_f32 v245, v245
    v_exp_f32 v246, v246
    v_exp_f32 v247, v247
    v_exp_f32 v184, v184
    v_exp_f32 v185, v185
    v_smfmac_f32_32x32x32_bf16 a[216:231], a[124:127], v[240:247], v13
    buffer_load_dwordx4 a[100:103], v1, s[20:23], s30 offen offset:3072 sc1
    v_exp_f32 v186, v186
    v_exp_f32 v187, v187
    v_exp_f32 v188, v188
    v_mfma_f32_32x32x4_2b_bf16 v[216:247], a[196:197], a[246:247], 0
    s_add_u32 s30, s27, 163840
    buffer_load_dwordx4 a[24:27], v1, s[20:23], s30 offen offset:0 sc1
    v_exp_f32 v189, v189
    v_exp_f32 v190, v190
    v_exp_f32 v191, v191
    v_exp_f32 v192, v192
    v_exp_f32 v193, v193
    v_exp_f32 v194, v194
    v_exp_f32 v195, v195
    v_exp_f32 v196, v196
    v_smfmac_f32_32x32x32_bf16 a[216:231], a[128:131], v[184:191], v13
    s_waitcnt vmcnt(26) lgkmcnt(0)
    buffer_load_dwordx4 a[28:31], v1, s[20:23], s30 offen offset:1024 sc1
    v_exp_f32 v197, v197
    v_exp_f32 v198, v198
    v_exp_f32 v199, v199
    v_mfma_f32_16x16x32_bf16 v[148:151], v[56:59], a[232:235], v[148:151]
    v_exp_f32 v200, v200
    v_mfma_f32_16x16x32_bf16 v[152:155], v[60:63], a[232:235], v[152:155]
    v_exp_f32 v201, v201
    v_smfmac_f32_32x32x32_bf16 a[216:231], a[132:135], v[192:199], v13
    s_add_u32 s30, s27, 135168
    buffer_load_dwordx4 a[104:107], v1, s[20:23], s30 offen offset:3072 sc1
    v_exp_f32 v202, v202
    v_exp_f32 v203, v203
    v_exp_f32 v204, v204
    v_mfma_f32_32x32x16_bf16 v[216:231], a[40:43], a[240:243], v[216:231]
    v_exp_f32 v205, v205
    v_exp_f32 v206, v206
    v_exp_f32 v207, v207
    v_mfma_f32_32x32x16_bf16 v[232:247], a[44:47], a[240:243], v[232:247]
    s_add_u32 s30, s27, 126976
    buffer_load_dwordx4 v[56:59], v1, s[20:23], s30 offen offset:2048 sc1
    v_exp_f32 v208, v208
    v_exp_f32 v209, v209
    v_exp_f32 v210, v210
    v_smfmac_f32_32x32x32_bf16 a[216:231], a[136:139], v[200:207], v13
    buffer_load_dwordx4 v[60:63], v1, s[20:23], s30 offen offset:3072 sc1
    v_exp_f32 v211, v211
    v_exp_f32 v212, v212
    v_exp_f32 v213, v213
    v_mfma_f32_16x16x32_bf16 v[156:159], v[64:67], a[232:235], v[156:159]
    v_exp_f32 v214, v214
    v_mfma_f32_16x16x32_bf16 v[160:163], v[68:71], a[232:235], v[160:163]
    v_exp_f32 v215, v215
    v_mfma_f32_16x16x32_bf16 v[164:167], v[72:75], a[232:235], v[164:167]
    v_exp_f32 v216, v216
    v_mfma_f32_16x16x32_bf16 v[168:171], v[76:79], a[232:235], v[168:171]
    v_exp_f32 v217, v217
    v_smfmac_f32_32x32x32_bf16 a[216:231], a[140:143], v[208:215], v13
    s_add_u32 s30, s27, 139264
    buffer_load_dwordx4 a[108:111], v1, s[20:23], s30 offen offset:0 sc1
    v_exp_f32 v218, v218
    v_exp_f32 v219, v219
    v_exp_f32 v220, v220
    v_mfma_f32_32x32x4_2b_bf16 v[184:215], a[198:199], a[244:245], 0
    buffer_load_dwordx4 a[112:115], v1, s[20:23], s30 offen offset:1024 sc1
    v_exp_f32 v221, v221
    v_exp_f32 v222, v222
    v_exp_f32 v223, v223
    v_exp_f32 v224, v224
    v_exp_f32 v225, v225
    v_exp_f32 v226, v226
    v_exp_f32 v227, v227
    v_exp_f32 v228, v228
    v_smfmac_f32_32x32x32_bf16 a[216:231], a[144:147], v[216:223], v13
    s_add_u32 s30, s27, 131072
    buffer_load_dwordx4 v[64:67], v1, s[20:23], s30 offen offset:0 sc1
    v_exp_f32 v229, v229
    v_exp_f32 v230, v230
    v_exp_f32 v231, v231
    v_mfma_f32_16x16x32_bf16 v[172:175], v[80:83], a[232:235], v[172:175]
    v_exp_f32 v232, v232
    v_mfma_f32_16x16x32_bf16 v[176:179], v[84:87], a[232:235], v[176:179]
    v_exp_f32 v233, v233
    v_smfmac_f32_32x32x32_bf16 a[216:231], a[148:151], v[224:231], v13
    buffer_load_dwordx4 v[68:71], v1, s[20:23], s30 offen offset:1024 sc1
    v_exp_f32 v234, v234
    v_exp_f32 v235, v235
    v_exp_f32 v236, v236
    v_mfma_f32_32x32x16_bf16 v[184:199], a[48:51], a[240:243], v[184:199]
    v_exp_f32 v237, v237
    v_exp_f32 v238, v238
    v_exp_f32 v239, v239
    v_mfma_f32_32x32x16_bf16 v[200:215], a[52:55], a[240:243], v[200:215]
    buffer_load_dwordx4 v[72:75], v1, s[20:23], s30 offen offset:2048 sc1
    v_exp_f32 v240, v240
    v_exp_f32 v241, v241
    v_exp_f32 v242, v242
    v_smfmac_f32_32x32x32_bf16 a[216:231], a[152:155], v[232:239], v13
    s_waitcnt vmcnt(26)
    buffer_load_dwordx4 v[76:79], v1, s[20:23], s30 offen offset:3072 sc1
    v_exp_f32 v243, v243
    v_exp_f32 v244, v244
    v_exp_f32 v245, v245
    v_mfma_f32_16x16x32_bf16 v[180:183], v[88:91], a[232:235], v[180:183]
    v_exp_f32 v246, v246
    v_mfma_f32_16x16x32_bf16 v[148:151], v[92:95], a[236:239], v[148:151]
    v_exp_f32 v247, v247
    v_mfma_f32_16x16x32_bf16 v[152:155], v[96:99], a[236:239], v[152:155]
    v_exp_f32 v184, v184
    v_mfma_f32_16x16x32_bf16 v[156:159], v[100:103], a[236:239], v[156:159]
    v_exp_f32 v185, v185
    v_smfmac_f32_32x32x32_bf16 a[216:231], a[156:159], v[240:247], v13
    s_add_u32 s30, s27, 139264
    buffer_load_dwordx4 a[116:119], v1, s[20:23], s30 offen offset:2048 sc1
    v_exp_f32 v186, v186
    v_exp_f32 v187, v187
    v_exp_f32 v188, v188
    v_mfma_f32_32x32x4_2b_bf16 v[216:247], a[198:199], a[246:247], 0
    buffer_load_dwordx4 a[32:35], v1, s[20:23], s30 offen offset:3072 sc1
    v_exp_f32 v189, v189
    v_exp_f32 v190, v190
    v_exp_f32 v191, v191
    v_exp_f32 v192, v192
    v_exp_f32 v193, v193
    v_exp_f32 v194, v194
    v_exp_f32 v195, v195
    v_exp_f32 v196, v196
    v_smfmac_f32_32x32x32_bf16 a[216:231], a[160:163], v[184:191], v13
    s_add_u32 s30, s27, 143360
    buffer_load_dwordx4 a[36:39], v1, s[20:23], s30 offen offset:0 sc1
    v_exp_f32 v197, v197
    v_exp_f32 v198, v198
    v_exp_f32 v199, v199
    v_mfma_f32_16x16x32_bf16 v[160:163], v[104:107], a[236:239], v[160:163]
    v_exp_f32 v200, v200
    v_mfma_f32_16x16x32_bf16 v[164:167], v[108:111], a[236:239], v[164:167]
    v_exp_f32 v201, v201
    v_smfmac_f32_32x32x32_bf16 a[216:231], a[164:167], v[192:199], v13
    s_lshl_b32 s43, s25, 12
    s_add_u32 s43, s43, 41943040
    v_and_b32 v22, 31, v0
    v_lshlrev_b32 v22, 15, v22
    s_add_u32 s30, s27, 135168
    buffer_load_dwordx4 v[80:83], v1, s[20:23], s30 offen offset:0 sc1
    v_exp_f32 v202, v202
    v_exp_f32 v203, v203
    v_exp_f32 v204, v204
    v_mfma_f32_32x32x16_bf16 v[216:231], a[56:59], a[240:243], v[216:231]
    v_exp_f32 v205, v205
    v_exp_f32 v206, v206
    v_exp_f32 v207, v207
    v_mfma_f32_32x32x16_bf16 v[232:247], a[60:63], a[240:243], v[232:247]
    buffer_load_dwordx4 v[84:87], v1, s[20:23], s30 offen offset:1024 sc1
    v_exp_f32 v208, v208
    v_exp_f32 v209, v209
    v_exp_f32 v210, v210
    v_smfmac_f32_32x32x32_bf16 a[216:231], a[168:171], v[200:207], v13
    buffer_load_dwordx4 v[88:91], v1, s[20:23], s30 offen offset:2048 sc1
    v_exp_f32 v211, v211
    v_exp_f32 v212, v212
    v_exp_f32 v213, v213
    v_mfma_f32_16x16x32_bf16 v[168:171], v[112:115], a[236:239], v[168:171]
    v_exp_f32 v214, v214
    v_mfma_f32_16x16x32_bf16 v[172:175], v[116:119], a[236:239], v[172:175]
    v_exp_f32 v215, v215
    v_exp_f32 v216, v216
    v_exp_f32 v217, v217
    v_smfmac_f32_32x32x32_bf16 a[216:231], a[172:175], v[208:215], v13
    s_add_u32 s30, s27, 143360
    buffer_load_dwordx4 a[120:123], v1, s[20:23], s30 offen offset:1024 sc1
    v_exp_f32 v218, v218
    v_exp_f32 v219, v219
    v_exp_f32 v220, v220
    v_exp_f32 v221, v221
    v_exp_f32 v222, v222
    v_exp_f32 v223, v223
    v_exp_f32 v224, v224
    v_exp_f32 v225, v225
    v_exp_f32 v226, v226
    v_exp_f32 v227, v227
    v_exp_f32 v228, v228
    v_smfmac_f32_32x32x32_bf16 a[216:231], a[176:179], v[216:223], v13
    buffer_load_dwordx4 a[124:127], v1, s[20:23], s30 offen offset:2048 sc1
    v_exp_f32 v229, v229
    v_exp_f32 v230, v230
    v_exp_f32 v231, v231
    v_mfma_f32_16x16x32_bf16 v[176:179], v[120:123], a[236:239], v[176:179]
    v_exp_f32 v232, v232
    v_mfma_f32_16x16x32_bf16 v[180:183], v[124:127], a[236:239], v[180:183]
    v_exp_f32 v233, v233
    v_smfmac_f32_32x32x32_bf16 a[216:231], a[180:183], v[224:231], v13
    buffer_load_dwordx4 a[128:131], v1, s[20:23], s30 offen offset:3072 sc1
    v_exp_f32 v234, v234
    v_exp_f32 v235, v235
    v_exp_f32 v236, v236
    v_exp_f32 v237, v237
    v_exp_f32 v238, v238
    v_exp_f32 v239, v239
    v_exp_f32 v240, v240
    v_exp_f32 v241, v241
    v_exp_f32 v242, v242
    v_smfmac_f32_32x32x32_bf16 a[216:231], a[184:187], v[232:239], v13
    buffer_load_dwordx2 v[20:21], v22, s[20:23], s43 offen sc1
    v_exp_f32 v243, v243
    v_exp_f32 v244, v244
    v_exp_f32 v245, v245
    v_exp_f32 v246, v246
    v_exp_f32 v247, v247
KM_atail:
    s_lshl_b32 s40, s26, 7
    s_add_u32 s40, s40, 93704
    v_smfmac_f32_32x32x32_bf16 a[216:231], a[188:191], v[240:247], v13
    ds_read_b128 v[136:139], v10 offset:2048
    v_lshl_add_u32 v30, v7, 2, s40
    s_lshl_b32 s40, s26, 2
    s_add_u32 s40, s40, 125440
    v_mov_b32 v53, s40
    s_getpc_b64 s[40:41]
KM_ct1:
    s_lshl2_add_u32 s42, s101, s26
    s_lshl_b32 s42, s42, 7
    s_min_u32 s42, s42, KM_slow-KM_ct1
    s_add_u32 s40, s40, s42
    s_addc_u32 s41, s41, 0
    v_mov_b32 v28, s40
    v_mov_b32 v29, s41
    global_load_dword v28, v[28:29], off
    ds_write_b128 v5, a[216:219] offset:0
    ds_write_b128 v5, a[220:223] offset:1024
    ds_write_b128 v5, a[224:227] offset:2048
    s_waitcnt vmcnt(29) lgkmcnt(3)
    v_mfma_f32_16x16x32_bf16 v[148:151], a[0:3], v[136:139], v[148:151]
    v_mfma_f32_16x16x32_bf16 v[152:155], a[4:7], v[136:139], v[152:155]
    v_mfma_f32_16x16x32_bf16 v[156:159], a[64:67], v[136:139], v[156:159]
    s_waitcnt lgkmcnt(0)
    s_barrier
    ds_read_b32 v32, v30 offset:0
    ds_read_b32 v33, v30 offset:3072
    ds_read_b32 v34, v30 offset:6144
    ds_read_b32 v35, v30 offset:9216
    ds_read_b128 v[36:39], v6 offset:0
    ds_read_b128 v[40:43], v6 offset:3072
    ds_read_b128 v[44:47], v6 offset:6144
    ds_read_b128 v[48:51], v6 offset:9216
    s_waitcnt vmcnt(1)
    v_cmp_ne_u64 vcc, s[0:1], v[20:21]
    v_mfma_f32_16x16x32_bf16 v[160:163], a[68:71], v[136:139], v[160:163]
    v_mfma_f32_16x16x32_bf16 v[164:167], a[8:11], v[136:139], v[164:167]
    v_mfma_f32_16x16x32_bf16 v[168:171], a[12:15], v[136:139], v[168:171]
    s_waitcnt lgkmcnt(4)
    v_add_f32 v32, v32, v33
    v_add_f32 v34, v34, v35
    s_cbranch_vccnz KM_s0spin
KM_s0ok:
    v_add_f32 v52, v32, v34
    v_rcp_f32 v54, v52
    s_add_u32 s36, s55, s32
    buffer_load_dwordx4 v[184:187], v1, s[20:23], s36 offen offset:0 sc1
    s_waitcnt lgkmcnt(0)
    v_add_f32 v38, v38, v42
    v_add_f32 v36, v36, v40
    v_add_f32 v37, v37, v41
    v_add_f32 v39, v39, v43
    v_add_f32 v46, v46, v50
    v_add_f32 v44, v44, v48
    v_add_f32 v45, v45, v49
    v_add_f32 v47, v47, v51
    v_add_f32 v38, v38, v46
    v_add_f32 v36, v36, v44
    v_add_f32 v37, v37, v45
    v_add_f32 v39, v39, v47
    v_max3_f32 v14, v14, v52, v54
    v_cmp_lt_f32 vcc, 0x53800000, v14
    v_mul_f32 v36, v36, v54
    v_mul_f32 v37, v37, v54
    v_mul_f32 v38, v38, v54
    v_mul_f32 v39, v39, v54
    v_cvt_pk_bf16_f32 v36, v36, v37
    v_cvt_pk_bf16_f32 v37, v38, v39
    ds_write_b32 v8, v36 offset:17920
    ds_write_b32 v9, v37 offset:17920
    s_cmp_lg_u64 vcc, 0
    s_cselect_b32 s41, 1, 0
    v_mov_b32 v41, s41
    ds_write_b32 v53, v41
    v_mov_b32 v40, 125440
    v_mfma_f32_16x16x32_bf16 v[172:175], a[72:75], v[136:139], v[172:175]
    buffer_load_dwordx4 v[188:191], v1, s[20:23], s36 offen offset:1024 sc1
    v_mfma_f32_16x16x32_bf16 v[176:179], a[76:79], v[136:139], v[176:179]
    s_waitcnt lgkmcnt(0)
    s_barrier
    ds_read_b128 v[128:131], v12 offset:17920
    ds_read_b128 v[140:143], v10 offset:12288
    ds_read_b128 v[132:135], v12 offset:18944
    ds_read_b128 v[36:39], v40
    v_mfma_f32_16x16x32_bf16 v[180:183], a[80:83], v[136:139], v[180:183]
    buffer_load_dwordx4 v[192:195], v1, s[20:23], s36 offen offset:2048 sc1
    s_and_b32 s40, s2, 1
    s_lshl_b32 s40, s40, 7
    s_lshl2_add_u32 s42, s26, 124928
    s_waitcnt vmcnt(8) lgkmcnt(3)
    v_mfma_f32_16x16x32_bf16 v[148:151], v[56:59], v[128:131], v[148:151]
    v_and_b32 v15, 15, v0
    v_cmp_gt_u32 s[44:45], 8, v15
    v_mfma_f32_16x16x32_bf16 v[152:155], v[60:63], v[128:131], v[152:155]
    v_mov_b32 v25, 1073741824
    v_add_u32 v31, s40, v1
    v_mfma_f32_16x16x32_bf16 v[156:159], v[64:67], v[128:131], v[156:159]
    v_cndmask_b32 v24, v25, v31, s[44:45]
    v_and_b32 v31, 0x18, v0
    v_mfma_f32_16x16x32_bf16 v[160:163], v[68:71], v[128:131], v[160:163]
    v_cmp_eq_u32 s[44:45], 0, v31
    v_lshrrev_b32 v32, 5, v0
    s_add_u32 s36, s36, 3072
    buffer_load_dwordx4 v[196:199], v1, s[20:23], s36 offen offset:0 sc1
    v_mfma_f32_16x16x32_bf16 v[164:167], v[72:75], v[128:131], v[164:167]
    v_lshlrev_b32 v32, 8, v32
    v_lshl_add_u32 v32, v15, 4, v32
    v_mfma_f32_16x16x32_bf16 v[168:171], v[76:79], v[128:131], v[168:171]
    v_add_u32 v31, s40, v32
    v_cndmask_b32 v25, v25, v31, s[44:45]
    v_mfma_f32_16x16x32_bf16 v[172:175], v[80:83], v[128:131], v[172:175]
    v_add_u32 v26, s42, v32
    v_lshlrev_b32 v27, 4, v15
    v_mfma_f32_16x16x32_bf16 v[176:179], v[84:87], v[128:131], v[176:179]
    v_add_u32 v27, 124928, v27
    v_mfma_f32_16x16x32_bf16 v[180:183], v[88:91], v[128:131], v[180:183]
    buffer_load_dwordx4 v[200:203], v1, s[20:23], s36 offen offset:1024 sc1
    s_waitcnt vmcnt(7) lgkmcnt(0)
    v_or3_b32 v36, v36, v37, v38
    v_or_b32 v36, v36, v39
    v_mfma_f32_16x16x32_bf16 v[148:151], a[84:87], v[140:143], v[148:151]
    s_mul_i32 s42, s24, 73728
    v_readfirstlane_b32 s41, v36
    v_mfma_f32_16x16x32_bf16 v[148:151], a[104:107], v[132:135], v[148:151]
    s_bfe_u32 s43, s2, 0x20001
    buffer_load_dwordx4 v[204:207], v1, s[20:23], s36 offen offset:2048 sc1
    v_mfma_f32_16x16x32_bf16 v[152:155], a[16:19], v[140:143], v[152:155]
    s_lshl_b32 s44, s43, 10
    v_mfma_f32_16x16x32_bf16 v[152:155], a[108:111], v[132:135], v[152:155]
    s_add_u32 s44, s44, s42
    s_add_u32 s36, s55, s52
    buffer_load_dwordx4 v[208:211], v1, s[20:23], s36 offen offset:0 sc1
    v_mfma_f32_16x16x32_bf16 v[156:159], a[20:23], v[140:143], v[156:159]
    s_add_u32 s44, s44, 3407872
    v_mfma_f32_16x16x32_bf16 v[156:159], a[112:115], v[132:135], v[156:159]
    s_lshl_b32 s45, s26, 12
    buffer_load_dwordx4 v[212:215], v1, s[20:23], s36 offen offset:1024 sc1
    v_mfma_f32_16x16x32_bf16 v[160:163], a[88:91], v[140:143], v[160:163]
    s_add_u32 s45, s45, s44
    v_add_f32 v40, v148, v149
    v_add_f32 v41, v150, v151
    v_mul_f32 v42, v148, v148
    v_mfma_f32_16x16x32_bf16 v[160:163], a[116:119], v[132:135], v[160:163]
    s_lshr_b32 s46, s26, 1
    buffer_load_dwordx4 v[216:219], v1, s[20:23], s36 offen offset:2048 sc1
    v_mfma_f32_16x16x32_bf16 v[164:167], a[92:95], v[140:143], v[164:167]
    s_lshl_b32 s46, s46, 12
    v_mul_f32 v43, v149, v149
    v_fmac_f32 v42, v150, v150
    v_fmac_f32 v43, v151, v151
    v_mfma_f32_16x16x32_bf16 v[164:167], a[32:35], v[132:135], v[164:167]
    s_add_u32 s46, s46, s44
    s_add_u32 s36, s36, 3072
    buffer_load_dwordx4 v[220:223], v1, s[20:23], s36 offen offset:0 sc1
    v_mfma_f32_16x16x32_bf16 v[168:171], a[96:99], v[140:143], v[168:171]
    s_and_b32 s44, s26, 1
    v_add_f32 v40, v40, v152
    v_fmac_f32 v42, v152, v152
    v_add_f32 v41, v41, v153
    v_mfma_f32_16x16x32_bf16 v[168:171], a[36:39], v[132:135], v[168:171]
    s_lshl_b32 s44, s44, 9
    buffer_load_dwordx4 v[224:227], v1, s[20:23], s36 offen offset:1024 sc1
    v_mfma_f32_16x16x32_bf16 v[172:175], a[100:103], v[140:143], v[172:175]
    s_add_u32 s46, s46, s44
    v_fmac_f32 v43, v153, v153
    v_add_f32 v40, v40, v154
    v_fmac_f32 v42, v154, v154
    v_mfma_f32_16x16x32_bf16 v[172:175], a[120:123], v[132:135], v[172:175]
    s_add_u32 s46, s46, 65536
    v_add_f32 v41, v41, v155
    v_fmac_f32 v43, v155, v155
    v_add_f32 v40, v40, v156
    v_mfma_f32_16x16x32_bf16 v[176:179], a[24:27], v[140:143], v[176:179]
    v_fmac_f32 v42, v156, v156
    v_add_f32 v41, v41, v157
    v_fmac_f32 v43, v157, v157
    v_mfma_f32_16x16x32_bf16 v[176:179], a[124:127], v[132:135], v[176:179]
    v_add_f32 v40, v40, v158
    v_fmac_f32 v42, v158, v158
    v_add_f32 v41, v41, v159
    v_mfma_f32_16x16x32_bf16 v[180:183], a[28:31], v[140:143], v[180:183]
    v_fmac_f32 v43, v159, v159
    v_add_f32 v40, v40, v160
    v_fmac_f32 v42, v160, v160
    v_mfma_f32_16x16x32_bf16 v[180:183], a[128:131], v[132:135], v[180:183]
    v_add_f32 v41, v41, v161
    v_fmac_f32 v43, v161, v161
    v_add_f32 v40, v40, v162
    s_cmp_lg_u32 s41, 0
    s_cbranch_scc1 KM_slow
    v_fmac_f32 v42, v162, v162
    v_add_f32 v41, v41, v163
    v_fmac_f32 v43, v163, v163
    v_add_f32 v40, v40, v164
    v_fmac_f32 v42, v164, v164
    v_add_f32 v41, v41, v165
    v_fmac_f32 v43, v165, v165
    v_add_f32 v40, v40, v166
    v_fmac_f32 v42, v166, v166
    v_add_f32 v41, v41, v167
    v_fmac_f32 v43, v167, v167
    v_add_f32 v40, v40, v168
    v_fmac_f32 v42, v168, v168
    v_add_f32 v41, v41, v169
    v_fmac_f32 v43, v169, v169
    v_add_f32 v40, v40, v170
    v_fmac_f32 v42, v170, v170
    v_add_f32 v41, v41, v171
    v_fmac_f32 v43, v171, v171
KM_ln:
    v_pk_add_f32 v[40:41], v[40:41], v[172:173]
    v_pk_fma_f32 v[42:43], v[172:173], v[172:173], v[42:43]
    v_pk_add_f32 v[40:41], v[40:41], v[174:175]
    v_pk_fma_f32 v[42:43], v[174:175], v[174:175], v[42:43]
    v_pk_add_f32 v[40:41], v[40:41], v[176:177]
    v_pk_fma_f32 v[42:43], v[176:177], v[176:177], v[42:43]
    v_pk_add_f32 v[40:41], v[40:41], v[178:179]
    v_pk_fma_f32 v[42:43], v[178:179], v[178:179], v[42:43]
    v_pk_add_f32 v[40:41], v[40:41], v[180:181]
    v_pk_fma_f32 v[42:43], v[180:181], v[180:181], v[42:43]
    v_pk_add_f32 v[40:41], v[40:41], v[182:183]
    v_pk_fma_f32 v[42:43], v[182:183], v[182:183], v[42:43]
    v_add_f32 v36, v40, v41
    v_add_f32 v38, v42, v43
    buffer_load_dwordx4 v[228:231], v1, s[20:23], s36 offen offset:2048 sc1
    s_nop 0
    v_permlane32_swap_b32 v36, v38
    v_add_f32 v36, v36, v38
    v_add_f32 v37, 0, v36
    s_nop 1
    v_permlane16_swap_b32 v36, v37
    v_add_f32 v36, v36, v37
    ds_write_b32 v26, v36
    s_add_u32 s36, s55, s53
    buffer_load_dwordx4 v[232:235], v1, s[20:23], s36 offen offset:0 sc1
    s_waitcnt lgkmcnt(0)
    s_barrier
    ds_read_b128 v[44:47], v27
    ds_read_b128 v[48:51], v27 offset:256
    buffer_load_dwordx4 v[236:239], v1, s[20:23], s36 offen offset:1024 sc1
    v_mov_b32 v36, 0x3ae38e39
    s_waitcnt lgkmcnt(0)
    v_pk_add_f32 v[44:45], v[44:45], v[46:47]
    v_pk_add_f32 v[48:49], v[48:49], v[50:51]
    v_add_f32 v44, v44, v45
    v_add_f32 v48, v48, v49
    v_mul_f32 v44, v36, v44
    v_mul_f32 v45, v44, v44
    v_fma_f32 v48, v36, v48, -v45
    v_max_f32 v48, 0, v48
    v_add_f32 v48, 0x3727c5ac, v48
    v_rsq_f32 v48, v48
    s_nop 0
    v_mul_f32 v44, -v44, v48
    v_pk_fma_f32 v[88:89], v[180:181], v[48:49], v[44:45] op_sel_hi:[1,0,0]
    v_pk_fma_f32 v[90:91], v[182:183], v[48:49], v[44:45] op_sel_hi:[1,0,0]
    v_cvt_pk_bf16_f32 v108, v88, v89
    v_cvt_pk_bf16_f32 v109, v90, v91
    v_pk_fma_f32 v[56:57], v[148:149], v[48:49], v[44:45] op_sel_hi:[1,0,0]
    v_pk_fma_f32 v[58:59], v[150:151], v[48:49], v[44:45] op_sel_hi:[1,0,0]
    v_cvt_pk_bf16_f32 v92, v56, v57
    v_cvt_pk_bf16_f32 v93, v58, v59
    v_permlane16_swap_b32 v108, v110
    v_permlane16_swap_b32 v109, v111
    buffer_store_dwordx4 v[108:111], v25, s[20:23], s46 offen sc1
    v_pk_fma_f32 v[60:61], v[152:153], v[48:49], v[44:45] op_sel_hi:[1,0,0]
    v_pk_fma_f32 v[62:63], v[154:155], v[48:49], v[44:45] op_sel_hi:[1,0,0]
    v_cvt_pk_bf16_f32 v94, v60, v61
    v_cvt_pk_bf16_f32 v95, v62, v63
    buffer_store_dwordx4 v[92:95], v24, s[20:23], s45 offen sc1
    s_add_u32 s45, s45, 16384
    v_pk_fma_f32 v[64:65], v[156:157], v[48:49], v[44:45] op_sel_hi:[1,0,0]
    v_pk_fma_f32 v[66:67], v[158:159], v[48:49], v[44:45] op_sel_hi:[1,0,0]
    v_cvt_pk_bf16_f32 v96, v64, v65
    v_cvt_pk_bf16_f32 v97, v66, v67
    v_pk_fma_f32 v[68:69], v[160:161], v[48:49], v[44:45] op_sel_hi:[1,0,0]
    v_pk_fma_f32 v[70:71], v[162:163], v[48:49], v[44:45] op_sel_hi:[1,0,0]
    v_cvt_pk_bf16_f32 v98, v68, v69
    v_cvt_pk_bf16_f32 v99, v70, v71
    buffer_store_dwordx4 v[96:99], v24, s[20:23], s45 offen sc1
    s_add_u32 s45, s45, 16384
    v_pk_fma_f32 v[72:73], v[164:165], v[48:49], v[44:45] op_sel_hi:[1,0,0]
    v_pk_fma_f32 v[74:75], v[166:167], v[48:49], v[44:45] op_sel_hi:[1,0,0]
    v_cvt_pk_bf16_f32 v100, v72, v73
    v_cvt_pk_bf16_f32 v101, v74, v75
    v_pk_fma_f32 v[76:77], v[168:169], v[48:49], v[44:45] op_sel_hi:[1,0,0]
    v_pk_fma_f32 v[78:79], v[170:171], v[48:49], v[44:45] op_sel_hi:[1,0,0]
    v_cvt_pk_bf16_f32 v102, v76, v77
    v_cvt_pk_bf16_f32 v103, v78, v79
    buffer_store_dwordx4 v[100:103], v24, s[20:23], s45 offen sc1
    s_add_u32 s45, s45, 16384
    v_pk_fma_f32 v[80:81], v[172:173], v[48:49], v[44:45] op_sel_hi:[1,0,0]
    v_pk_fma_f32 v[82:83], v[174:175], v[48:49], v[44:45] op_sel_hi:[1,0,0]
    v_cvt_pk_bf16_f32 v104, v80, v81
    v_cvt_pk_bf16_f32 v105, v82, v83
    v_pk_fma_f32 v[84:85], v[176:177], v[48:49], v[44:45] op_sel_hi:[1,0,0]
    v_pk_fma_f32 v[86:87], v[178:179], v[48:49], v[44:45] op_sel_hi:[1,0,0]
    v_cvt_pk_bf16_f32 v106, v84, v85
    v_cvt_pk_bf16_f32 v107, v86, v87
    buffer_store_dwordx4 v[104:107], v24, s[20:23], s45 offen sc1
    s_add_u32 s45, s45, 16384
    buffer_load_dwordx4 v[240:243], v1, s[20:23], s36 offen offset:2048 sc1
    v_mov_b32 v132, 0
    v_mov_b32 v133, 0
    v_mov_b32 v134, 0
    v_mov_b32 v135, 0
    v_mov_b32 v136, 0
    v_mov_b32 v137, 0
    v_mov_b32 v138, 0
    v_mov_b32 v139, 0
    v_mov_b32 v140, 0
    v_mov_b32 v141, 0
    v_mov_b32 v142, 0
    v_mov_b32 v143, 0
    v_mov_b32 v144, 0
    v_mov_b32 v145, 0
    v_mov_b32 v146, 0
    v_mov_b32 v147, 0
    s_add_u32 s36, s36, 3072
    buffer_load_dwordx4 v[244:247], v1, s[20:23], s36 offen offset:0 sc1
    v_lshrrev_b32 v3, 4, v0
    v_and_b32 v15, 7, v0
    v_lshl_add_u32 v3, v3, 3, v15
    s_lshl_b32 s40, s26, 12
    s_add_u32 s40, s40, 147456
    v_lshl_add_u32 v3, v3, 4, s40
    s_and_b32 s40, s25, 1
    s_lshl_b32 s40, s40, 3
    s_lshl_b32 s40, 0x00ff00ff, s40
    s_lshr_b32 s41, s25, 1
    buffer_load_dwordx4 v[248:251], v1, s[20:23], s36 offen offset:1024 sc1
    s_cmp_eq_u32 s41, 0
    s_cselect_b32 s8, s40, 0
    s_mov_b32 s9, s8
    s_cmp_eq_u32 s41, 1
    s_cselect_b32 s10, s40, 0
    s_mov_b32 s11, s10
    s_cmp_eq_u32 s41, 2
    s_cselect_b32 s12, s40, 0
    s_mov_b32 s13, s12
    s_cmp_eq_u32 s41, 3
    s_cselect_b32 s14, s40, 0
    s_mov_b32 s15, s14
    buffer_load_dwordx4 v[252:255], v1, s[20:23], s36 offen offset:2048 sc1
    s_mov_b32 s42, 0x00ff00ff
    s_mov_b32 s43, s42
    s_mov_b64 exec, s[42:43]
    ds_write_b128 v3, v[180:183]
    s_mov_b64 exec, s[8:9]
    ds_read_b128 v[132:135], v3
    s_mov_b64 exec, s[10:11]
    ds_read_b128 v[136:139], v3
    s_mov_b64 exec, s[12:13]
    ds_read_b128 v[140:143], v3
    s_mov_b64 exec, s[14:15]
    ds_read_b128 v[144:147], v3
    s_mov_b64 exec, -1
    s_mul_i32 m0, s26, 18432
    s_add_u32 s36, s55, s97
    buffer_load_dwordx4 v1, s[20:23], s36 offen offset:0 sc1 lds
    s_mov_b64 exec, s[42:43]
    ds_write_b128 v3, v[148:151] offset:0
    ds_write_b128 v3, v[152:155] offset:512
    ds_write_b128 v3, v[156:159] offset:1024
    ds_write_b128 v3, v[160:163] offset:1536
    s_mov_b64 exec, -1
    buffer_load_dwordx4 v1, s[20:23], s36 offen offset:1024 sc1 lds
    s_mov_b64 exec, s[42:43]
    ds_write_b128 v3, v[164:167] offset:2048
    ds_write_b128 v3, v[168:171] offset:2560
    ds_write_b128 v3, v[172:175] offset:3072
    ds_write_b128 v3, v[176:179] offset:3584
    s_mov_b64 exec, -1
    buffer_load_dwordx4 v1, s[20:23], s36 offen offset:2048 sc1 lds
    s_add_u32 m0, m0, 3072
    s_add_u32 s36, s36, 3072
    buffer_load_dwordx4 v1, s[20:23], s36 offen offset:0 sc1 lds
    s_lshl_b32 s44, s2, 12
    s_add_u32 s44, s44, 41943168
    s_cmp_lg_u32 s26, 0
    s_waitcnt vmcnt(8)
    s_barrier
    s_cbranch_scc1 KM_nof1
    v_mov_b32 v20, s0
    v_mov_b32 v21, s1
    s_mov_b64 exec, 0xff
    buffer_store_dwordx4 v[20:23], v1, s[20:23], s44 offen sc1
    s_mov_b64 exec, -1
    s_nop 0
KM_nof1:
    buffer_load_dwordx4 v1, s[20:23], s36 offen offset:1024 sc1 lds
    v_mov_b32 v4, 0xc0135761
    v_mov_b32 v5, 0xbdd2d3e8
    v_add_u32 v6, 73728, v1
    v_add_u32 v7, 139264, v1
    s_lshr_b32 s40, s26, 1
    s_lshl_b32 s40, s40, 12
    s_and_b32 s41, s26, 1
    s_lshl3_add_u32 s40, s41, s40
    v_add_u32 v2, s40, v1
    s_mul_i32 s40, s26, 18432
    v_add_u32 v12, s40, v1
    buffer_load_dwordx4 v1, s[20:23], s36 offen offset:2048 sc1 lds
    s_lshl_b32 s40, s24, 15
    s_lshl_b32 s41, s26, 13
    s_add_u32 s46, s40, s41
    s_add_u32 s46, s46, 41943168
    s_add_u32 s40, s40, 41943552
    s_lshr_b32 s41, s25, 1
    s_lshl_b32 s41, s41, 7
    s_add_u32 s33, s40, s41
    s_lshl_b32 s41, s26, 7
    s_add_u32 s30, s40, s41
    s_lshl_b32 s41, s25, 12
    s_add_u32 s29, s30, s41
    v_and_b32 v10, 1, v0
    v_lshlrev_b32 v10, 12, v10
    s_mul_i32 s40, s25, 36
    s_add_u32 s40, s40, s26
    s_mul_i32 s27, s40, 19456
    s_add_u32 s27, s27, 17203200
    s_add_u32 s37, s27, 622592
    s_add_u32 m0, m0, 3072
    s_add_u32 s36, s55, s98
    buffer_load_dwordx4 v1, s[20:23], s36 offen offset:0 sc1 lds
    s_mul_i32 s42, s24, 73728
    s_lshl_b32 s44, s26, 10
    s_add_u32 s45, s42, s44
    s_add_u32 s45, s45, 3407872
    s_add_u32 s44, s44, 73728
    s_mov_b32 s38, 7
    s_add_u32 s41, s42, 23068672
    s_lshl2_add_u32 s40, s25, s26
    s_lshl_b32 s40, s40, 11
    s_add_u32 s34, s41, s40
    buffer_load_dwordx4 v1, s[20:23], s36 offen offset:1024 sc1 lds
    s_mul_i32 s35, s25, 2359296
    s_add_u32 s35, s35, s41
    s_lshl_b32 s40, s26, 11
    s_add_u32 s35, s35, s40
    s_add_u32 s39, s35, 65536
    s_lshl2_add_u32 s40, s25, s26
    s_lshl_b32 s40, s40, 8
    s_add_u32 s47, s41, s40
    s_add_u32 s47, s47, 65536
    s_add_u32 s48, s47, 9436160
    buffer_load_dwordx4 v1, s[20:23], s36 offen offset:2048 sc1 lds
    s_waitcnt lgkmcnt(0)
    v_mov_b32 v148, 0
    v_mov_b32 v149, 0
    v_mov_b32 v150, 0
    v_mov_b32 v151, 0
    v_mov_b32 v152, 0
    v_mov_b32 v153, 0
    v_mov_b32 v154, 0
    v_mov_b32 v155, 0
    v_mov_b32 v156, 0
    v_mov_b32 v157, 0
    v_mov_b32 v158, 0
    v_mov_b32 v159, 0
    s_add_u32 m0, m0, 3072
    s_add_u32 s36, s36, 3072
    buffer_load_dwordx4 v1, s[20:23], s36 offen offset:0 sc1 lds
    v_mov_b32 v160, 0
    v_mov_b32 v161, 0
    v_mov_b32 v162, 0
    v_mov_b32 v163, 0
    v_mov_b32 v164, 0
    v_mov_b32 v165, 0
    v_mov_b32 v166, 0
    v_mov_b32 v167, 0
    v_mov_b32 v168, 0
    v_mov_b32 v169, 0
    v_mov_b32 v170, 0
    v_mov_b32 v171, 0
    buffer_load_dwordx4 v1, s[20:23], s36 offen offset:1024 sc1 lds
    v_lshrrev_b32 v174, 4, v0
    v_and_b32 v175, 15, v0
    s_mov_b32 s40, 2359296
    v_mul_lo_u32 v11, v174, s40
    v_lshl_add_u32 v11, v175, 4, v11
    v_lshrrev_b32 v172, 5, v0
    v_and_b32 v173, 1, v174
    v_mul_u32_u24 v13, 1152, v175
    v_mul_u32_u24 v172, 18432, v172
    v_lshl_add_u32 v172, v173, 2, v172
    v_add_u32 v14, v172, v13
    v_mul_u32_u24 v173, 18432, v173
    v_lshrrev_b32 v172, 5, v0
    v_lshl_add_u32 v172, v172, 4, v173
    v_add_u32 v13, v13, v172
    buffer_load_dwordx4 v1, s[20:23], s36 offen offset:2048 sc1 lds
    buffer_load_dwordx2 v[8:9], v10, s[20:23], s46 offen sc1
    s_add_u32 m0, m0, 3072
    s_add_u32 s36, s55, s99
    buffer_load_dwordx4 v1, s[20:23], s36 offen offset:0 sc1 lds
    buffer_load_dwordx4 v1, s[20:23], s36 offen offset:1024 sc1 lds
    buffer_load_dwordx4 v1, s[20:23], s36 offen offset:2048 sc1 lds
    s_add_u32 m0, m0, 3072
    s_add_u32 s36, s36, 3072
    buffer_load_dwordx4 v1, s[20:23], s36 offen offset:0 sc1 lds
    buffer_load_dwordx4 v1, s[20:23], s36 offen offset:1024 sc1 lds
    buffer_load_dwordx4 v1, s[20:23], s36 offen offset:2048 sc1 lds
    s_branch KO_7
KP_7:
    s_branch KP_back2
KO_7:
    s_waitcnt vmcnt(6)
    v_cmp_ne_u64 vcc, s[0:1], v[8:9]
    s_cbranch_vccz KM_s1_ok
KM_s1:
    buffer_load_dwordx2 v[8:9], v10, s[20:23], s46 offen sc1
    s_waitcnt vmcnt(0)
    v_cmp_ne_u64 vcc, s[0:1], v[8:9]
    s_cbranch_vccz KM_s1_ok
    s_sub_u32 s54, s54, 1
    s_cbranch_scc0 KM_s1
    s_mov_b32 s54, 0
KM_s1_ok:
    s_add_u32 m0, s44, 0
    s_lshl1_add_u32 s40, s32, s45
    buffer_load_dwordx4 v1, s[20:23], s40 offen sc1 lds
    s_add_u32 m0, s44, 4096
    s_add_u32 s40, s40, 4096
    buffer_load_dwordx4 v1, s[20:23], s40 offen sc1 lds
    s_add_u32 m0, s44, 8192
    s_add_u32 s40, s40, 4096
    buffer_load_dwordx4 v1, s[20:23], s40 offen sc1 lds
    s_add_u32 m0, s44, 12288
    s_lshl1_add_u32 s40, s52, s45
    buffer_load_dwordx4 v1, s[20:23], s40 offen sc1 lds
    s_add_u32 m0, s44, 16384
    s_add_u32 s40, s40, 4096
    buffer_load_dwordx4 v1, s[20:23], s40 offen sc1 lds
    s_add_u32 m0, s44, 20480
    s_add_u32 s40, s40, 4096
    buffer_load_dwordx4 v1, s[20:23], s40 offen sc1 lds
    s_add_u32 m0, s44, 24576
    s_lshl1_add_u32 s40, s53, s45
    buffer_load_dwordx4 v1, s[20:23], s40 offen sc1 lds
    s_add_u32 m0, s44, 28672
    s_add_u32 s40, s40, 4096
    buffer_load_dwordx4 v1, s[20:23], s40 offen sc1 lds
    s_waitcnt vmcnt(5)
    s_barrier
    ds_read_b128 a[0:3], v6 offset:0
    ds_read_b128 a[4:7], v6 offset:1024
    ds_read_b128 a[8:11], v6 offset:2048
    ds_read_b128 a[12:15], v6 offset:3072
    ds_read_b128 a[16:19], v6 offset:4096
    ds_read_b128 a[20:23], v6 offset:5120
    ds_read_b128 a[24:27], v6 offset:6144
    ds_read_b128 a[28:31], v6 offset:7168
    ds_read_b128 a[32:35], v6 offset:8192
    ds_read_b128 a[36:39], v6 offset:9216
    ds_read_b128 a[40:43], v6 offset:10240
    ds_read_b128 a[44:47], v6 offset:11264
    s_waitcnt lgkmcnt(0)
    v_mfma_f32_16x16x32_bf16 v[48:51], v[184:187], a[0:3], 0
    v_mfma_f32_16x16x32_bf16 v[48:51], v[188:191], a[16:19], v[48:51]
    s_add_u32 m0, s44, 32768
    s_add_u32 s40, s40, 4096
    buffer_load_dwordx4 v1, s[20:23], s40 offen sc1 lds
    v_mfma_f32_16x16x32_bf16 v[48:51], v[192:195], a[32:35], v[48:51]
    v_mfma_f32_16x16x32_bf16 v[52:55], v[184:187], a[4:7], 0
    v_mfma_f32_16x16x32_bf16 v[52:55], v[188:191], a[20:23], v[52:55]
    s_waitcnt vmcnt(3)
    s_barrier
    ds_read_b128 a[48:51], v6 offset:12288
    v_mfma_f32_16x16x32_bf16 v[52:55], v[192:195], a[36:39], v[52:55]
    s_add_u32 m0, s44, 36864
    s_lshl1_add_u32 s40, s97, s45
    buffer_load_dwordx4 v1, s[20:23], s40 offen sc1 lds
    ds_read_b128 a[52:55], v6 offset:13312
    v_mfma_f32_16x16x32_bf16 v[56:59], v[184:187], a[8:11], 0
    ds_read_b128 a[56:59], v6 offset:14336
    v_mfma_f32_16x16x32_bf16 v[56:59], v[188:191], a[24:27], v[56:59]
    v_mfma_f32_16x16x32_bf16 v[56:59], v[192:195], a[40:43], v[56:59]
    ds_read_b128 a[60:63], v6 offset:15360
    v_mfma_f32_16x16x32_bf16 v[60:63], v[184:187], a[12:15], 0
    s_add_u32 m0, s44, 40960
    s_add_u32 s40, s40, 4096
    buffer_load_dwordx4 v1, s[20:23], s40 offen sc1 lds
    ds_read_b128 a[64:67], v6 offset:16384
    v_mfma_f32_16x16x32_bf16 v[60:63], v[188:191], a[28:31], v[60:63]
    ds_read_b128 a[68:71], v6 offset:17408
    v_mfma_f32_16x16x32_bf16 v[60:63], v[192:195], a[44:47], v[60:63]
    v_mfma_f32_16x16x32_bf16 v[64:67], v[196:199], a[0:3], 0
    ds_read_b128 a[72:75], v6 offset:18432
    v_mfma_f32_16x16x32_bf16 v[64:67], v[200:203], a[16:19], v[64:67]
    s_add_u32 m0, s44, 45056
    s_add_u32 s40, s40, 4096
    buffer_load_dwordx4 v1, s[20:23], s40 offen sc1 lds
    ds_read_b128 a[76:79], v6 offset:19456
    v_mfma_f32_16x16x32_bf16 v[64:67], v[204:207], a[32:35], v[64:67]
    ds_read_b128 a[80:83], v6 offset:20480
    v_mfma_f32_16x16x32_bf16 v[68:71], v[196:199], a[4:7], 0
    ds_read_b128 v[184:187], v12 offset:0
    v_mfma_f32_16x16x32_bf16 v[68:71], v[200:203], a[20:23], v[68:71]
    ds_read_b128 a[84:87], v6 offset:21504
    v_mfma_f32_16x16x32_bf16 v[68:71], v[204:207], a[36:39], v[68:71]
    s_add_u32 m0, s44, 49152
    s_lshl1_add_u32 s40, s98, s45
    buffer_load_dwordx4 v1, s[20:23], s40 offen sc1 lds
    ds_read_b128 a[88:91], v6 offset:22528
    v_mfma_f32_16x16x32_bf16 v[72:75], v[196:199], a[8:11], 0
    ds_read_b128 a[92:95], v6 offset:23552
    v_mfma_f32_16x16x32_bf16 v[72:75], v[200:203], a[24:27], v[72:75]
    ds_read_b128 v[188:191], v12 offset:1024
    v_mfma_f32_16x16x32_bf16 v[72:75], v[204:207], a[40:43], v[72:75]
    v_mfma_f32_16x16x32_bf16 v[76:79], v[196:199], a[12:15], 0
    s_add_u32 m0, s44, 53248
    s_add_u32 s40, s40, 4096
    buffer_load_dwordx4 v1, s[20:23], s40 offen sc1 lds
    v_mfma_f32_16x16x32_bf16 v[76:79], v[200:203], a[28:31], v[76:79]
    v_mfma_f32_16x16x32_bf16 v[76:79], v[204:207], a[44:47], v[76:79]
    ds_read_b128 v[192:195], v12 offset:2048
    s_waitcnt lgkmcnt(1)
    v_mfma_f32_16x16x32_bf16 v[48:51], v[208:211], a[48:51], v[48:51]
    v_mfma_f32_16x16x32_bf16 v[48:51], v[212:215], a[64:67], v[48:51]
    s_add_u32 m0, s44, 57344
    s_add_u32 s40, s40, 4096
    buffer_load_dwordx4 v1, s[20:23], s40 offen sc1 lds
    v_mfma_f32_16x16x32_bf16 v[48:51], v[216:219], a[80:83], v[48:51]
    v_mfma_f32_16x16x32_bf16 v[52:55], v[208:211], a[52:55], v[52:55]
    ds_read_b128 v[196:199], v12 offset:3072
    v_mfma_f32_16x16x32_bf16 v[52:55], v[212:215], a[68:71], v[52:55]
    s_waitcnt vmcnt(6)
    s_barrier
    ds_read_b128 a[96:99], v6 offset:24576
    v_mfma_f32_16x16x32_bf16 v[52:55], v[216:219], a[84:87], v[52:55]
    s_add_u32 m0, s44, 61440
    s_lshl1_add_u32 s40, s99, s45
    buffer_load_dwordx4 v1, s[20:23], s40 offen sc1 lds
    ds_read_b128 a[100:103], v6 offset:25600
    v_mfma_f32_16x16x32_bf16 v[56:59], v[208:211], a[56:59], v[56:59]
    ds_read_b128 a[104:107], v6 offset:26624
    v_mfma_f32_16x16x32_bf16 v[56:59], v[212:215], a[72:75], v[56:59]
    ds_read_b128 v[200:203], v12 offset:4096
    v_mfma_f32_16x16x32_bf16 v[56:59], v[216:219], a[88:91], v[56:59]
    ds_read_b128 a[108:111], v6 offset:27648
    v_mfma_f32_16x16x32_bf16 v[60:63], v[208:211], a[60:63], v[60:63]
    s_add_u32 m0, s44, 65536
    s_add_u32 s40, s40, 4096
    buffer_load_dwordx4 v1, s[20:23], s40 offen sc1 lds
    ds_read_b128 a[112:115], v6 offset:28672
    v_mfma_f32_16x16x32_bf16 v[60:63], v[212:215], a[76:79], v[60:63]
    ds_read_b128 a[116:119], v6 offset:29696
    v_mfma_f32_16x16x32_bf16 v[60:63], v[216:219], a[92:95], v[60:63]
    ds_read_b128 v[204:207], v12 offset:5120
    v_mfma_f32_16x16x32_bf16 v[64:67], v[220:223], a[48:51], v[64:67]
    ds_read_b128 a[120:123], v6 offset:30720
    v_mfma_f32_16x16x32_bf16 v[64:67], v[224:227], a[64:67], v[64:67]
    s_add_u32 m0, s44, 69632
    s_add_u32 s40, s40, 4096
    buffer_load_dwordx4 v1, s[20:23], s40 offen sc1 lds
    ds_read_b128 a[124:127], v6 offset:31744
    v_mfma_f32_16x16x32_bf16 v[64:67], v[228:231], a[80:83], v[64:67]
    ds_read_b128 a[128:131], v6 offset:32768
    v_mfma_f32_16x16x32_bf16 v[68:71], v[220:223], a[52:55], v[68:71]
    ds_read_b128 v[208:211], v12 offset:6144
    v_mfma_f32_16x16x32_bf16 v[68:71], v[224:227], a[68:71], v[68:71]
    ds_read_b128 a[132:135], v6 offset:33792
    v_mfma_f32_16x16x32_bf16 v[68:71], v[228:231], a[84:87], v[68:71]
    ds_read_b128 a[136:139], v6 offset:34816
    v_mfma_f32_16x16x32_bf16 v[72:75], v[220:223], a[56:59], v[72:75]
    ds_read_b128 a[140:143], v6 offset:35840
    v_mfma_f32_16x16x32_bf16 v[72:75], v[224:227], a[72:75], v[72:75]
    ds_read_b128 v[212:215], v12 offset:7168
    v_mfma_f32_16x16x32_bf16 v[72:75], v[228:231], a[88:91], v[72:75]
    v_mfma_f32_16x16x32_bf16 v[76:79], v[220:223], a[60:63], v[76:79]
    v_mfma_f32_16x16x32_bf16 v[76:79], v[224:227], a[76:79], v[76:79]
    v_mfma_f32_16x16x32_bf16 v[76:79], v[228:231], a[92:95], v[76:79]
    ds_read_b128 v[216:219], v12 offset:8192
    s_waitcnt lgkmcnt(1)
    v_mfma_f32_16x16x32_bf16 v[48:51], v[232:235], a[96:99], v[48:51]
    v_mfma_f32_16x16x32_bf16 v[48:51], v[236:239], a[112:115], v[48:51]
    v_mfma_f32_16x16x32_bf16 v[48:51], v[240:243], a[128:131], v[48:51]
    v_mfma_f32_16x16x32_bf16 v[52:55], v[232:235], a[100:103], v[52:55]
    ds_read_b128 v[220:223], v12 offset:9216
    v_mfma_f32_16x16x32_bf16 v[52:55], v[236:239], a[116:119], v[52:55]
    s_waitcnt vmcnt(6)
    s_barrier
    ds_read_b128 a[144:147], v6 offset:36864
    v_mfma_f32_16x16x32_bf16 v[52:55], v[240:243], a[132:135], v[52:55]
    ds_read_b128 a[148:151], v6 offset:37888
    v_mfma_f32_16x16x32_bf16 v[56:59], v[232:235], a[104:107], v[56:59]
    ds_read_b128 a[152:155], v6 offset:38912
    v_mfma_f32_16x16x32_bf16 v[56:59], v[236:239], a[120:123], v[56:59]
    ds_read_b128 v[224:227], v12 offset:10240
    v_mfma_f32_16x16x32_bf16 v[56:59], v[240:243], a[136:139], v[56:59]
    ds_read_b128 a[156:159], v6 offset:39936
    v_mfma_f32_16x16x32_bf16 v[60:63], v[232:235], a[108:111], v[60:63]
    ds_read_b128 a[160:163], v6 offset:40960
    v_mfma_f32_16x16x32_bf16 v[60:63], v[236:239], a[124:127], v[60:63]
    ds_read_b128 a[164:167], v6 offset:41984
    v_mfma_f32_16x16x32_bf16 v[60:63], v[240:243], a[140:143], v[60:63]
    ds_read_b128 v[228:231], v12 offset:11264
    v_mfma_f32_16x16x32_bf16 v[64:67], v[244:247], a[96:99], v[64:67]
    ds_read_b128 a[168:171], v6 offset:43008
    v_mfma_f32_16x16x32_bf16 v[64:67], v[248:251], a[112:115], v[64:67]
    ds_read_b128 a[172:175], v6 offset:44032
    v_mfma_f32_16x16x32_bf16 v[64:67], v[252:255], a[128:131], v[64:67]
    ds_read_b128 a[176:179], v6 offset:45056
    v_mfma_f32_16x16x32_bf16 v[68:71], v[244:247], a[100:103], v[68:71]
    ds_read_b128 v[232:235], v12 offset:12288
    v_mfma_f32_16x16x32_bf16 v[68:71], v[248:251], a[116:119], v[68:71]
    ds_read_b128 a[180:183], v6 offset:46080
    v_mfma_f32_16x16x32_bf16 v[68:71], v[252:255], a[132:135], v[68:71]
    ds_read_b128 a[184:187], v6 offset:47104
    v_mfma_f32_16x16x32_bf16 v[72:75], v[244:247], a[104:107], v[72:75]
    ds_read_b128 a[188:191], v6 offset:48128
    v_mfma_f32_16x16x32_bf16 v[72:75], v[248:251], a[120:123], v[72:75]
    ds_read_b128 v[236:239], v12 offset:13312
    v_mfma_f32_16x16x32_bf16 v[72:75], v[252:255], a[136:139], v[72:75]
    v_mfma_f32_16x16x32_bf16 v[76:79], v[244:247], a[108:111], v[76:79]
    v_mfma_f32_16x16x32_bf16 v[76:79], v[248:251], a[124:127], v[76:79]
    v_mfma_f32_16x16x32_bf16 v[76:79], v[252:255], a[140:143], v[76:79]
    ds_read_b128 v[240:243], v12 offset:14336
    s_waitcnt lgkmcnt(1)
    v_mfma_f32_16x16x32_bf16 v[48:51], v[184:187], a[144:147], v[48:51]
    v_mfma_f32_16x16x32_bf16 v[48:51], v[188:191], a[160:163], v[48:51]
    v_mfma_f32_16x16x32_bf16 v[48:51], v[192:195], a[176:179], v[48:51]
    v_mfma_f32_16x16x32_bf16 v[52:55], v[184:187], a[148:151], v[52:55]
    ds_read_b128 v[244:247], v12 offset:15360
    v_mfma_f32_16x16x32_bf16 v[52:55], v[188:191], a[164:167], v[52:55]
    s_waitcnt vmcnt(3)
    s_barrier
    ds_read_b128 a[192:195], v6 offset:49152
    v_mfma_f32_16x16x32_bf16 v[52:55], v[192:195], a[180:183], v[52:55]
    s_add_u32 s55, s55, 151552
    ds_read_b128 a[196:199], v6 offset:50176
    v_mfma_f32_16x16x32_bf16 v[56:59], v[184:187], a[152:155], v[56:59]
    ds_read_b128 a[200:203], v6 offset:51200
    v_mfma_f32_16x16x32_bf16 v[56:59], v[188:191], a[168:171], v[56:59]
    ds_read_b128 v[248:251], v12 offset:16384
    v_mfma_f32_16x16x32_bf16 v[56:59], v[192:195], a[184:187], v[56:59]
    ds_read_b128 a[204:207], v6 offset:52224
    v_mfma_f32_16x16x32_bf16 v[60:63], v[184:187], a[156:159], v[60:63]
    ds_read_b128 a[208:211], v6 offset:53248
    v_mfma_f32_16x16x32_bf16 v[60:63], v[188:191], a[172:175], v[60:63]
    ds_read_b128 a[212:215], v6 offset:54272
    v_mfma_f32_16x16x32_bf16 v[60:63], v[192:195], a[188:191], v[60:63]
    ds_read_b128 v[252:255], v12 offset:17408
    v_mfma_f32_16x16x32_bf16 v[64:67], v[196:199], a[144:147], v[64:67]
    s_add_u32 s36, s55, s32
    ds_read_b128 a[216:219], v6 offset:55296
    v_mfma_f32_16x16x32_bf16 v[64:67], v[200:203], a[160:163], v[64:67]
    ds_read_b128 a[220:223], v6 offset:56320
    v_mfma_f32_16x16x32_bf16 v[64:67], v[204:207], a[176:179], v[64:67]
    ds_read_b128 a[224:227], v6 offset:57344
    v_mfma_f32_16x16x32_bf16 v[68:71], v[196:199], a[148:151], v[68:71]
    buffer_load_dwordx4 v[184:187], v1, s[20:23], s36 offen offset:0 sc1
    v_mfma_f32_16x16x32_bf16 v[68:71], v[200:203], a[164:167], v[68:71]
    ds_read_b128 a[228:231], v6 offset:58368
    v_mfma_f32_16x16x32_bf16 v[68:71], v[204:207], a[180:183], v[68:71]
    ds_read_b128 a[232:235], v6 offset:59392
    v_mfma_f32_16x16x32_bf16 v[72:75], v[196:199], a[152:155], v[72:75]
    ds_read_b128 a[236:239], v6 offset:60416
    v_mfma_f32_16x16x32_bf16 v[72:75], v[200:203], a[168:171], v[72:75]
    buffer_load_dwordx4 v[188:191], v1, s[20:23], s36 offen offset:1024 sc1
    v_mfma_f32_16x16x32_bf16 v[72:75], v[204:207], a[184:187], v[72:75]
    v_mfma_f32_16x16x32_bf16 v[76:79], v[196:199], a[156:159], v[76:79]
    v_mfma_f32_16x16x32_bf16 v[76:79], v[200:203], a[172:175], v[76:79]
    v_mfma_f32_16x16x32_bf16 v[76:79], v[204:207], a[188:191], v[76:79]
    buffer_load_dwordx4 v[192:195], v1, s[20:23], s36 offen offset:2048 sc1
    s_waitcnt lgkmcnt(0)
    v_mfma_f32_16x16x32_bf16 v[48:51], v[208:211], a[192:195], v[48:51]
    s_add_u32 s36, s36, 3072
    v_mfma_f32_16x16x32_bf16 v[48:51], v[212:215], a[208:211], v[48:51]
    v_mfma_f32_16x16x32_bf16 v[48:51], v[216:219], a[224:227], v[48:51]
    v_mfma_f32_16x16x32_bf16 v[52:55], v[208:211], a[196:199], v[52:55]
    buffer_load_dwordx4 v[196:199], v1, s[20:23], s36 offen offset:0 sc1
    v_mfma_f32_16x16x32_bf16 v[52:55], v[212:215], a[212:215], v[52:55]
    s_waitcnt vmcnt(4)
    s_barrier
    ds_read_b128 a[240:243], v6 offset:61440
    v_mfma_f32_16x16x32_bf16 v[52:55], v[216:219], a[228:231], v[52:55]
    ds_read_b128 a[244:247], v6 offset:62464
    v_mfma_f32_16x16x32_bf16 v[56:59], v[208:211], a[200:203], v[56:59]
    ds_read_b128 a[248:251], v6 offset:63488
    v_mfma_f32_16x16x32_bf16 v[56:59], v[212:215], a[216:219], v[56:59]
    buffer_load_dwordx4 v[200:203], v1, s[20:23], s36 offen offset:1024 sc1
    v_mfma_f32_16x16x32_bf16 v[56:59], v[216:219], a[232:235], v[56:59]
    ds_read_b128 a[252:255], v6 offset:64512
    v_mfma_f32_16x16x32_bf16 v[60:63], v[208:211], a[204:207], v[60:63]
    ds_read_b128 v[16:19], v7 offset:0
    v_mfma_f32_16x16x32_bf16 v[60:63], v[212:215], a[220:223], v[60:63]
    ds_read_b128 v[20:23], v7 offset:1024
    v_mfma_f32_16x16x32_bf16 v[60:63], v[216:219], a[236:239], v[60:63]
    buffer_load_dwordx4 v[204:207], v1, s[20:23], s36 offen offset:2048 sc1
    v_mfma_f32_16x16x32_bf16 v[64:67], v[220:223], a[192:195], v[64:67]
    s_add_u32 s36, s55, s52
    ds_read_b128 v[24:27], v7 offset:2048
    v_mfma_f32_16x16x32_bf16 v[64:67], v[224:227], a[208:211], v[64:67]
    ds_read_b128 v[28:31], v7 offset:3072
    v_mfma_f32_16x16x32_bf16 v[64:67], v[228:231], a[224:227], v[64:67]
    ds_read_b128 v[32:35], v7 offset:4096
    v_mfma_f32_16x16x32_bf16 v[68:71], v[220:223], a[196:199], v[68:71]
    buffer_load_dwordx4 v[208:211], v1, s[20:23], s36 offen offset:0 sc1
    v_mfma_f32_16x16x32_bf16 v[68:71], v[224:227], a[212:215], v[68:71]
    ds_read_b128 v[36:39], v7 offset:5120
    v_mfma_f32_16x16x32_bf16 v[68:71], v[228:231], a[228:231], v[68:71]
    ds_read_b128 v[40:43], v7 offset:6144
    v_mfma_f32_16x16x32_bf16 v[72:75], v[220:223], a[200:203], v[72:75]
    ds_read_b128 v[44:47], v7 offset:7168
    v_mfma_f32_16x16x32_bf16 v[72:75], v[224:227], a[216:219], v[72:75]
    buffer_load_dwordx4 v[212:215], v1, s[20:23], s36 offen offset:1024 sc1
    v_mfma_f32_16x16x32_bf16 v[72:75], v[228:231], a[232:235], v[72:75]
    v_mfma_f32_16x16x32_bf16 v[76:79], v[220:223], a[204:207], v[76:79]
    v_mfma_f32_16x16x32_bf16 v[76:79], v[224:227], a[220:223], v[76:79]
    v_mfma_f32_16x16x32_bf16 v[76:79], v[228:231], a[236:239], v[76:79]
    buffer_load_dwordx4 v[216:219], v1, s[20:23], s36 offen offset:2048 sc1
    s_waitcnt lgkmcnt(0)
    v_mfma_f32_16x16x32_bf16 v[48:51], v[232:235], a[240:243], v[48:51]
    s_add_u32 s36, s36, 3072
    v_mfma_f32_16x16x32_bf16 v[48:51], v[236:239], v[16:19], v[48:51]
    v_mfma_f32_16x16x32_bf16 v[80:83], v[240:243], v[32:35], v[48:51]
    v_mfma_f32_16x16x32_bf16 v[52:55], v[232:235], a[244:247], v[52:55]
    buffer_load_dwordx4 v[220:223], v1, s[20:23], s36 offen offset:0 sc1
    v_mfma_f32_16x16x32_bf16 v[52:55], v[236:239], v[20:23], v[52:55]
    v_mfma_f32_16x16x32_bf16 v[84:87], v[240:243], v[36:39], v[52:55]
    v_mfma_f32_16x16x32_bf16 v[56:59], v[232:235], a[248:251], v[56:59]
    v_mfma_f32_16x16x32_bf16 v[56:59], v[236:239], v[24:27], v[56:59]
    buffer_load_dwordx4 v[224:227], v1, s[20:23], s36 offen offset:1024 sc1
    v_mfma_f32_16x16x32_bf16 v[88:91], v[240:243], v[40:43], v[56:59]
    v_mfma_f32_16x16x32_bf16 v[60:63], v[232:235], a[252:255], v[60:63]
    v_mfma_f32_16x16x32_bf16 v[60:63], v[236:239], v[28:31], v[60:63]
    v_mfma_f32_16x16x32_bf16 v[92:95], v[240:243], v[44:47], v[60:63]
    buffer_load_dwordx4 v[228:231], v1, s[20:23], s36 offen offset:2048 sc1
    v_mfma_f32_16x16x32_bf16 v[64:67], v[244:247], a[240:243], v[64:67]
    s_add_u32 s36, s55, s53
    v_mfma_f32_16x16x32_bf16 v[64:67], v[248:251], v[16:19], v[64:67]
    v_mfma_f32_16x16x32_bf16 v[96:99], v[252:255], v[32:35], v[64:67]
    v_mfma_f32_16x16x32_bf16 v[68:71], v[244:247], a[244:247], v[68:71]
    buffer_load_dwordx4 v[232:235], v1, s[20:23], s36 offen offset:0 sc1
    v_mfma_f32_16x16x32_bf16 v[68:71], v[248:251], v[20:23], v[68:71]
    v_mfma_f32_16x16x32_bf16 v[100:103], v[252:255], v[36:39], v[68:71]
    v_subrev_u32 v6, 73728, v6
    v_subrev_u32 v7, 73728, v7
    v_mfma_f32_16x16x32_bf16 v[72:75], v[244:247], a[248:251], v[72:75]
    v_mfma_f32_16x16x32_bf16 v[72:75], v[248:251], v[24:27], v[72:75]
    buffer_load_dwordx4 v[236:239], v1, s[20:23], s36 offen offset:1024 sc1
    v_mfma_f32_16x16x32_bf16 v[104:107], v[252:255], v[40:43], v[72:75]
    s_getpc_b64 s[40:41]
KM_ct2:
    s_lshl2_add_u32 s42, s101, s26
    s_lshl_b32 s42, s42, 7
    s_min_u32 s42, s42, KM_slow-KM_ct2
    s_add_u32 s40, s40, s42
    s_addc_u32 s41, s41, 0
    v_mov_b32 v172, s40
    v_mov_b32 v173, s41
    global_load_dword v172, v[172:173], off
    v_mfma_f32_16x16x32_bf16 v[76:79], v[244:247], a[252:255], v[76:79]
    v_mfma_f32_16x16x32_bf16 v[76:79], v[248:251], v[28:31], v[76:79]
    s_waitcnt vmcnt(12)
    v_mfma_f32_16x16x32_bf16 v[108:111], v[252:255], v[44:47], v[76:79]
    buffer_load_dwordx4 v[240:243], v1, s[20:23], s36 offen offset:2048 sc1
KM_p1:
    v_mfma_f32_16x16x32_bf16 v[48:51], v[184:187], a[0:3], 0
    s_add_u32 s36, s36, 3072
    v_mfma_f32_16x16x32_bf16 v[48:51], v[188:191], a[16:19], v[48:51]
    v_mfma_f32_16x16x32_bf16 v[48:51], v[192:195], a[32:35], v[48:51]
    v_mfma_f32_16x16x32_bf16 v[52:55], v[184:187], a[4:7], 0
    buffer_load_dwordx4 v[244:247], v1, s[20:23], s36 offen offset:0 sc1
    v_mfma_f32_16x16x32_bf16 v[52:55], v[188:191], a[20:23], v[52:55]
    v_mul_f32 v112, v80, v80
    v_mul_f32 v113, v81, v81
    v_mfma_f32_16x16x32_bf16 v[52:55], v[192:195], a[36:39], v[52:55]
    v_mul_f32 v114, v82, v82
    v_mul_f32 v115, v83, v83
    v_mfma_f32_16x16x32_bf16 v[56:59], v[184:187], a[8:11], 0
    v_fma_f32 v112, v112, v5, v4
    v_fma_f32 v113, v113, v5, v4
    v_mfma_f32_16x16x32_bf16 v[56:59], v[188:191], a[24:27], v[56:59]
    buffer_load_dwordx4 v[248:251], v1, s[20:23], s36 offen offset:1024 sc1
    v_mfma_f32_16x16x32_bf16 v[56:59], v[192:195], a[40:43], v[56:59]
    v_fma_f32 v114, v114, v5, v4
    v_fma_f32 v115, v115, v5, v4
    v_mfma_f32_16x16x32_bf16 v[60:63], v[184:187], a[12:15], 0
    v_mul_f32 v112, v112, v80
    v_mul_f32 v113, v113, v81
    v_mfma_f32_16x16x32_bf16 v[60:63], v[188:191], a[28:31], v[60:63]
    s_waitcnt vmcnt(11)
    v_mul_f32 v114, v114, v82
    v_mul_f32 v115, v115, v83
    v_mfma_f32_16x16x32_bf16 v[60:63], v[192:195], a[44:47], v[60:63]
    buffer_load_dwordx4 v[252:255], v1, s[20:23], s36 offen offset:2048 sc1
    v_mfma_f32_16x16x32_bf16 v[64:67], v[196:199], a[0:3], 0
    s_add_u32 s36, s55, s97
    v_exp_f32 v112, v112
    v_mfma_f32_16x16x32_bf16 v[64:67], v[200:203], a[16:19], v[64:67]
    v_exp_f32 v113, v113
    v_mfma_f32_16x16x32_bf16 v[64:67], v[204:207], a[32:35], v[64:67]
    v_exp_f32 v114, v114
    v_mfma_f32_16x16x32_bf16 v[68:71], v[196:199], a[4:7], 0
    buffer_load_dwordx4 v[184:187], v1, s[20:23], s36 offen offset:0 sc1
    v_mfma_f32_16x16x32_bf16 v[68:71], v[200:203], a[20:23], v[68:71]
    v_exp_f32 v115, v115
    v_mfma_f32_16x16x32_bf16 v[68:71], v[204:207], a[36:39], v[68:71]
    v_mul_f32 v116, v80, v96
    v_mfma_f32_16x16x32_bf16 v[72:75], v[196:199], a[8:11], 0
    v_mul_f32 v117, v81, v97
    v_mul_f32 v118, v82, v98
    v_mfma_f32_16x16x32_bf16 v[72:75], v[200:203], a[24:27], v[72:75]
    buffer_load_dwordx4 v[188:191], v1, s[20:23], s36 offen offset:1024 sc1
    v_mfma_f32_16x16x32_bf16 v[72:75], v[204:207], a[40:43], v[72:75]
    v_mul_f32 v119, v83, v99
    v_mfma_f32_16x16x32_bf16 v[76:79], v[196:199], a[12:15], 0
    v_add_f32 v112, 1.0, v112
    v_add_f32 v113, 1.0, v113
    v_mfma_f32_16x16x32_bf16 v[76:79], v[200:203], a[28:31], v[76:79]
    s_waitcnt vmcnt(11)
    v_add_f32 v114, 1.0, v114
    v_add_f32 v115, 1.0, v115
    v_mfma_f32_16x16x32_bf16 v[76:79], v[204:207], a[44:47], v[76:79]
    buffer_load_dwordx4 v[192:195], v1, s[20:23], s36 offen offset:2048 sc1
    v_mfma_f32_16x16x32_bf16 v[48:51], v[208:211], a[48:51], v[48:51]
    s_add_u32 s36, s36, 3072
    v_rcp_f32 v112, v112
    v_mfma_f32_16x16x32_bf16 v[48:51], v[212:215], a[64:67], v[48:51]
    v_rcp_f32 v113, v113
    v_mfma_f32_16x16x32_bf16 v[48:51], v[216:219], a[80:83], v[48:51]
    v_rcp_f32 v114, v114
    v_mfma_f32_16x16x32_bf16 v[52:55], v[208:211], a[52:55], v[52:55]
    buffer_load_dwordx4 v[196:199], v1, s[20:23], s36 offen offset:0 sc1
    v_mfma_f32_16x16x32_bf16 v[52:55], v[212:215], a[68:71], v[52:55]
    v_rcp_f32 v115, v115
    v_mfma_f32_16x16x32_bf16 v[52:55], v[216:219], a[84:87], v[52:55]
    v_mul_f32 v116, v116, v112
    v_mfma_f32_16x16x32_bf16 v[56:59], v[208:211], a[56:59], v[56:59]
    v_mul_f32 v117, v117, v113
    v_mul_f32 v118, v118, v114
    v_mfma_f32_16x16x32_bf16 v[56:59], v[212:215], a[72:75], v[56:59]
    buffer_load_dwordx4 v[200:203], v1, s[20:23], s36 offen offset:1024 sc1
    v_mfma_f32_16x16x32_bf16 v[56:59], v[216:219], a[88:91], v[56:59]
    v_mul_f32 v119, v119, v115
    v_cvt_pk_bf16_f32 v128, v116, v117
    v_mfma_f32_16x16x32_bf16 v[60:63], v[208:211], a[60:63], v[60:63]
    v_cvt_pk_bf16_f32 v129, v118, v119
    v_mfma_f32_16x16x32_bf16 v[60:63], v[212:215], a[76:79], v[60:63]
    s_waitcnt vmcnt(11)
    ds_write_b64 v2, v[128:129] offset:0
    v_mfma_f32_16x16x32_bf16 v[60:63], v[216:219], a[92:95], v[60:63]
    buffer_load_dwordx4 v[204:207], v1, s[20:23], s36 offen offset:2048 sc1
    v_mfma_f32_16x16x32_bf16 v[64:67], v[220:223], a[48:51], v[64:67]
    s_add_u32 s36, s55, s98
    v_mul_f32 v120, v84, v84
    v_mul_f32 v121, v85, v85
    v_mfma_f32_16x16x32_bf16 v[64:67], v[224:227], a[64:67], v[64:67]
    v_mul_f32 v122, v86, v86
    v_mul_f32 v123, v87, v87
    v_mfma_f32_16x16x32_bf16 v[64:67], v[228:231], a[80:83], v[64:67]
    v_fma_f32 v120, v120, v5, v4
    v_fma_f32 v121, v121, v5, v4
    v_mfma_f32_16x16x32_bf16 v[68:71], v[220:223], a[52:55], v[68:71]
    buffer_load_dwordx4 v[208:211], v1, s[20:23], s36 offen offset:0 sc1
    v_mfma_f32_16x16x32_bf16 v[68:71], v[224:227], a[68:71], v[68:71]
    v_fma_f32 v122, v122, v5, v4
    v_fma_f32 v123, v123, v5, v4
    v_mfma_f32_16x16x32_bf16 v[68:71], v[228:231], a[84:87], v[68:71]
    v_mul_f32 v120, v120, v84
    v_mul_f32 v121, v121, v85
    v_mfma_f32_16x16x32_bf16 v[72:75], v[220:223], a[56:59], v[72:75]
    v_mul_f32 v122, v122, v86
    v_mul_f32 v123, v123, v87
    v_mfma_f32_16x16x32_bf16 v[72:75], v[224:227], a[72:75], v[72:75]
    buffer_load_dwordx4 v[212:215], v1, s[20:23], s36 offen offset:1024 sc1
    v_mfma_f32_16x16x32_bf16 v[72:75], v[228:231], a[88:91], v[72:75]
    v_exp_f32 v120, v120
    v_mfma_f32_16x16x32_bf16 v[76:79], v[220:223], a[60:63], v[76:79]
    v_exp_f32 v121, v121
    v_mfma_f32_16x16x32_bf16 v[76:79], v[224:227], a[76:79], v[76:79]
    s_waitcnt vmcnt(11)
    v_exp_f32 v122, v122
    v_mfma_f32_16x16x32_bf16 v[76:79], v[228:231], a[92:95], v[76:79]
    buffer_load_dwordx4 v[216:219], v1, s[20:23], s36 offen offset:2048 sc1
    v_mfma_f32_16x16x32_bf16 v[48:51], v[232:235], a[96:99], v[48:51]
    s_add_u32 s36, s36, 3072
    v_exp_f32 v123, v123
    v_mfma_f32_16x16x32_bf16 v[48:51], v[236:239], a[112:115], v[48:51]
    v_mul_f32 v124, v84, v100
    v_mfma_f32_16x16x32_bf16 v[48:51], v[240:243], a[128:131], v[48:51]
    v_mul_f32 v125, v85, v101
    v_mul_f32 v126, v86, v102
    v_mfma_f32_16x16x32_bf16 v[52:55], v[232:235], a[100:103], v[52:55]
    buffer_load_dwordx4 v[220:223], v1, s[20:23], s36 offen offset:0 sc1
    v_mfma_f32_16x16x32_bf16 v[52:55], v[236:239], a[116:119], v[52:55]
    v_mul_f32 v127, v87, v103
    v_add_f32 v120, 1.0, v120
    v_mfma_f32_16x16x32_bf16 v[52:55], v[240:243], a[132:135], v[52:55]
    v_add_f32 v121, 1.0, v121
    v_add_f32 v122, 1.0, v122
    v_mfma_f32_16x16x32_bf16 v[56:59], v[232:235], a[104:107], v[56:59]
    v_add_f32 v123, 1.0, v123
    v_mfma_f32_16x16x32_bf16 v[56:59], v[236:239], a[120:123], v[56:59]
    buffer_load_dwordx4 v[224:227], v1, s[20:23], s36 offen offset:1024 sc1
    v_mfma_f32_16x16x32_bf16 v[56:59], v[240:243], a[136:139], v[56:59]
    v_rcp_f32 v120, v120
    v_mfma_f32_16x16x32_bf16 v[60:63], v[232:235], a[108:111], v[60:63]
    v_rcp_f32 v121, v121
    v_mfma_f32_16x16x32_bf16 v[60:63], v[236:239], a[124:127], v[60:63]
    s_waitcnt vmcnt(11)
    v_rcp_f32 v122, v122
    v_mfma_f32_16x16x32_bf16 v[60:63], v[240:243], a[140:143], v[60:63]
    buffer_load_dwordx4 v[228:231], v1, s[20:23], s36 offen offset:2048 sc1
    v_mfma_f32_16x16x32_bf16 v[64:67], v[244:247], a[96:99], v[64:67]
    s_add_u32 s36, s55, s99
    v_rcp_f32 v123, v123
    v_mfma_f32_16x16x32_bf16 v[64:67], v[248:251], a[112:115], v[64:67]
    v_mul_f32 v124, v124, v120
    v_mul_f32 v125, v125, v121
    v_mfma_f32_16x16x32_bf16 v[64:67], v[252:255], a[128:131], v[64:67]
    v_mul_f32 v126, v126, v122
    v_mfma_f32_16x16x32_bf16 v[68:71], v[244:247], a[100:103], v[68:71]
    buffer_load_dwordx4 v[232:235], v1, s[20:23], s36 offen offset:0 sc1
    v_mfma_f32_16x16x32_bf16 v[68:71], v[248:251], a[116:119], v[68:71]
    v_mul_f32 v127, v127, v123
    v_cvt_pk_bf16_f32 v130, v124, v125
    v_mfma_f32_16x16x32_bf16 v[68:71], v[252:255], a[132:135], v[68:71]
    v_cvt_pk_bf16_f32 v131, v126, v127
    v_mfma_f32_16x16x32_bf16 v[72:75], v[244:247], a[104:107], v[72:75]
    ds_write_b64 v2, v[130:131] offset:1024
    v_mfma_f32_16x16x32_bf16 v[72:75], v[248:251], a[120:123], v[72:75]
    buffer_load_dwordx4 v[236:239], v1, s[20:23], s36 offen offset:1024 sc1
    v_mfma_f32_16x16x32_bf16 v[72:75], v[252:255], a[136:139], v[72:75]
    v_mul_f32 v112, v88, v88
    v_mul_f32 v113, v89, v89
    v_mfma_f32_16x16x32_bf16 v[76:79], v[244:247], a[108:111], v[76:79]
    v_mul_f32 v114, v90, v90
    v_mul_f32 v115, v91, v91
    v_mfma_f32_16x16x32_bf16 v[76:79], v[248:251], a[124:127], v[76:79]
    s_waitcnt vmcnt(11)
    v_fma_f32 v112, v112, v5, v4
    v_fma_f32 v113, v113, v5, v4
    v_mfma_f32_16x16x32_bf16 v[76:79], v[252:255], a[140:143], v[76:79]
    buffer_load_dwordx4 v[240:243], v1, s[20:23], s36 offen offset:2048 sc1
    v_mfma_f32_16x16x32_bf16 v[48:51], v[184:187], a[144:147], v[48:51]
    s_add_u32 s36, s36, 3072
    v_fma_f32 v114, v114, v5, v4
    v_fma_f32 v115, v115, v5, v4
    v_mfma_f32_16x16x32_bf16 v[48:51], v[188:191], a[160:163], v[48:51]
    v_mul_f32 v112, v112, v88
    v_mul_f32 v113, v113, v89
    v_mfma_f32_16x16x32_bf16 v[48:51], v[192:195], a[176:179], v[48:51]
    v_mul_f32 v114, v114, v90
    v_mul_f32 v115, v115, v91
    v_mfma_f32_16x16x32_bf16 v[52:55], v[184:187], a[148:151], v[52:55]
    buffer_load_dwordx4 v[244:247], v1, s[20:23], s36 offen offset:0 sc1
    v_mfma_f32_16x16x32_bf16 v[52:55], v[188:191], a[164:167], v[52:55]
    v_exp_f32 v112, v112
    v_mfma_f32_16x16x32_bf16 v[52:55], v[192:195], a[180:183], v[52:55]
    s_add_u32 s55, s55, 151552
    v_exp_f32 v113, v113
    v_mfma_f32_16x16x32_bf16 v[56:59], v[184:187], a[152:155], v[56:59]
    v_exp_f32 v114, v114
    v_mfma_f32_16x16x32_bf16 v[56:59], v[188:191], a[168:171], v[56:59]
    buffer_load_dwordx4 v[248:251], v1, s[20:23], s36 offen offset:1024 sc1
    v_mfma_f32_16x16x32_bf16 v[56:59], v[192:195], a[184:187], v[56:59]
    v_exp_f32 v115, v115
    v_mfma_f32_16x16x32_bf16 v[60:63], v[184:187], a[156:159], v[60:63]
    s_sub_u32 s38, s38, 1
    v_mul_f32 v116, v88, v104
    v_mfma_f32_16x16x32_bf16 v[60:63], v[188:191], a[172:175], v[60:63]
    s_waitcnt vmcnt(11)
    v_mul_f32 v117, v89, v105
    v_mul_f32 v118, v90, v106
    v_mfma_f32_16x16x32_bf16 v[60:63], v[192:195], a[188:191], v[60:63]
    buffer_load_dwordx4 v[252:255], v1, s[20:23], s36 offen offset:2048 sc1
    v_mfma_f32_16x16x32_bf16 v[64:67], v[196:199], a[144:147], v[64:67]
    s_add_u32 s36, s55, s32
    v_mul_f32 v119, v91, v107
    v_add_f32 v112, 1.0, v112
    v_mfma_f32_16x16x32_bf16 v[64:67], v[200:203], a[160:163], v[64:67]
    v_add_f32 v113, 1.0, v113
    v_add_f32 v114, 1.0, v114
    v_mfma_f32_16x16x32_bf16 v[64:67], v[204:207], a[176:179], v[64:67]
    v_add_f32 v115, 1.0, v115
    v_mfma_f32_16x16x32_bf16 v[68:71], v[196:199], a[148:151], v[68:71]
    buffer_load_dwordx4 v[184:187], v1, s[20:23], s36 offen offset:0 sc1
    v_mfma_f32_16x16x32_bf16 v[68:71], v[200:203], a[164:167], v[68:71]
    v_rcp_f32 v112, v112
    v_mfma_f32_16x16x32_bf16 v[68:71], v[204:207], a[180:183], v[68:71]
    s_branch KO_8
KP_8:
    s_branch KP_back2
KO_8:
    v_rcp_f32 v113, v113
    v_mfma_f32_16x16x32_bf16 v[72:75], v[196:199], a[152:155], v[72:75]
    v_rcp_f32 v114, v114
    v_mfma_f32_16x16x32_bf16 v[72:75], v[200:203], a[168:171], v[72:75]
    buffer_load_dwordx4 v[188:191], v1, s[20:23], s36 offen offset:1024 sc1
    v_mfma_f32_16x16x32_bf16 v[72:75], v[204:207], a[184:187], v[72:75]
    v_rcp_f32 v115, v115
    v_mfma_f32_16x16x32_bf16 v[76:79], v[196:199], a[156:159], v[76:79]
    v_mul_f32 v116, v116, v112
    v_mul_f32 v117, v117, v113
    v_mfma_f32_16x16x32_bf16 v[76:79], v[200:203], a[172:175], v[76:79]
    s_waitcnt vmcnt(11)
    v_mul_f32 v118, v118, v114
    v_mul_f32 v119, v119, v115
    v_mfma_f32_16x16x32_bf16 v[76:79], v[204:207], a[188:191], v[76:79]
    buffer_load_dwordx4 v[192:195], v1, s[20:23], s36 offen offset:2048 sc1
    v_mfma_f32_16x16x32_bf16 v[48:51], v[208:211], a[192:195], v[48:51]
    s_add_u32 s36, s36, 3072
    v_cvt_pk_bf16_f32 v128, v116, v117
    v_cvt_pk_bf16_f32 v129, v118, v119
    v_mfma_f32_16x16x32_bf16 v[48:51], v[212:215], a[208:211], v[48:51]
    ds_write_b64 v2, v[128:129] offset:2048
    v_mfma_f32_16x16x32_bf16 v[48:51], v[216:219], a[224:227], v[48:51]
    v_mul_f32 v120, v92, v92
    v_mfma_f32_16x16x32_bf16 v[52:55], v[208:211], a[196:199], v[52:55]
    buffer_load_dwordx4 v[196:199], v1, s[20:23], s36 offen offset:0 sc1
    v_mfma_f32_16x16x32_bf16 v[52:55], v[212:215], a[212:215], v[52:55]
    v_mul_f32 v121, v93, v93
    v_mul_f32 v122, v94, v94
    v_mfma_f32_16x16x32_bf16 v[52:55], v[216:219], a[228:231], v[52:55]
    v_mul_f32 v123, v95, v95
    v_fma_f32 v120, v120, v5, v4
    v_mfma_f32_16x16x32_bf16 v[56:59], v[208:211], a[200:203], v[56:59]
    v_fma_f32 v121, v121, v5, v4
    v_fma_f32 v122, v122, v5, v4
    v_mfma_f32_16x16x32_bf16 v[56:59], v[212:215], a[216:219], v[56:59]
    buffer_load_dwordx4 v[200:203], v1, s[20:23], s36 offen offset:1024 sc1
    v_mfma_f32_16x16x32_bf16 v[56:59], v[216:219], a[232:235], v[56:59]
    v_fma_f32 v123, v123, v5, v4
    v_mul_f32 v120, v120, v92
    v_mfma_f32_16x16x32_bf16 v[60:63], v[208:211], a[204:207], v[60:63]
    v_mul_f32 v121, v121, v93
    v_mfma_f32_16x16x32_bf16 v[60:63], v[212:215], a[220:223], v[60:63]
    s_waitcnt vmcnt(11)
    v_mul_f32 v122, v122, v94
    v_mul_f32 v123, v123, v95
    v_mfma_f32_16x16x32_bf16 v[60:63], v[216:219], a[236:239], v[60:63]
    buffer_load_dwordx4 v[204:207], v1, s[20:23], s36 offen offset:2048 sc1
    v_mfma_f32_16x16x32_bf16 v[64:67], v[220:223], a[192:195], v[64:67]
    s_add_u32 s36, s55, s52
    v_exp_f32 v120, v120
    v_mfma_f32_16x16x32_bf16 v[64:67], v[224:227], a[208:211], v[64:67]
    v_exp_f32 v121, v121
    v_mfma_f32_16x16x32_bf16 v[64:67], v[228:231], a[224:227], v[64:67]
    v_exp_f32 v122, v122
    v_mfma_f32_16x16x32_bf16 v[68:71], v[220:223], a[196:199], v[68:71]
    buffer_load_dwordx4 v[208:211], v1, s[20:23], s36 offen offset:0 sc1
    v_mfma_f32_16x16x32_bf16 v[68:71], v[224:227], a[212:215], v[68:71]
    v_exp_f32 v123, v123
    v_mfma_f32_16x16x32_bf16 v[68:71], v[228:231], a[228:231], v[68:71]
    v_mul_f32 v124, v92, v108
    v_mul_f32 v125, v93, v109
    v_mfma_f32_16x16x32_bf16 v[72:75], v[220:223], a[200:203], v[72:75]
    v_mul_f32 v126, v94, v110
    v_mfma_f32_16x16x32_bf16 v[72:75], v[224:227], a[216:219], v[72:75]
    buffer_load_dwordx4 v[212:215], v1, s[20:23], s36 offen offset:1024 sc1
    v_mfma_f32_16x16x32_bf16 v[72:75], v[228:231], a[232:235], v[72:75]
    v_mul_f32 v127, v95, v111
    v_add_f32 v120, 1.0, v120
    v_mfma_f32_16x16x32_bf16 v[76:79], v[220:223], a[204:207], v[76:79]
    v_add_f32 v121, 1.0, v121
    v_add_f32 v122, 1.0, v122
    v_mfma_f32_16x16x32_bf16 v[76:79], v[224:227], a[220:223], v[76:79]
    s_waitcnt vmcnt(11)
    v_add_f32 v123, 1.0, v123
    v_mfma_f32_16x16x32_bf16 v[76:79], v[228:231], a[236:239], v[76:79]
    buffer_load_dwordx4 v[216:219], v1, s[20:23], s36 offen offset:2048 sc1
    v_mfma_f32_16x16x32_bf16 v[48:51], v[232:235], a[240:243], v[48:51]
    s_add_u32 s36, s36, 3072
    v_rcp_f32 v120, v120
    v_mfma_f32_16x16x32_bf16 v[48:51], v[236:239], v[16:19], v[48:51]
    v_rcp_f32 v121, v121
    v_mfma_f32_16x16x32_bf16 v[80:83], v[240:243], v[32:35], v[48:51]
    v_rcp_f32 v122, v122
    v_mfma_f32_16x16x32_bf16 v[52:55], v[232:235], a[244:247], v[52:55]
    buffer_load_dwordx4 v[220:223], v1, s[20:23], s36 offen offset:0 sc1
    v_mfma_f32_16x16x32_bf16 v[52:55], v[236:239], v[20:23], v[52:55]
    v_rcp_f32 v123, v123
    v_mfma_f32_16x16x32_bf16 v[84:87], v[240:243], v[36:39], v[52:55]
    v_mul_f32 v124, v124, v120
    v_mul_f32 v125, v125, v121
    v_mfma_f32_16x16x32_bf16 v[56:59], v[232:235], a[248:251], v[56:59]
    v_mul_f32 v126, v126, v122
    v_mul_f32 v127, v127, v123
    v_mfma_f32_16x16x32_bf16 v[56:59], v[236:239], v[24:27], v[56:59]
    buffer_load_dwordx4 v[224:227], v1, s[20:23], s36 offen offset:1024 sc1
    v_mfma_f32_16x16x32_bf16 v[88:91], v[240:243], v[40:43], v[56:59]
    v_cvt_pk_bf16_f32 v130, v124, v125
    v_cvt_pk_bf16_f32 v131, v126, v127
    v_mfma_f32_16x16x32_bf16 v[60:63], v[232:235], a[252:255], v[60:63]
    ds_write_b64 v2, v[130:131] offset:3072
    v_mfma_f32_16x16x32_bf16 v[60:63], v[236:239], v[28:31], v[60:63]
    s_waitcnt vmcnt(11)
    v_add_u32 v2, 8192, v2
    v_mfma_f32_16x16x32_bf16 v[92:95], v[240:243], v[44:47], v[60:63]
    buffer_load_dwordx4 v[228:231], v1, s[20:23], s36 offen offset:2048 sc1
    v_mfma_f32_16x16x32_bf16 v[64:67], v[244:247], a[240:243], v[64:67]
    s_add_u32 s36, s55, s53
    v_mfma_f32_16x16x32_bf16 v[64:67], v[248:251], v[16:19], v[64:67]
    v_mfma_f32_16x16x32_bf16 v[96:99], v[252:255], v[32:35], v[64:67]
    v_mfma_f32_16x16x32_bf16 v[68:71], v[244:247], a[244:247], v[68:71]
    buffer_load_dwordx4 v[232:235], v1, s[20:23], s36 offen offset:0 sc1
    v_mfma_f32_16x16x32_bf16 v[68:71], v[248:251], v[20:23], v[68:71]
    v_mfma_f32_16x16x32_bf16 v[100:103], v[252:255], v[36:39], v[68:71]
    v_mfma_f32_16x16x32_bf16 v[72:75], v[244:247], a[248:251], v[72:75]
    v_mfma_f32_16x16x32_bf16 v[72:75], v[248:251], v[24:27], v[72:75]
    buffer_load_dwordx4 v[236:239], v1, s[20:23], s36 offen offset:1024 sc1
    v_mfma_f32_16x16x32_bf16 v[104:107], v[252:255], v[40:43], v[72:75]
    s_cmp_lg_u32 s38, 0
    v_mfma_f32_16x16x32_bf16 v[76:79], v[244:247], a[252:255], v[76:79]
    v_mfma_f32_16x16x32_bf16 v[76:79], v[248:251], v[28:31], v[76:79]
    s_waitcnt vmcnt(11)
    v_mfma_f32_16x16x32_bf16 v[108:111], v[252:255], v[44:47], v[76:79]
    buffer_load_dwordx4 v[240:243], v1, s[20:23], s36 offen offset:2048 sc1
    s_cbranch_scc1 KM_p1
KM_b9:
    v_mfma_f32_16x16x32_bf16 v[48:51], v[184:187], a[0:3], 0
    s_add_u32 s36, s36, 3072
    v_mfma_f32_16x16x32_bf16 v[48:51], v[188:191], a[16:19], v[48:51]
    v_mfma_f32_16x16x32_bf16 v[48:51], v[192:195], a[32:35], v[48:51]
    v_mfma_f32_16x16x32_bf16 v[52:55], v[184:187], a[4:7], 0
    buffer_load_dwordx4 v[244:247], v1, s[20:23], s36 offen offset:0 sc1
    v_mfma_f32_16x16x32_bf16 v[52:55], v[188:191], a[20:23], v[52:55]
    v_mul_f32 v112, v80, v80
    v_mul_f32 v113, v81, v81
    v_mfma_f32_16x16x32_bf16 v[52:55], v[192:195], a[36:39], v[52:55]
    v_mul_f32 v114, v82, v82
    v_mul_f32 v115, v83, v83
    v_mfma_f32_16x16x32_bf16 v[56:59], v[184:187], a[8:11], 0
    v_fma_f32 v112, v112, v5, v4
    v_fma_f32 v113, v113, v5, v4
    v_mfma_f32_16x16x32_bf16 v[56:59], v[188:191], a[24:27], v[56:59]
    buffer_load_dwordx4 v[248:251], v1, s[20:23], s36 offen offset:1024 sc1
    v_mfma_f32_16x16x32_bf16 v[56:59], v[192:195], a[40:43], v[56:59]
    v_fma_f32 v114, v114, v5, v4
    v_fma_f32 v115, v115, v5, v4
    v_mfma_f32_16x16x32_bf16 v[60:63], v[184:187], a[12:15], 0
    v_mul_f32 v112, v112, v80
    v_mul_f32 v113, v113, v81
    v_mfma_f32_16x16x32_bf16 v[60:63], v[188:191], a[28:31], v[60:63]
    s_waitcnt vmcnt(11)
    v_mul_f32 v114, v114, v82
    v_mul_f32 v115, v115, v83
    v_mfma_f32_16x16x32_bf16 v[60:63], v[192:195], a[44:47], v[60:63]
    buffer_load_dwordx4 v[252:255], v1, s[20:23], s36 offen offset:2048 sc1
    v_mfma_f32_16x16x32_bf16 v[64:67], v[196:199], a[0:3], 0
    s_add_u32 s36, s55, s97
    v_exp_f32 v112, v112
    v_mfma_f32_16x16x32_bf16 v[64:67], v[200:203], a[16:19], v[64:67]
    v_exp_f32 v113, v113
    v_mfma_f32_16x16x32_bf16 v[64:67], v[204:207], a[32:35], v[64:67]
    v_exp_f32 v114, v114
    v_mfma_f32_16x16x32_bf16 v[68:71], v[196:199], a[4:7], 0
    buffer_load_dwordx4 v[184:187], v1, s[20:23], s36 offen offset:0 sc1
    v_mfma_f32_16x16x32_bf16 v[68:71], v[200:203], a[20:23], v[68:71]
    v_exp_f32 v115, v115
    v_mfma_f32_16x16x32_bf16 v[68:71], v[204:207], a[36:39], v[68:71]
    v_mul_f32 v116, v80, v96
    v_mfma_f32_16x16x32_bf16 v[72:75], v[196:199], a[8:11], 0
    v_mul_f32 v117, v81, v97
    v_mul_f32 v118, v82, v98
    v_mfma_f32_16x16x32_bf16 v[72:75], v[200:203], a[24:27], v[72:75]
    buffer_load_dwordx4 v[188:191], v1, s[20:23], s36 offen offset:1024 sc1
    v_mfma_f32_16x16x32_bf16 v[72:75], v[204:207], a[40:43], v[72:75]
    v_mul_f32 v119, v83, v99
    v_mfma_f32_16x16x32_bf16 v[76:79], v[196:199], a[12:15], 0
    s_waitcnt lgkmcnt(0)
    s_barrier
    v_add_f32 v112, 1.0, v112
    v_add_f32 v113, 1.0, v113
    v_mfma_f32_16x16x32_bf16 v[76:79], v[200:203], a[28:31], v[76:79]
    s_waitcnt vmcnt(11)
    v_add_f32 v114, 1.0, v114
    v_add_f32 v115, 1.0, v115
    v_mfma_f32_16x16x32_bf16 v[76:79], v[204:207], a[44:47], v[76:79]
    buffer_load_dwordx4 v[192:195], v1, s[20:23], s36 offen offset:2048 sc1
    v_mfma_f32_16x16x32_bf16 v[48:51], v[208:211], a[48:51], v[48:51]
    s_add_u32 s36, s36, 3072
    v_lshl_add_u32 v12, s56, 2, v6
    ds_read_b128 a[0:3], v12 offset:0
    v_rcp_f32 v112, v112
    v_mfma_f32_16x16x32_bf16 v[48:51], v[212:215], a[64:67], v[48:51]
    v_rcp_f32 v113, v113
    v_mfma_f32_16x16x32_bf16 v[48:51], v[216:219], a[80:83], v[48:51]
    ds_read_b128 a[4:7], v12 offset:1024
    v_rcp_f32 v114, v114
    v_mfma_f32_16x16x32_bf16 v[52:55], v[208:211], a[52:55], v[52:55]
    buffer_load_dwordx4 v[196:199], v1, s[20:23], s36 offen offset:0 sc1
    v_mfma_f32_16x16x32_bf16 v[52:55], v[212:215], a[68:71], v[52:55]
    ds_read_b128 a[8:11], v12 offset:2048
    v_rcp_f32 v115, v115
    v_mfma_f32_16x16x32_bf16 v[52:55], v[216:219], a[84:87], v[52:55]
    v_mul_f32 v116, v116, v112
    v_mfma_f32_16x16x32_bf16 v[56:59], v[208:211], a[56:59], v[56:59]
    ds_read_b128 a[12:15], v12 offset:3072
    v_mul_f32 v117, v117, v113
    v_mul_f32 v118, v118, v114
    v_mfma_f32_16x16x32_bf16 v[56:59], v[212:215], a[72:75], v[56:59]
    buffer_load_dwordx4 v[200:203], v1, s[20:23], s36 offen offset:1024 sc1
    v_mfma_f32_16x16x32_bf16 v[56:59], v[216:219], a[88:91], v[56:59]
    ds_read_b128 a[16:19], v12 offset:4096
    v_mul_f32 v119, v119, v115
    v_cvt_pk_bf16_f32 v128, v116, v117
    v_mfma_f32_16x16x32_bf16 v[60:63], v[208:211], a[60:63], v[60:63]
    v_cvt_pk_bf16_f32 v129, v118, v119
    v_mfma_f32_16x16x32_bf16 v[60:63], v[212:215], a[76:79], v[60:63]
    s_waitcnt vmcnt(11)
    ds_read_b128 a[20:23], v12 offset:5120
    ds_write_b64 v2, v[128:129] offset:0
    v_mfma_f32_16x16x32_bf16 v[60:63], v[216:219], a[92:95], v[60:63]
    buffer_load_dwordx4 v[204:207], v1, s[20:23], s36 offen offset:2048 sc1
    v_mfma_f32_16x16x32_bf16 v[64:67], v[220:223], a[48:51], v[64:67]
    s_add_u32 s36, s55, s98
    ds_read_b128 a[24:27], v12 offset:6144
    v_mul_f32 v120, v84, v84
    v_mul_f32 v121, v85, v85
    v_mfma_f32_16x16x32_bf16 v[64:67], v[224:227], a[64:67], v[64:67]
    v_mul_f32 v122, v86, v86
    v_mul_f32 v123, v87, v87
    v_mfma_f32_16x16x32_bf16 v[64:67], v[228:231], a[80:83], v[64:67]
    ds_read_b128 a[28:31], v12 offset:7168
    v_fma_f32 v120, v120, v5, v4
    v_fma_f32 v121, v121, v5, v4
    v_mfma_f32_16x16x32_bf16 v[68:71], v[220:223], a[52:55], v[68:71]
    buffer_load_dwordx4 v[208:211], v1, s[20:23], s36 offen offset:0 sc1
    v_mfma_f32_16x16x32_bf16 v[68:71], v[224:227], a[68:71], v[68:71]
    ds_read_b128 a[32:35], v12 offset:8192
    v_fma_f32 v122, v122, v5, v4
    v_fma_f32 v123, v123, v5, v4
    v_mfma_f32_16x16x32_bf16 v[68:71], v[228:231], a[84:87], v[68:71]
    v_mul_f32 v120, v120, v84
    v_mul_f32 v121, v121, v85
    v_mfma_f32_16x16x32_bf16 v[72:75], v[220:223], a[56:59], v[72:75]
    ds_read_b128 a[36:39], v12 offset:9216
    v_mul_f32 v122, v122, v86
    v_mul_f32 v123, v123, v87
    v_mfma_f32_16x16x32_bf16 v[72:75], v[224:227], a[72:75], v[72:75]
    buffer_load_dwordx4 v[212:215], v1, s[20:23], s36 offen offset:1024 sc1
    v_mfma_f32_16x16x32_bf16 v[72:75], v[228:231], a[88:91], v[72:75]
    ds_read_b128 a[40:43], v12 offset:10240
    v_exp_f32 v120, v120
    v_mfma_f32_16x16x32_bf16 v[76:79], v[220:223], a[60:63], v[76:79]
    v_exp_f32 v121, v121
    v_mfma_f32_16x16x32_bf16 v[76:79], v[224:227], a[76:79], v[76:79]
    s_waitcnt vmcnt(11)
    ds_read_b128 a[44:47], v12 offset:11264
    v_exp_f32 v122, v122
    v_mfma_f32_16x16x32_bf16 v[76:79], v[228:231], a[92:95], v[76:79]
    buffer_load_dwordx4 v[216:219], v1, s[20:23], s36 offen offset:2048 sc1
    v_mfma_f32_16x16x32_bf16 v[48:51], v[232:235], a[96:99], v[48:51]
    s_add_u32 s36, s36, 3072
    v_lshl_add_u32 v12, s57, 2, v6
    ds_read_b128 a[48:51], v12 offset:0
    v_exp_f32 v123, v123
    v_mfma_f32_16x16x32_bf16 v[48:51], v[236:239], a[112:115], v[48:51]
    v_mul_f32 v124, v84, v100
    v_mfma_f32_16x16x32_bf16 v[48:51], v[240:243], a[128:131], v[48:51]
    ds_read_b128 a[52:55], v12 offset:1024
    v_mul_f32 v125, v85, v101
    v_mul_f32 v126, v86, v102
    v_mfma_f32_16x16x32_bf16 v[52:55], v[232:235], a[100:103], v[52:55]
    buffer_load_dwordx4 v[220:223], v1, s[20:23], s36 offen offset:0 sc1
    v_mfma_f32_16x16x32_bf16 v[52:55], v[236:239], a[116:119], v[52:55]
    ds_read_b128 a[56:59], v12 offset:2048
    v_mul_f32 v127, v87, v103
    v_add_f32 v120, 1.0, v120
    v_mfma_f32_16x16x32_bf16 v[52:55], v[240:243], a[132:135], v[52:55]
    v_add_f32 v121, 1.0, v121
    v_add_f32 v122, 1.0, v122
    v_mfma_f32_16x16x32_bf16 v[56:59], v[232:235], a[104:107], v[56:59]
    ds_read_b128 a[60:63], v12 offset:3072
    v_add_f32 v123, 1.0, v123
    v_mfma_f32_16x16x32_bf16 v[56:59], v[236:239], a[120:123], v[56:59]
    buffer_load_dwordx4 v[224:227], v1, s[20:23], s36 offen offset:1024 sc1
    v_mfma_f32_16x16x32_bf16 v[56:59], v[240:243], a[136:139], v[56:59]
    ds_read_b128 a[64:67], v12 offset:4096
    v_rcp_f32 v120, v120
    v_mfma_f32_16x16x32_bf16 v[60:63], v[232:235], a[108:111], v[60:63]
    v_rcp_f32 v121, v121
    v_mfma_f32_16x16x32_bf16 v[60:63], v[236:239], a[124:127], v[60:63]
    s_waitcnt vmcnt(11)
    ds_read_b128 a[68:71], v12 offset:5120
    v_rcp_f32 v122, v122
    v_mfma_f32_16x16x32_bf16 v[60:63], v[240:243], a[140:143], v[60:63]
    buffer_load_dwordx4 v[228:231], v1, s[20:23], s36 offen offset:2048 sc1
    v_mfma_f32_16x16x32_bf16 v[64:67], v[244:247], a[96:99], v[64:67]
    s_add_u32 s36, s55, s99
    ds_read_b128 a[72:75], v12 offset:6144
    v_rcp_f32 v123, v123
    v_mfma_f32_16x16x32_bf16 v[64:67], v[248:251], a[112:115], v[64:67]
    v_mul_f32 v124, v124, v120
    v_mul_f32 v125, v125, v121
    v_mfma_f32_16x16x32_bf16 v[64:67], v[252:255], a[128:131], v[64:67]
    ds_read_b128 a[76:79], v12 offset:7168
    v_mul_f32 v126, v126, v122
    v_mfma_f32_16x16x32_bf16 v[68:71], v[244:247], a[100:103], v[68:71]
    buffer_load_dwordx4 v[232:235], v1, s[20:23], s36 offen offset:0 sc1
    v_mfma_f32_16x16x32_bf16 v[68:71], v[248:251], a[116:119], v[68:71]
    ds_read_b128 a[80:83], v12 offset:8192
    v_mul_f32 v127, v127, v123
    v_cvt_pk_bf16_f32 v130, v124, v125
    v_mfma_f32_16x16x32_bf16 v[68:71], v[252:255], a[132:135], v[68:71]
    v_cvt_pk_bf16_f32 v131, v126, v127
    v_mfma_f32_16x16x32_bf16 v[72:75], v[244:247], a[104:107], v[72:75]
    ds_read_b128 a[84:87], v12 offset:9216
    ds_write_b64 v2, v[130:131] offset:1024
    v_mfma_f32_16x16x32_bf16 v[72:75], v[248:251], a[120:123], v[72:75]
    buffer_load_dwordx4 v[236:239], v1, s[20:23], s36 offen offset:1024 sc1
    v_mfma_f32_16x16x32_bf16 v[72:75], v[252:255], a[136:139], v[72:75]
    ds_read_b128 a[88:91], v12 offset:10240
    v_mul_f32 v112, v88, v88
    v_mul_f32 v113, v89, v89
    v_mfma_f32_16x16x32_bf16 v[76:79], v[244:247], a[108:111], v[76:79]
    v_mul_f32 v114, v90, v90
    v_mul_f32 v115, v91, v91
    v_mfma_f32_16x16x32_bf16 v[76:79], v[248:251], a[124:127], v[76:79]
    s_waitcnt vmcnt(11)
    ds_read_b128 a[92:95], v12 offset:11264
    v_fma_f32 v112, v112, v5, v4
    v_fma_f32 v113, v113, v5, v4
    v_mfma_f32_16x16x32_bf16 v[76:79], v[252:255], a[140:143], v[76:79]
    buffer_load_dwordx4 v[240:243], v1, s[20:23], s36 offen offset:2048 sc1
    v_mfma_f32_16x16x32_bf16 v[48:51], v[184:187], a[144:147], v[48:51]
    s_add_u32 s36, s36, 3072
    v_lshl_add_u32 v12, s58, 2, v6
    ds_read_b128 a[96:99], v12 offset:0
    v_fma_f32 v114, v114, v5, v4
    v_fma_f32 v115, v115, v5, v4
    v_mfma_f32_16x16x32_bf16 v[48:51], v[188:191], a[160:163], v[48:51]
    v_mul_f32 v112, v112, v88
    v_mul_f32 v113, v113, v89
    v_mfma_f32_16x16x32_bf16 v[48:51], v[192:195], a[176:179], v[48:51]
    ds_read_b128 a[100:103], v12 offset:1024
    v_mul_f32 v114, v114, v90
    v_mul_f32 v115, v115, v91
    v_mfma_f32_16x16x32_bf16 v[52:55], v[184:187], a[148:151], v[52:55]
    buffer_load_dwordx4 v[244:247], v1, s[20:23], s36 offen offset:0 sc1
    v_mfma_f32_16x16x32_bf16 v[52:55], v[188:191], a[164:167], v[52:55]
    ds_read_b128 a[104:107], v12 offset:2048
    v_exp_f32 v112, v112
    v_mfma_f32_16x16x32_bf16 v[52:55], v[192:195], a[180:183], v[52:55]
    v_exp_f32 v113, v113
    v_mfma_f32_16x16x32_bf16 v[56:59], v[184:187], a[152:155], v[56:59]
    ds_read_b128 a[108:111], v12 offset:3072
    v_exp_f32 v114, v114
    v_mfma_f32_16x16x32_bf16 v[56:59], v[188:191], a[168:171], v[56:59]
    buffer_load_dwordx4 v[248:251], v1, s[20:23], s36 offen offset:1024 sc1
    v_mfma_f32_16x16x32_bf16 v[56:59], v[192:195], a[184:187], v[56:59]
    ds_read_b128 a[112:115], v12 offset:4096
    v_exp_f32 v115, v115
    v_mfma_f32_16x16x32_bf16 v[60:63], v[184:187], a[156:159], v[60:63]
    v_mul_f32 v116, v88, v104
    v_mfma_f32_16x16x32_bf16 v[60:63], v[188:191], a[172:175], v[60:63]
    s_waitcnt vmcnt(11)
    ds_read_b128 a[116:119], v12 offset:5120
    v_mul_f32 v117, v89, v105
    v_mul_f32 v118, v90, v106
    v_mfma_f32_16x16x32_bf16 v[60:63], v[192:195], a[188:191], v[60:63]
    buffer_load_dwordx4 v[252:255], v1, s[20:23], s36 offen offset:2048 sc1
    v_mfma_f32_16x16x32_bf16 v[64:67], v[196:199], a[144:147], v[64:67]
    s_add_u32 s36, s37, s56
    ds_read_b128 a[120:123], v12 offset:6144
    v_mul_f32 v119, v91, v107
    v_add_f32 v112, 1.0, v112
    v_mfma_f32_16x16x32_bf16 v[64:67], v[200:203], a[160:163], v[64:67]
    v_add_f32 v113, 1.0, v113
    v_add_f32 v114, 1.0, v114
    v_mfma_f32_16x16x32_bf16 v[64:67], v[204:207], a[176:179], v[64:67]
    ds_read_b128 a[124:127], v12 offset:7168
    v_add_f32 v115, 1.0, v115
    v_mfma_f32_16x16x32_bf16 v[68:71], v[196:199], a[148:151], v[68:71]
    buffer_load_dwordx4 v[184:187], v1, s[20:23], s36 offen offset:0 sc1
    v_mfma_f32_16x16x32_bf16 v[68:71], v[200:203], a[164:167], v[68:71]
    ds_read_b128 a[128:131], v12 offset:8192
    v_rcp_f32 v112, v112
    v_mfma_f32_16x16x32_bf16 v[68:71], v[204:207], a[180:183], v[68:71]
    v_rcp_f32 v113, v113
    v_mfma_f32_16x16x32_bf16 v[72:75], v[196:199], a[152:155], v[72:75]
    ds_read_b128 a[132:135], v12 offset:9216
    v_rcp_f32 v114, v114
    v_mfma_f32_16x16x32_bf16 v[72:75], v[200:203], a[168:171], v[72:75]
    buffer_load_dwordx4 v[188:191], v1, s[20:23], s36 offen offset:1024 sc1
    v_mfma_f32_16x16x32_bf16 v[72:75], v[204:207], a[184:187], v[72:75]
    ds_read_b128 a[136:139], v12 offset:10240
    v_rcp_f32 v115, v115
    v_mfma_f32_16x16x32_bf16 v[76:79], v[196:199], a[156:159], v[76:79]
    v_mul_f32 v116, v116, v112
    v_mul_f32 v117, v117, v113
    v_mfma_f32_16x16x32_bf16 v[76:79], v[200:203], a[172:175], v[76:79]
    s_waitcnt vmcnt(11)
    ds_read_b128 a[140:143], v12 offset:11264
    v_mul_f32 v118, v118, v114
    v_mul_f32 v119, v119, v115
    v_mfma_f32_16x16x32_bf16 v[76:79], v[204:207], a[188:191], v[76:79]
    buffer_load_dwordx4 v[192:195], v1, s[20:23], s36 offen offset:2048 sc1
    v_mfma_f32_16x16x32_bf16 v[48:51], v[208:211], a[192:195], v[48:51]
    s_add_u32 s36, s37, s57
    v_lshl_add_u32 v12, s59, 2, v6
    ds_read_b128 a[144:147], v12 offset:0
    v_cvt_pk_bf16_f32 v128, v116, v117
    v_cvt_pk_bf16_f32 v129, v118, v119
    v_mfma_f32_16x16x32_bf16 v[48:51], v[212:215], a[208:211], v[48:51]
    ds_write_b64 v2, v[128:129] offset:2048
    v_mfma_f32_16x16x32_bf16 v[48:51], v[216:219], a[224:227], v[48:51]
    ds_read_b128 a[148:151], v12 offset:1024
    v_mul_f32 v120, v92, v92
    v_mfma_f32_16x16x32_bf16 v[52:55], v[208:211], a[196:199], v[52:55]
    buffer_load_dwordx4 v[196:199], v1, s[20:23], s36 offen offset:0 sc1
    v_mfma_f32_16x16x32_bf16 v[52:55], v[212:215], a[212:215], v[52:55]
    ds_read_b128 a[152:155], v12 offset:2048
    v_mul_f32 v121, v93, v93
    v_mul_f32 v122, v94, v94
    v_mfma_f32_16x16x32_bf16 v[52:55], v[216:219], a[228:231], v[52:55]
    v_mul_f32 v123, v95, v95
    v_fma_f32 v120, v120, v5, v4
    v_mfma_f32_16x16x32_bf16 v[56:59], v[208:211], a[200:203], v[56:59]
    ds_read_b128 a[156:159], v12 offset:3072
    v_fma_f32 v121, v121, v5, v4
    v_fma_f32 v122, v122, v5, v4
    v_mfma_f32_16x16x32_bf16 v[56:59], v[212:215], a[216:219], v[56:59]
    buffer_load_dwordx4 v[200:203], v1, s[20:23], s36 offen offset:1024 sc1
    v_mfma_f32_16x16x32_bf16 v[56:59], v[216:219], a[232:235], v[56:59]
    ds_read_b128 a[160:163], v12 offset:4096
    v_fma_f32 v123, v123, v5, v4
    v_mul_f32 v120, v120, v92
    v_mfma_f32_16x16x32_bf16 v[60:63], v[208:211], a[204:207], v[60:63]
    v_mul_f32 v121, v121, v93
    v_mfma_f32_16x16x32_bf16 v[60:63], v[212:215], a[220:223], v[60:63]
    s_waitcnt vmcnt(11)
    ds_read_b128 a[164:167], v12 offset:5120
    v_mul_f32 v122, v122, v94
    v_mul_f32 v123, v123, v95
    v_mfma_f32_16x16x32_bf16 v[60:63], v[216:219], a[236:239], v[60:63]
    buffer_load_dwordx4 v[204:207], v1, s[20:23], s36 offen offset:2048 sc1
    v_mfma_f32_16x16x32_bf16 v[64:67], v[220:223], a[192:195], v[64:67]
    s_add_u32 s36, s37, s58
    ds_read_b128 a[168:171], v12 offset:6144
    v_exp_f32 v120, v120
    v_mfma_f32_16x16x32_bf16 v[64:67], v[224:227], a[208:211], v[64:67]
    v_exp_f32 v121, v121
    v_mfma_f32_16x16x32_bf16 v[64:67], v[228:231], a[224:227], v[64:67]
    ds_read_b128 a[172:175], v12 offset:7168
    v_exp_f32 v122, v122
    v_mfma_f32_16x16x32_bf16 v[68:71], v[220:223], a[196:199], v[68:71]
    buffer_load_dwordx4 v[208:211], v1, s[20:23], s36 offen offset:0 sc1
    v_mfma_f32_16x16x32_bf16 v[68:71], v[224:227], a[212:215], v[68:71]
    ds_read_b128 a[176:179], v12 offset:8192
    v_exp_f32 v123, v123
    v_mfma_f32_16x16x32_bf16 v[68:71], v[228:231], a[228:231], v[68:71]
    v_mul_f32 v124, v92, v108
    v_mul_f32 v125, v93, v109
    v_mfma_f32_16x16x32_bf16 v[72:75], v[220:223], a[200:203], v[72:75]
    ds_read_b128 a[180:183], v12 offset:9216
    v_mul_f32 v126, v94, v110
    v_mfma_f32_16x16x32_bf16 v[72:75], v[224:227], a[216:219], v[72:75]
    buffer_load_dwordx4 v[212:215], v1, s[20:23], s36 offen offset:1024 sc1
    v_mfma_f32_16x16x32_bf16 v[72:75], v[228:231], a[232:235], v[72:75]
    ds_read_b128 a[184:187], v12 offset:10240
    v_mul_f32 v127, v95, v111
    v_add_f32 v120, 1.0, v120
    v_mfma_f32_16x16x32_bf16 v[76:79], v[220:223], a[204:207], v[76:79]
    v_add_f32 v121, 1.0, v121
    v_add_f32 v122, 1.0, v122
    v_mfma_f32_16x16x32_bf16 v[76:79], v[224:227], a[220:223], v[76:79]
    s_waitcnt vmcnt(11)
    ds_read_b128 a[188:191], v12 offset:11264
    v_add_f32 v123, 1.0, v123
    v_mfma_f32_16x16x32_bf16 v[76:79], v[228:231], a[236:239], v[76:79]
    buffer_load_dwordx4 v[216:219], v1, s[20:23], s36 offen offset:2048 sc1
    v_mfma_f32_16x16x32_bf16 v[48:51], v[232:235], a[240:243], v[48:51]
    s_add_u32 s36, s37, s59
    v_rcp_f32 v120, v120
    v_mfma_f32_16x16x32_bf16 v[48:51], v[236:239], v[16:19], v[48:51]
    v_rcp_f32 v121, v121
    v_mfma_f32_16x16x32_bf16 v[80:83], v[240:243], v[32:35], v[48:51]
    v_rcp_f32 v122, v122
    v_mfma_f32_16x16x32_bf16 v[52:55], v[232:235], a[244:247], v[52:55]
    buffer_load_dwordx4 v[220:223], v1, s[20:23], s36 offen offset:0 sc1
    v_mfma_f32_16x16x32_bf16 v[52:55], v[236:239], v[20:23], v[52:55]
    v_rcp_f32 v123, v123
    v_mfma_f32_16x16x32_bf16 v[84:87], v[240:243], v[36:39], v[52:55]
    v_mul_f32 v124, v124, v120
    v_mul_f32 v125, v125, v121
    v_mfma_f32_16x16x32_bf16 v[56:59], v[232:235], a[248:251], v[56:59]
    v_mul_f32 v126, v126, v122
    v_mul_f32 v127, v127, v123
    v_mfma_f32_16x16x32_bf16 v[56:59], v[236:239], v[24:27], v[56:59]
    buffer_load_dwordx4 v[224:227], v1, s[20:23], s36 offen offset:1024 sc1
    v_mfma_f32_16x16x32_bf16 v[88:91], v[240:243], v[40:43], v[56:59]
    v_cvt_pk_bf16_f32 v130, v124, v125
    v_cvt_pk_bf16_f32 v131, v126, v127
    v_mfma_f32_16x16x32_bf16 v[60:63], v[232:235], a[252:255], v[60:63]
    ds_write_b64 v2, v[130:131] offset:3072
    v_mfma_f32_16x16x32_bf16 v[60:63], v[236:239], v[28:31], v[60:63]
    s_waitcnt vmcnt(11)
    v_add_u32 v2, 8192, v2
    v_mfma_f32_16x16x32_bf16 v[92:95], v[240:243], v[44:47], v[60:63]
    buffer_load_dwordx4 v[228:231], v1, s[20:23], s36 offen offset:2048 sc1
    v_mfma_f32_16x16x32_bf16 v[64:67], v[244:247], a[240:243], v[64:67]
    s_add_u32 s36, s37, 12288
    v_mfma_f32_16x16x32_bf16 v[64:67], v[248:251], v[16:19], v[64:67]
    v_mfma_f32_16x16x32_bf16 v[96:99], v[252:255], v[32:35], v[64:67]
    v_mfma_f32_16x16x32_bf16 v[68:71], v[244:247], a[244:247], v[68:71]
    buffer_load_dwordx4 v[232:235], v1, s[20:23], s36 offen offset:0 sc1
    v_mfma_f32_16x16x32_bf16 v[68:71], v[248:251], v[20:23], v[68:71]
    v_mfma_f32_16x16x32_bf16 v[100:103], v[252:255], v[36:39], v[68:71]
    v_mfma_f32_16x16x32_bf16 v[72:75], v[244:247], a[248:251], v[72:75]
    v_mfma_f32_16x16x32_bf16 v[72:75], v[248:251], v[24:27], v[72:75]
    buffer_load_dwordx4 v[236:239], v1, s[20:23], s36 offen offset:1024 sc1
    v_mfma_f32_16x16x32_bf16 v[104:107], v[252:255], v[40:43], v[72:75]
    v_mfma_f32_16x16x32_bf16 v[76:79], v[244:247], a[252:255], v[76:79]
    v_mfma_f32_16x16x32_bf16 v[76:79], v[248:251], v[28:31], v[76:79]
    s_waitcnt vmcnt(11)
    v_mfma_f32_16x16x32_bf16 v[108:111], v[252:255], v[44:47], v[76:79]
    buffer_load_dwordx4 v[240:243], v1, s[20:23], s36 offen offset:2048 sc1
KM_s0:
    s_waitcnt lgkmcnt(0)
    s_barrier
    s_mov_b32 s28, 1
    s_add_u32 s40, s25, s28
    s_and_b32 s40, s40, 7
    s_mul_i32 s41, s40, 77824
    s_add_u32 s37, s41, s27
    v_mfma_f32_16x16x32_bf16 v[48:51], v[184:187], a[0:3], v[132:135]
    s_add_u32 s36, s36, 3072
    ds_read_b128 a[192:195], v6 offset:49152
    v_mul_f32 v112, v80, v80
    v_mul_f32 v113, v81, v81
    v_mul_f32 v114, v82, v82
    v_mul_f32 v115, v83, v83
    v_fma_f32 v112, v112, v5, v4
    v_mfma_f32_16x16x32_bf16 v[52:55], v[184:187], a[4:7], v[136:139]
    v_fma_f32 v113, v113, v5, v4
    v_fma_f32 v114, v114, v5, v4
    v_fma_f32 v115, v115, v5, v4
    v_mul_f32 v112, v112, v80
    v_mfma_f32_16x16x32_bf16 v[56:59], v[184:187], a[8:11], v[140:143]
    s_waitcnt vmcnt(13)
    ds_read_b128 a[196:199], v6 offset:50176
    v_mul_f32 v113, v113, v81
    v_mul_f32 v114, v114, v82
    v_mul_f32 v115, v115, v83
    v_exp_f32 v112, v112
    v_mfma_f32_16x16x32_bf16 v[60:63], v[184:187], a[12:15], v[144:147]
    buffer_load_dwordx4 v[244:247], v1, s[20:23], s36 offen offset:0 sc1
    v_mfma_f32_16x16x32_bf16 v[48:51], v[188:191], a[16:19], v[48:51]
    ds_read_b128 a[200:203], v6 offset:51200
    v_exp_f32 v113, v113
    v_exp_f32 v114, v114
    v_mfma_f32_16x16x32_bf16 v[52:55], v[188:191], a[20:23], v[52:55]
    v_exp_f32 v115, v115
    v_mul_f32 v116, v80, v96
    v_mul_f32 v117, v81, v97
    v_mfma_f32_16x16x32_bf16 v[56:59], v[188:191], a[24:27], v[56:59]
    s_waitcnt vmcnt(13)
    ds_read_b128 a[204:207], v6 offset:52224
    v_mul_f32 v118, v82, v98
    v_mul_f32 v119, v83, v99
    v_add_f32 v112, 1.0, v112
    v_add_f32 v113, 1.0, v113
    v_mfma_f32_16x16x32_bf16 v[60:63], v[188:191], a[28:31], v[60:63]
    buffer_load_dwordx4 v[248:251], v1, s[20:23], s36 offen offset:1024 sc1
    v_mfma_f32_16x16x32_bf16 v[48:51], v[192:195], a[32:35], v[48:51]
    ds_read_b128 a[208:211], v6 offset:53248
    v_add_f32 v114, 1.0, v114
    v_add_f32 v115, 1.0, v115
    v_rcp_f32 v112, v112
    v_mfma_f32_16x16x32_bf16 v[52:55], v[192:195], a[36:39], v[52:55]
    v_rcp_f32 v113, v113
    v_rcp_f32 v114, v114
    v_mfma_f32_16x16x32_bf16 v[56:59], v[192:195], a[40:43], v[56:59]
    s_waitcnt vmcnt(13)
    ds_read_b128 a[212:215], v6 offset:54272
    v_rcp_f32 v115, v115
    v_mul_f32 v116, v116, v112
    v_mul_f32 v117, v117, v113
    v_mfma_f32_16x16x32_bf16 v[60:63], v[192:195], a[44:47], v[60:63]
    buffer_load_dwordx4 v[252:255], v1, s[20:23], s36 offen offset:2048 sc1
    v_mfma_f32_16x16x32_bf16 v[48:51], v[196:199], a[48:51], v[48:51]
    s_add_u32 s36, s37, s56
    ds_read_b128 a[216:219], v6 offset:55296
    v_mul_f32 v118, v118, v114
    v_mul_f32 v119, v119, v115
    v_cvt_pk_bf16_f32 v128, v116, v117
    v_cvt_pk_bf16_f32 v129, v118, v119
    v_mfma_f32_16x16x32_bf16 v[52:55], v[196:199], a[52:55], v[52:55]
    ds_write_b64 v2, v[128:129] offset:0
    v_mul_f32 v120, v84, v84
    v_mul_f32 v121, v85, v85
    v_mul_f32 v122, v86, v86
    v_mfma_f32_16x16x32_bf16 v[56:59], v[196:199], a[56:59], v[56:59]
    s_waitcnt vmcnt(13)
    ds_read_b128 a[220:223], v6 offset:56320
    v_mul_f32 v123, v87, v87
    v_fma_f32 v120, v120, v5, v4
    v_fma_f32 v121, v121, v5, v4
    v_fma_f32 v122, v122, v5, v4
    v_mfma_f32_16x16x32_bf16 v[60:63], v[196:199], a[60:63], v[60:63]
    buffer_load_dwordx4 v[184:187], v1, s[20:23], s36 offen offset:0 sc1
    v_mfma_f32_16x16x32_bf16 v[48:51], v[200:203], a[64:67], v[48:51]
    ds_read_b128 a[224:227], v6 offset:57344
    v_fma_f32 v123, v123, v5, v4
    v_mul_f32 v120, v120, v84
    v_mul_f32 v121, v121, v85
    v_mul_f32 v122, v122, v86
    v_mfma_f32_16x16x32_bf16 v[52:55], v[200:203], a[68:71], v[52:55]
    v_mul_f32 v123, v123, v87
    v_exp_f32 v120, v120
    v_exp_f32 v121, v121
    v_mfma_f32_16x16x32_bf16 v[56:59], v[200:203], a[72:75], v[56:59]
    s_waitcnt vmcnt(13)
    ds_read_b128 a[228:231], v6 offset:58368
    v_exp_f32 v122, v122
    v_exp_f32 v123, v123
    v_mfma_f32_16x16x32_bf16 v[60:63], v[200:203], a[76:79], v[60:63]
    buffer_load_dwordx4 v[188:191], v1, s[20:23], s36 offen offset:1024 sc1
    v_mfma_f32_16x16x32_bf16 v[48:51], v[204:207], a[80:83], v[48:51]
    ds_read_b128 a[232:235], v6 offset:59392
    v_mul_f32 v124, v84, v100
    v_mul_f32 v125, v85, v101
    v_mul_f32 v126, v86, v102
    v_mul_f32 v127, v87, v103
    v_mfma_f32_16x16x32_bf16 v[52:55], v[204:207], a[84:87], v[52:55]
    s_branch KO_9
KP_9:
    s_branch KP_back2
KO_9:
    v_add_f32 v120, 1.0, v120
    v_add_f32 v121, 1.0, v121
    v_add_f32 v122, 1.0, v122
    v_add_f32 v123, 1.0, v123
    v_mfma_f32_16x16x32_bf16 v[56:59], v[204:207], a[88:91], v[56:59]
    s_waitcnt vmcnt(13)
    ds_read_b128 a[236:239], v6 offset:60416
    v_rcp_f32 v120, v120
    v_rcp_f32 v121, v121
    v_mfma_f32_16x16x32_bf16 v[60:63], v[204:207], a[92:95], v[60:63]
    buffer_load_dwordx4 v[192:195], v1, s[20:23], s36 offen offset:2048 sc1
    v_mfma_f32_16x16x32_bf16 v[48:51], v[208:211], a[96:99], v[48:51]
    s_add_u32 s36, s37, s57
    ds_read_b128 a[240:243], v6 offset:61440
    v_rcp_f32 v122, v122
    v_rcp_f32 v123, v123
    v_mul_f32 v124, v124, v120
    v_mfma_f32_16x16x32_bf16 v[52:55], v[208:211], a[100:103], v[52:55]
    v_mul_f32 v125, v125, v121
    v_mul_f32 v126, v126, v122
    v_mul_f32 v127, v127, v123
    v_cvt_pk_bf16_f32 v130, v124, v125
    v_mfma_f32_16x16x32_bf16 v[56:59], v[208:211], a[104:107], v[56:59]
    s_waitcnt vmcnt(13)
    ds_read_b128 a[244:247], v6 offset:62464
    v_cvt_pk_bf16_f32 v131, v126, v127
    ds_write_b64 v2, v[130:131] offset:1024
    v_mul_f32 v112, v88, v88
    v_mfma_f32_16x16x32_bf16 v[60:63], v[208:211], a[108:111], v[60:63]
    buffer_load_dwordx4 v[196:199], v1, s[20:23], s36 offen offset:0 sc1
    v_mfma_f32_16x16x32_bf16 v[48:51], v[212:215], a[112:115], v[48:51]
    ds_read_b128 a[248:251], v6 offset:63488
    v_mul_f32 v113, v89, v89
    v_mul_f32 v114, v90, v90
    v_mul_f32 v115, v91, v91
    v_fma_f32 v112, v112, v5, v4
    v_mfma_f32_16x16x32_bf16 v[52:55], v[212:215], a[116:119], v[52:55]
    v_fma_f32 v113, v113, v5, v4
    v_fma_f32 v114, v114, v5, v4
    v_fma_f32 v115, v115, v5, v4
    v_mul_f32 v112, v112, v88
    v_mfma_f32_16x16x32_bf16 v[56:59], v[212:215], a[120:123], v[56:59]
    s_waitcnt vmcnt(13)
    ds_read_b128 a[252:255], v6 offset:64512
    v_mul_f32 v113, v113, v89
    v_mul_f32 v114, v114, v90
    v_mul_f32 v115, v115, v91
    v_exp_f32 v112, v112
    v_mfma_f32_16x16x32_bf16 v[60:63], v[212:215], a[124:127], v[60:63]
    buffer_load_dwordx4 v[200:203], v1, s[20:23], s36 offen offset:1024 sc1
    v_mfma_f32_16x16x32_bf16 v[48:51], v[216:219], a[128:131], v[48:51]
    v_exp_f32 v113, v113
    v_exp_f32 v114, v114
    v_mfma_f32_16x16x32_bf16 v[52:55], v[216:219], a[132:135], v[52:55]
    v_exp_f32 v115, v115
    v_mul_f32 v116, v88, v104
    v_mul_f32 v117, v89, v105
    v_mfma_f32_16x16x32_bf16 v[56:59], v[216:219], a[136:139], v[56:59]
    s_waitcnt vmcnt(13)
    v_mul_f32 v118, v90, v106
    v_mul_f32 v119, v91, v107
    v_add_f32 v112, 1.0, v112
    v_add_f32 v113, 1.0, v113
    v_mfma_f32_16x16x32_bf16 v[60:63], v[216:219], a[140:143], v[60:63]
    buffer_load_dwordx4 v[204:207], v1, s[20:23], s36 offen offset:2048 sc1
    v_mfma_f32_16x16x32_bf16 v[48:51], v[220:223], a[144:147], v[48:51]
    s_add_u32 s36, s37, s58
    v_add_f32 v114, 1.0, v114
    v_add_f32 v115, 1.0, v115
    v_rcp_f32 v112, v112
    v_mfma_f32_16x16x32_bf16 v[52:55], v[220:223], a[148:151], v[52:55]
    v_rcp_f32 v113, v113
    v_rcp_f32 v114, v114
    v_mfma_f32_16x16x32_bf16 v[56:59], v[220:223], a[152:155], v[56:59]
    s_waitcnt vmcnt(13)
    v_rcp_f32 v115, v115
    v_mul_f32 v116, v116, v112
    v_mul_f32 v117, v117, v113
    v_mul_f32 v118, v118, v114
    v_mfma_f32_16x16x32_bf16 v[60:63], v[220:223], a[156:159], v[60:63]
    buffer_load_dwordx4 v[208:211], v1, s[20:23], s36 offen offset:0 sc1
    v_mfma_f32_16x16x32_bf16 v[48:51], v[224:227], a[160:163], v[48:51]
    v_mul_f32 v119, v119, v115
    v_cvt_pk_bf16_f32 v128, v116, v117
    v_cvt_pk_bf16_f32 v129, v118, v119
    ds_write_b64 v2, v[128:129] offset:2048
    v_mfma_f32_16x16x32_bf16 v[52:55], v[224:227], a[164:167], v[52:55]
    v_mul_f32 v120, v92, v92
    v_mul_f32 v121, v93, v93
    v_mul_f32 v122, v94, v94
    v_mfma_f32_16x16x32_bf16 v[56:59], v[224:227], a[168:171], v[56:59]
    s_waitcnt vmcnt(13)
    v_mul_f32 v123, v95, v95
    v_fma_f32 v120, v120, v5, v4
    v_fma_f32 v121, v121, v5, v4
    v_fma_f32 v122, v122, v5, v4
    v_fma_f32 v123, v123, v5, v4
    v_mfma_f32_16x16x32_bf16 v[60:63], v[224:227], a[172:175], v[60:63]
    buffer_load_dwordx4 v[212:215], v1, s[20:23], s36 offen offset:1024 sc1
    v_mfma_f32_16x16x32_bf16 v[48:51], v[228:231], a[176:179], v[48:51]
    v_mul_f32 v120, v120, v92
    v_mul_f32 v121, v121, v93
    v_mul_f32 v122, v122, v94
    v_mul_f32 v123, v123, v95
    v_mfma_f32_16x16x32_bf16 v[52:55], v[228:231], a[180:183], v[52:55]
    v_exp_f32 v120, v120
    v_exp_f32 v121, v121
    v_mfma_f32_16x16x32_bf16 v[56:59], v[228:231], a[184:187], v[56:59]
    s_waitcnt vmcnt(13)
    v_exp_f32 v122, v122
    v_exp_f32 v123, v123
    v_mfma_f32_16x16x32_bf16 v[60:63], v[228:231], a[188:191], v[60:63]
    s_waitcnt lgkmcnt(0)
    buffer_load_dwordx4 v[216:219], v1, s[20:23], s36 offen offset:2048 sc1
    v_mfma_f32_16x16x32_bf16 v[48:51], v[232:235], a[192:195], v[48:51]
    s_add_u32 s36, s37, s59
    v_mul_f32 v124, v92, v108
    v_mul_f32 v125, v93, v109
    v_mul_f32 v126, v94, v110
    v_mul_f32 v127, v95, v111
    v_mfma_f32_16x16x32_bf16 v[52:55], v[232:235], a[196:199], v[52:55]
    v_add_f32 v120, 1.0, v120
    v_add_f32 v121, 1.0, v121
    v_add_f32 v122, 1.0, v122
    v_add_f32 v123, 1.0, v123
    v_mfma_f32_16x16x32_bf16 v[56:59], v[232:235], a[200:203], v[56:59]
    s_waitcnt vmcnt(13)
    v_rcp_f32 v120, v120
    v_rcp_f32 v121, v121
    v_mfma_f32_16x16x32_bf16 v[60:63], v[232:235], a[204:207], v[60:63]
    buffer_load_dwordx4 v[220:223], v1, s[20:23], s36 offen offset:0 sc1
    v_mfma_f32_16x16x32_bf16 v[48:51], v[236:239], a[208:211], v[48:51]
    v_rcp_f32 v122, v122
    v_rcp_f32 v123, v123
    v_mul_f32 v124, v124, v120
    v_mfma_f32_16x16x32_bf16 v[52:55], v[236:239], a[212:215], v[52:55]
    v_mul_f32 v125, v125, v121
    v_mul_f32 v126, v126, v122
    v_mul_f32 v127, v127, v123
    v_cvt_pk_bf16_f32 v130, v124, v125
    v_mfma_f32_16x16x32_bf16 v[56:59], v[236:239], a[216:219], v[56:59]
    s_waitcnt vmcnt(13)
    v_cvt_pk_bf16_f32 v131, v126, v127
    ds_write_b64 v2, v[130:131] offset:3072
    v_add_u32 v2, 8192, v2
    v_mfma_f32_16x16x32_bf16 v[60:63], v[236:239], a[220:223], v[60:63]
    buffer_load_dwordx4 v[224:227], v1, s[20:23], s36 offen offset:1024 sc1
    v_mfma_f32_16x16x32_bf16 v[48:51], v[240:243], a[224:227], v[48:51]
    v_lshl_add_u32 v15, s40, 9, v3
    s_mov_b64 exec, s[8:9]
    ds_read_b128 v[132:135], v15
    s_mov_b64 exec, s[10:11]
    ds_read_b128 v[136:139], v15
    s_mov_b64 exec, s[12:13]
    ds_read_b128 v[140:143], v15
    s_mov_b64 exec, s[14:15]
    ds_read_b128 v[144:147], v15
    s_mov_b64 exec, -1
    v_mfma_f32_16x16x32_bf16 v[52:55], v[240:243], a[228:231], v[52:55]
    v_mfma_f32_16x16x32_bf16 v[56:59], v[240:243], a[232:235], v[56:59]
    s_waitcnt vmcnt(13)
    v_mfma_f32_16x16x32_bf16 v[60:63], v[240:243], a[236:239], v[60:63]
    buffer_load_dwordx4 v[228:231], v1, s[20:23], s36 offen offset:2048 sc1
    s_waitcnt lgkmcnt(0)
    s_barrier
    ds_read_b128 v[16:19], v7 offset:0
    ds_read_b128 v[20:23], v7 offset:1024
    ds_read_b128 v[24:27], v7 offset:2048
    ds_read_b128 v[28:31], v7 offset:3072
    ds_read_b128 v[32:35], v7 offset:4096
    ds_read_b128 v[36:39], v7 offset:5120
    ds_read_b128 v[40:43], v7 offset:6144
    ds_read_b128 v[44:47], v7 offset:7168
    v_mfma_f32_16x16x32_bf16 v[48:51], v[244:247], a[240:243], v[48:51]
    s_add_u32 s36, s37, 12288
    v_and_b32 v10, 7, v0
    v_lshlrev_b32 v10, 12, v10
    v_mfma_f32_16x16x32_bf16 v[52:55], v[244:247], a[244:247], v[52:55]
    v_mfma_f32_16x16x32_bf16 v[56:59], v[244:247], a[248:251], v[56:59]
    s_waitcnt vmcnt(13)
    v_mfma_f32_16x16x32_bf16 v[60:63], v[244:247], a[252:255], v[60:63]
    buffer_load_dwordx4 v[232:235], v1, s[20:23], s36 offen offset:0 sc1
    s_waitcnt lgkmcnt(4)
    v_mfma_f32_16x16x32_bf16 v[48:51], v[248:251], v[16:19], v[48:51]
    v_mfma_f32_16x16x32_bf16 v[52:55], v[248:251], v[20:23], v[52:55]
    s_lshl_b32 s44, s40, 13
    s_mov_b32 s28, 2
    v_mfma_f32_16x16x32_bf16 v[56:59], v[248:251], v[24:27], v[56:59]
    s_waitcnt vmcnt(13)
    v_mfma_f32_16x16x32_bf16 v[60:63], v[248:251], v[28:31], v[60:63]
    s_waitcnt lgkmcnt(0)
    buffer_load_dwordx4 v[236:239], v1, s[20:23], s36 offen offset:1024 sc1
    v_mfma_f32_16x16x32_bf16 v[80:83], v[252:255], v[32:35], v[48:51]
    v_mfma_f32_16x16x32_bf16 v[84:87], v[252:255], v[36:39], v[52:55]
    s_add_u32 s40, s25, s28
    s_and_b32 s40, s40, 7
    s_mul_i32 s41, s40, 77824
    s_add_u32 s37, s41, s27
    v_mfma_f32_16x16x32_bf16 v[88:91], v[252:255], v[40:43], v[56:59]
    s_waitcnt vmcnt(11)
    v_mfma_f32_16x16x32_bf16 v[92:95], v[252:255], v[44:47], v[60:63]
    buffer_load_dwordx4 v[240:243], v1, s[20:23], s36 offen offset:2048 sc1
KM_p2:
    v_mfma_f32_16x16x32_bf16 v[48:51], v[184:187], a[0:3], v[132:135]
    s_add_u32 s36, s36, 3072
    v_mfma_f32_16x16x32_bf16 v[48:51], v[188:191], a[16:19], v[48:51]
    s_cmp_lt_u32 s28, 4
    s_cbranch_scc1 KM_npl
    buffer_load_dwordx2 v[8:9], v10, s[20:23], s33 offen sc1
KM_npl:
    v_mfma_f32_16x16x32_bf16 v[48:51], v[192:195], a[32:35], v[48:51]
    v_mfma_f32_16x16x32_bf16 v[52:55], v[184:187], a[4:7], v[136:139]
    buffer_load_dwordx4 v[244:247], v1, s[20:23], s36 offen offset:0 sc1
    v_mfma_f32_16x16x32_bf16 v[52:55], v[188:191], a[20:23], v[52:55]
    v_lshl_add_u32 v15, s40, 9, v3
    v_mfma_f32_16x16x32_bf16 v[52:55], v[192:195], a[36:39], v[52:55]
    v_mfma_f32_16x16x32_bf16 v[56:59], v[184:187], a[8:11], v[140:143]
    v_mfma_f32_16x16x32_bf16 v[56:59], v[188:191], a[24:27], v[56:59]
    buffer_load_dwordx4 v[248:251], v1, s[20:23], s36 offen offset:1024 sc1
    v_mfma_f32_16x16x32_bf16 v[56:59], v[192:195], a[40:43], v[56:59]
    v_cvt_pk_bf16_f32 v112, v80, v81
    v_cvt_pk_bf16_f32 v113, v82, v83
    v_mfma_f32_16x16x32_bf16 v[60:63], v[184:187], a[12:15], v[144:147]
    v_cvt_pk_bf16_f32 v114, v84, v85
    v_cvt_pk_bf16_f32 v115, v86, v87
    v_mfma_f32_16x16x32_bf16 v[60:63], v[188:191], a[28:31], v[60:63]
    s_waitcnt vmcnt(11)
    v_cvt_pk_bf16_f32 v116, v88, v89
    v_cvt_pk_bf16_f32 v117, v90, v91
    v_mfma_f32_16x16x32_bf16 v[60:63], v[192:195], a[44:47], v[60:63]
    buffer_load_dwordx4 v[252:255], v1, s[20:23], s36 offen offset:2048 sc1
    v_mfma_f32_16x16x32_bf16 v[48:51], v[196:199], a[48:51], v[48:51]
    s_add_u32 s36, s37, s56
    v_cvt_pk_bf16_f32 v118, v92, v93
    v_cvt_pk_bf16_f32 v119, v94, v95
    v_mfma_f32_16x16x32_bf16 v[48:51], v[200:203], a[64:67], v[48:51]
    v_mfma_f32_16x16x32_bf16 v[48:51], v[204:207], a[80:83], v[48:51]
    s_bitcmp1_b32 248, s28
    s_cbranch_scc0 KM_nfl
    s_waitcnt vmcnt(16)
    v_mov_b32 v4, s0
    v_mov_b32 v5, s1
    s_mov_b64 exec, 0xff
    buffer_store_dwordx4 v[4:7], v1, s[20:23], s29 offen sc1
    s_mov_b64 exec, -1
    s_nop 0
    s_add_u32 s29, s29, 512
KM_nfl:
    v_mfma_f32_16x16x32_bf16 v[52:55], v[196:199], a[52:55], v[52:55]
    buffer_load_dwordx4 v[184:187], v1, s[20:23], s36 offen offset:0 sc1
    v_mfma_f32_16x16x32_bf16 v[52:55], v[200:203], a[68:71], v[52:55]
    v_mfma_f32_16x16x32_bf16 v[52:55], v[204:207], a[84:87], v[52:55]
    buffer_store_dwordx4 v[112:115], v1, s[20:23], s39 offen offset:0 sc1
    v_mfma_f32_16x16x32_bf16 v[56:59], v[196:199], a[56:59], v[56:59]
    v_mfma_f32_16x16x32_bf16 v[56:59], v[200:203], a[72:75], v[56:59]
    buffer_load_dwordx4 v[188:191], v1, s[20:23], s36 offen offset:1024 sc1
    v_mfma_f32_16x16x32_bf16 v[56:59], v[204:207], a[88:91], v[56:59]
    v_mfma_f32_16x16x32_bf16 v[60:63], v[196:199], a[60:63], v[60:63]
    buffer_store_dwordx4 v[116:119], v1, s[20:23], s39 offen offset:1024 sc1
    v_mfma_f32_16x16x32_bf16 v[60:63], v[200:203], a[76:79], v[60:63]
    s_waitcnt vmcnt(13)
    v_mfma_f32_16x16x32_bf16 v[60:63], v[204:207], a[92:95], v[60:63]
    buffer_load_dwordx4 v[192:195], v1, s[20:23], s36 offen offset:2048 sc1
    v_mfma_f32_16x16x32_bf16 v[48:51], v[208:211], a[96:99], v[48:51]
    s_add_u32 s36, s37, s57
    s_add_u32 s39, s35, s44
    v_mfma_f32_16x16x32_bf16 v[48:51], v[212:215], a[112:115], v[48:51]
    s_lshl_b32 s44, s40, 13
    v_mfma_f32_16x16x32_bf16 v[48:51], v[216:219], a[128:131], v[48:51]
    s_mov_b64 exec, s[8:9]
    ds_read_b128 v[132:135], v15
    s_mov_b64 exec, s[10:11]
    ds_read_b128 v[136:139], v15
    s_mov_b64 exec, s[12:13]
    ds_read_b128 v[140:143], v15
    s_mov_b64 exec, s[14:15]
    ds_read_b128 v[144:147], v15
    s_mov_b64 exec, -1
    v_mfma_f32_16x16x32_bf16 v[52:55], v[208:211], a[100:103], v[52:55]
    buffer_load_dwordx4 v[196:199], v1, s[20:23], s36 offen offset:0 sc1
    v_mfma_f32_16x16x32_bf16 v[52:55], v[212:215], a[116:119], v[52:55]
    s_sub_u32 s42, s28, 4
    v_mfma_f32_16x16x32_bf16 v[52:55], v[216:219], a[132:135], v[52:55]
    s_add_u32 s28, s28, 1
    v_mfma_f32_16x16x32_bf16 v[56:59], v[208:211], a[104:107], v[56:59]
    v_mfma_f32_16x16x32_bf16 v[56:59], v[212:215], a[120:123], v[56:59]
    buffer_load_dwordx4 v[200:203], v1, s[20:23], s36 offen offset:1024 sc1
    v_mfma_f32_16x16x32_bf16 v[56:59], v[216:219], a[136:139], v[56:59]
    v_mfma_f32_16x16x32_bf16 v[60:63], v[208:211], a[108:111], v[60:63]
    s_waitcnt vmcnt(12)
    v_mfma_f32_16x16x32_bf16 v[60:63], v[212:215], a[124:127], v[60:63]
    s_waitcnt vmcnt(13)
    v_mfma_f32_16x16x32_bf16 v[60:63], v[216:219], a[140:143], v[60:63]
    buffer_load_dwordx4 v[204:207], v1, s[20:23], s36 offen offset:2048 sc1
    v_mfma_f32_16x16x32_bf16 v[48:51], v[220:223], a[144:147], v[48:51]
    s_add_u32 s36, s37, s58
    s_add_u32 s40, s25, s28
    v_lshlrev_b32 v120, 16, v164
    v_and_b32 v121, 0xffff0000, v164
    v_mfma_f32_16x16x32_bf16 v[48:51], v[224:227], a[160:163], v[48:51]
    v_add_f32 v148, v148, v120
    v_add_f32 v149, v149, v121
    v_mfma_f32_16x16x32_bf16 v[48:51], v[228:231], a[176:179], v[48:51]
    v_lshlrev_b32 v122, 16, v165
    v_and_b32 v123, 0xffff0000, v165
    v_mfma_f32_16x16x32_bf16 v[52:55], v[220:223], a[148:151], v[52:55]
    buffer_load_dwordx4 v[208:211], v1, s[20:23], s36 offen offset:0 sc1
    v_mfma_f32_16x16x32_bf16 v[52:55], v[224:227], a[164:167], v[52:55]
    s_and_b32 s40, s40, 7
    v_add_f32 v150, v150, v122
    v_mfma_f32_16x16x32_bf16 v[52:55], v[228:231], a[180:183], v[52:55]
    v_add_f32 v151, v151, v123
    v_lshlrev_b32 v120, 16, v166
    v_mfma_f32_16x16x32_bf16 v[56:59], v[220:223], a[152:155], v[56:59]
    v_and_b32 v121, 0xffff0000, v166
    v_add_f32 v152, v152, v120
    v_mfma_f32_16x16x32_bf16 v[56:59], v[224:227], a[168:171], v[56:59]
    buffer_load_dwordx4 v[212:215], v1, s[20:23], s36 offen offset:1024 sc1
    v_mfma_f32_16x16x32_bf16 v[56:59], v[228:231], a[184:187], v[56:59]
    s_mul_i32 s41, s40, 77824
    v_add_f32 v153, v153, v121
    v_mfma_f32_16x16x32_bf16 v[60:63], v[220:223], a[156:159], v[60:63]
    v_lshlrev_b32 v122, 16, v167
    v_and_b32 v123, 0xffff0000, v167
    v_mfma_f32_16x16x32_bf16 v[60:63], v[224:227], a[172:175], v[60:63]
    s_waitcnt vmcnt(13)
    v_add_f32 v154, v154, v122
    v_add_f32 v155, v155, v123
    v_mfma_f32_16x16x32_bf16 v[60:63], v[228:231], a[188:191], v[60:63]
    buffer_load_dwordx4 v[216:219], v1, s[20:23], s36 offen offset:2048 sc1
    v_mfma_f32_16x16x32_bf16 v[48:51], v[232:235], a[192:195], v[48:51]
    s_add_u32 s36, s37, s59
    v_lshlrev_b32 v120, 16, v168
    v_mfma_f32_16x16x32_bf16 v[48:51], v[236:239], a[208:211], v[48:51]
    s_waitcnt vmcnt(14)
    v_cmp_ne_u64 vcc, s[0:1], v[8:9]
    v_and_b32 v121, 0xffff0000, v168
    v_add_f32 v156, v156, v120
    v_mfma_f32_16x16x32_bf16 v[48:51], v[240:243], a[224:227], v[48:51]
    v_add_f32 v157, v157, v121
    v_lshlrev_b32 v122, 16, v169
    v_mfma_f32_16x16x32_bf16 v[52:55], v[232:235], a[196:199], v[52:55]
    buffer_load_dwordx4 v[220:223], v1, s[20:23], s36 offen offset:0 sc1
    v_mfma_f32_16x16x32_bf16 v[52:55], v[236:239], a[212:215], v[52:55]
    s_sub_u32 s31, s25, s42
    v_and_b32 v123, 0xffff0000, v169
    v_mfma_f32_16x16x32_bf16 v[52:55], v[240:243], a[228:231], v[52:55]
    s_and_b32 s31, s31, 7
    v_add_f32 v158, v158, v122
    v_add_f32 v159, v159, v123
    v_mfma_f32_16x16x32_bf16 v[56:59], v[232:235], a[200:203], v[56:59]
    v_lshlrev_b32 v120, 16, v170
    v_and_b32 v121, 0xffff0000, v170
    v_mfma_f32_16x16x32_bf16 v[56:59], v[236:239], a[216:219], v[56:59]
    buffer_load_dwordx4 v[224:227], v1, s[20:23], s36 offen offset:1024 sc1
    v_mfma_f32_16x16x32_bf16 v[56:59], v[240:243], a[232:235], v[56:59]
    s_mul_i32 s31, s31, 2359296
    v_add_f32 v160, v160, v120
    v_mfma_f32_16x16x32_bf16 v[60:63], v[232:235], a[204:207], v[60:63]
    s_add_u32 s31, s31, s34
    v_add_f32 v161, v161, v121
    v_lshlrev_b32 v122, 16, v171
    v_mfma_f32_16x16x32_bf16 v[60:63], v[236:239], a[220:223], v[60:63]
    s_waitcnt vmcnt(13)
    v_and_b32 v123, 0xffff0000, v171
    v_add_f32 v162, v162, v122
    v_mfma_f32_16x16x32_bf16 v[60:63], v[240:243], a[236:239], v[60:63]
    buffer_load_dwordx4 v[228:231], v1, s[20:23], s36 offen offset:2048 sc1
    v_mfma_f32_16x16x32_bf16 v[48:51], v[244:247], a[240:243], v[48:51]
    s_add_u32 s36, s37, 12288
    s_waitcnt lgkmcnt(0)
    v_add_f32 v163, v163, v123
    v_mfma_f32_16x16x32_bf16 v[48:51], v[248:251], v[16:19], v[48:51]
    s_cbranch_vccnz KM_gspin
KM_gok:
    v_mfma_f32_16x16x32_bf16 v[80:83], v[252:255], v[32:35], v[48:51]
    v_mfma_f32_16x16x32_bf16 v[52:55], v[244:247], a[244:247], v[52:55]
    buffer_load_dwordx4 v[232:235], v1, s[20:23], s36 offen offset:0 sc1
    v_mfma_f32_16x16x32_bf16 v[52:55], v[248:251], v[20:23], v[52:55]
    v_mfma_f32_16x16x32_bf16 v[84:87], v[252:255], v[36:39], v[52:55]
    s_cmp_lt_u32 s28, 5
    s_cbranch_scc1 KM_ng
    v_mov_b32 v10, 0
    s_add_u32 s30, s30, 512
    s_sub_u32 s43, s25, s42
    s_sub_u32 s43, s43, 1
    s_and_b32 s43, s43, 7
    s_lshl_b32 s43, s43, 12
    s_add_u32 s33, s43, s30
    s_cmp_eq_u32 s28, 5
    s_cbranch_scc0 KM_gj
    buffer_load_dwordx4 v[176:179], v11, s[20:23], s47 offen offset:0 sc1
    buffer_load_dwordx4 v[180:183], v11, s[20:23], s48 offen offset:1024 sc1
    s_branch KM_ng
KM_gj:
    buffer_load_dwordx4 v[164:167], v1, s[20:23], s31 offen offset:0 sc1
    buffer_load_dwordx4 v[168:171], v1, s[20:23], s31 offen offset:1024 sc1
KM_ng:
    v_mfma_f32_16x16x32_bf16 v[56:59], v[244:247], a[248:251], v[56:59]
    v_mfma_f32_16x16x32_bf16 v[56:59], v[248:251], v[24:27], v[56:59]
    buffer_load_dwordx4 v[236:239], v1, s[20:23], s36 offen offset:1024 sc1
    v_mfma_f32_16x16x32_bf16 v[88:91], v[252:255], v[40:43], v[56:59]
    s_add_u32 s37, s41, s27
    v_mfma_f32_16x16x32_bf16 v[60:63], v[244:247], a[252:255], v[60:63]
    s_cmp_lg_u32 s28, 9
    v_mfma_f32_16x16x32_bf16 v[60:63], v[248:251], v[28:31], v[60:63]
    s_waitcnt vmcnt(11)
    v_mfma_f32_16x16x32_bf16 v[92:95], v[252:255], v[44:47], v[60:63]
    buffer_load_dwordx4 v[240:243], v1, s[20:23], s36 offen offset:2048 sc1
    s_cbranch_scc1 KM_p2
KM_s8:
    s_sub_u32 s49, s25, 5
    s_and_b32 s49, s49, 7
    s_mul_i32 s49, s49, 2359296
    s_add_u32 s49, s49, s34
    v_mfma_f32_16x16x32_bf16 v[48:51], v[184:187], a[0:3], v[132:135]
    s_add_u32 s36, s36, 3072
    s_sub_u32 s50, s25, 6
    s_and_b32 s50, s50, 7
    v_mfma_f32_16x16x32_bf16 v[48:51], v[188:191], a[16:19], v[48:51]
    s_mul_i32 s50, s50, 2359296
    s_add_u32 s50, s50, s34
    v_mfma_f32_16x16x32_bf16 v[48:51], v[192:195], a[32:35], v[48:51]
    buffer_load_dwordx4 v[64:67], v1, s[20:23], s49 offen offset:0 sc1
    v_mfma_f32_16x16x32_bf16 v[52:55], v[184:187], a[4:7], v[136:139]
    s_sub_u32 s51, s25, 7
    s_and_b32 s51, s51, 7
    buffer_load_dwordx4 v[244:247], v1, s[20:23], s36 offen offset:0 sc1
    v_mfma_f32_16x16x32_bf16 v[52:55], v[188:191], a[20:23], v[52:55]
    s_mul_i32 s51, s51, 2359296
    s_add_u32 s51, s51, s34
    v_mfma_f32_16x16x32_bf16 v[52:55], v[192:195], a[36:39], v[52:55]
    buffer_load_dwordx4 v[68:71], v1, s[20:23], s49 offen offset:1024 sc1
    v_mfma_f32_16x16x32_bf16 v[56:59], v[184:187], a[8:11], v[140:143]
    v_mfma_f32_16x16x32_bf16 v[56:59], v[188:191], a[24:27], v[56:59]
    v_cvt_pk_bf16_f32 v112, v80, v81
    v_cvt_pk_bf16_f32 v113, v82, v83
    buffer_load_dwordx4 v[248:251], v1, s[20:23], s36 offen offset:1024 sc1
    v_mfma_f32_16x16x32_bf16 v[56:59], v[192:195], a[40:43], v[56:59]
    v_cvt_pk_bf16_f32 v114, v84, v85
    v_cvt_pk_bf16_f32 v115, v86, v87
    v_mfma_f32_16x16x32_bf16 v[60:63], v[184:187], a[12:15], v[144:147]
    v_cvt_pk_bf16_f32 v116, v88, v89
    v_cvt_pk_bf16_f32 v117, v90, v91
    v_mfma_f32_16x16x32_bf16 v[60:63], v[188:191], a[28:31], v[60:63]
    s_waitcnt vmcnt(13)
    v_cvt_pk_bf16_f32 v118, v92, v93
    v_cvt_pk_bf16_f32 v119, v94, v95
    v_mfma_f32_16x16x32_bf16 v[60:63], v[192:195], a[44:47], v[60:63]
    buffer_store_dwordx4 v[112:115], v1, s[20:23], s39 offen offset:0 sc1
    buffer_load_dwordx4 v[252:255], v1, s[20:23], s36 offen offset:2048 sc1
    v_mfma_f32_16x16x32_bf16 v[48:51], v[196:199], a[48:51], v[48:51]
    v_mfma_f32_16x16x32_bf16 v[48:51], v[200:203], a[64:67], v[48:51]
    buffer_store_dwordx4 v[116:119], v1, s[20:23], s39 offen offset:1024 sc1
    v_mfma_f32_16x16x32_bf16 v[48:51], v[204:207], a[80:83], v[48:51]
    v_mfma_f32_16x16x32_bf16 v[52:55], v[196:199], a[52:55], v[52:55]
    buffer_load_dwordx4 v[72:75], v1, s[20:23], s50 offen offset:0 sc1
    v_mfma_f32_16x16x32_bf16 v[52:55], v[200:203], a[68:71], v[52:55]
    s_mov_b32 s6, 2359296
    v_lshlrev_b32 v104, 16, v176
    v_and_b32 v105, 0xffff0000, v176
    v_lshlrev_b32 v172, 16, v180
    v_mfma_f32_16x16x32_bf16 v[52:55], v[204:207], a[84:87], v[52:55]
    s_mov_b32 s7, 0x20000
    v_and_b32 v173, 0xffff0000, v180
    v_add_f32 v104, v104, v172
    v_mfma_f32_16x16x32_bf16 v[56:59], v[196:199], a[56:59], v[56:59]
    v_add_f32 v105, v105, v173
    v_lshlrev_b32 v106, 16, v177
    v_mfma_f32_16x16x32_bf16 v[56:59], v[200:203], a[72:75], v[56:59]
    buffer_load_dwordx4 v[76:79], v1, s[20:23], s50 offen offset:1024 sc1
    v_mfma_f32_16x16x32_bf16 v[56:59], v[204:207], a[88:91], v[56:59]
    s_mul_i32 s41, s24, 73728
    v_and_b32 v107, 0xffff0000, v177
    v_lshlrev_b32 v172, 16, v181
    v_mfma_f32_16x16x32_bf16 v[60:63], v[196:199], a[60:63], v[60:63]
    s_and_b32 s42, s25, 1
    v_and_b32 v173, 0xffff0000, v181
    v_add_f32 v106, v106, v172
    v_add_f32 v107, v107, v173
    v_mfma_f32_16x16x32_bf16 v[60:63], v[200:203], a[76:79], v[60:63]
    s_waitcnt vmcnt(15)
    v_lshlrev_b32 v108, 16, v178
    v_and_b32 v109, 0xffff0000, v178
    v_mfma_f32_16x16x32_bf16 v[60:63], v[204:207], a[92:95], v[60:63]
    s_mul_i32 s42, s42, 36864
    v_lshlrev_b32 v172, 16, v182
    v_and_b32 v173, 0xffff0000, v182
    v_mfma_f32_16x16x32_bf16 v[48:51], v[208:211], a[96:99], v[48:51]
    s_lshr_b32 s43, s25, 1
    v_add_f32 v108, v108, v172
    v_add_f32 v109, v109, v173
    v_mfma_f32_16x16x32_bf16 v[48:51], v[212:215], a[112:115], v[48:51]
    s_lshl2_add_u32 s43, s43, s26
    v_lshlrev_b32 v110, 16, v179
    v_and_b32 v111, 0xffff0000, v179
    v_lshlrev_b32 v172, 16, v183
    v_mfma_f32_16x16x32_bf16 v[48:51], v[216:219], a[128:131], v[48:51]
    v_and_b32 v173, 0xffff0000, v183
    v_add_f32 v110, v110, v172
    v_mfma_f32_16x16x32_bf16 v[52:55], v[208:211], a[100:103], v[52:55]
    s_lshl3_add_u32 s42, s43, s42
    v_add_f32 v111, v111, v173
    v_permlane32_swap_b32 v104, v108
    v_mfma_f32_16x16x32_bf16 v[52:55], v[212:215], a[116:119], v[52:55]
    s_add_u32 s42, s42, s41
    v_permlane32_swap_b32 v105, v109
    v_permlane32_swap_b32 v106, v110
    v_mfma_f32_16x16x32_bf16 v[52:55], v[216:219], a[132:135], v[52:55]
    s_lshl2_add_u32 s43, s25, s26
    v_permlane32_swap_b32 v107, v111
    v_add_f32 v104, v104, v108
    v_add_f32 v106, v106, v110
    v_mfma_f32_16x16x32_bf16 v[56:59], v[208:211], a[104:107], v[56:59]
    v_add_f32 v105, v105, v109
    v_add_f32 v107, v107, v111
    v_mfma_f32_16x16x32_bf16 v[56:59], v[212:215], a[120:123], v[56:59]
    s_lshl_b32 s43, s43, 5
    s_nop 0
    v_permlane16_swap_b32 v104, v106
    v_mfma_f32_16x16x32_bf16 v[56:59], v[216:219], a[136:139], v[56:59]
    s_add_u32 s41, s41, s43
    v_permlane16_swap_b32 v105, v107
    v_add_f32 v104, v104, v106
    v_mfma_f32_16x16x32_bf16 v[60:63], v[208:211], a[108:111], v[60:63]
    v_add_f32 v105, v105, v107
    v_cvt_pk_bf16_f32 v104, v104, v105
    v_mfma_f32_16x16x32_bf16 v[60:63], v[212:215], a[124:127], v[60:63]
    s_waitcnt vmcnt(12)
    v_mfma_f32_16x16x32_bf16 v[60:63], v[216:219], a[140:143], v[60:63]
    v_mfma_f32_16x16x32_bf16 v[48:51], v[220:223], a[144:147], v[48:51]
    buffer_store_dword v104, v14, s[4:7], s42 offen offset:1024
    v_mfma_f32_16x16x32_bf16 v[48:51], v[224:227], a[160:163], v[48:51]
    s_waitcnt vmcnt(7)
    v_max3_u32 v124, v64, v65, v66
    v_max3_u32 v124, v124, v67, v68
    v_max3_u32 v124, v124, v69, v70
    v_max_u32 v124, v124, v71
    v_cmp_eq_u32 vcc, -1, v124
    s_waitcnt vmcnt(12)
    v_mfma_f32_16x16x32_bf16 v[48:51], v[228:231], a[176:179], v[48:51]
    v_mfma_f32_16x16x32_bf16 v[52:55], v[220:223], a[148:151], v[52:55]
    v_mfma_f32_16x16x32_bf16 v[52:55], v[224:227], a[164:167], v[52:55]
    v_lshlrev_b32 v120, 16, v164
    v_and_b32 v121, 0xffff0000, v164
    v_add_f32 v148, v148, v120
    v_mfma_f32_16x16x32_bf16 v[52:55], v[228:231], a[180:183], v[52:55]
    v_add_f32 v149, v149, v121
    v_lshlrev_b32 v122, 16, v165
    v_mfma_f32_16x16x32_bf16 v[56:59], v[220:223], a[152:155], v[56:59]
    v_and_b32 v123, 0xffff0000, v165
    v_add_f32 v150, v150, v122
    v_mfma_f32_16x16x32_bf16 v[56:59], v[224:227], a[168:171], v[56:59]
    v_add_f32 v151, v151, v123
    v_lshlrev_b32 v120, 16, v166
    v_and_b32 v121, 0xffff0000, v166
    v_mfma_f32_16x16x32_bf16 v[56:59], v[228:231], a[184:187], v[56:59]
    v_add_f32 v152, v152, v120
    v_add_f32 v153, v153, v121
    v_mfma_f32_16x16x32_bf16 v[60:63], v[220:223], a[156:159], v[60:63]
    v_lshlrev_b32 v122, 16, v167
    v_and_b32 v123, 0xffff0000, v167
    v_mfma_f32_16x16x32_bf16 v[60:63], v[224:227], a[172:175], v[60:63]
    s_waitcnt vmcnt(10)
    v_add_f32 v154, v154, v122
    v_add_f32 v155, v155, v123
    v_mfma_f32_16x16x32_bf16 v[60:63], v[228:231], a[188:191], v[60:63]
    v_lshlrev_b32 v120, 16, v168
    v_and_b32 v121, 0xffff0000, v168
    v_add_f32 v156, v156, v120
    v_mfma_f32_16x16x32_bf16 v[48:51], v[232:235], a[192:195], v[48:51]
    v_add_f32 v157, v157, v121
    v_lshlrev_b32 v122, 16, v169
    v_mfma_f32_16x16x32_bf16 v[48:51], v[236:239], a[208:211], v[48:51]
    v_and_b32 v123, 0xffff0000, v169
    v_add_f32 v158, v158, v122
    v_mfma_f32_16x16x32_bf16 v[48:51], v[240:243], a[224:227], v[48:51]
    v_add_f32 v159, v159, v123
    v_lshlrev_b32 v120, 16, v170
    v_and_b32 v121, 0xffff0000, v170
    v_mfma_f32_16x16x32_bf16 v[52:55], v[232:235], a[196:199], v[52:55]
    v_add_f32 v160, v160, v120
    v_add_f32 v161, v161, v121
    v_mfma_f32_16x16x32_bf16 v[52:55], v[236:239], a[212:215], v[52:55]
    v_lshlrev_b32 v122, 16, v171
    v_and_b32 v123, 0xffff0000, v171
    v_mfma_f32_16x16x32_bf16 v[52:55], v[240:243], a[228:231], v[52:55]
    v_add_f32 v162, v162, v122
    v_add_f32 v163, v163, v123
    v_mfma_f32_16x16x32_bf16 v[56:59], v[232:235], a[200:203], v[56:59]
    v_mfma_f32_16x16x32_bf16 v[56:59], v[236:239], a[216:219], v[56:59]
    s_cbranch_vccnz KM_g5spin
KM_g5ok:
    v_mfma_f32_16x16x32_bf16 v[56:59], v[240:243], a[232:235], v[56:59]
    v_lshlrev_b32 v120, 16, v64
    v_and_b32 v121, 0xffff0000, v64
    v_mfma_f32_16x16x32_bf16 v[60:63], v[232:235], a[204:207], v[60:63]
    v_add_f32 v148, v148, v120
    v_add_f32 v149, v149, v121
    v_mfma_f32_16x16x32_bf16 v[60:63], v[236:239], a[220:223], v[60:63]
    s_waitcnt vmcnt(4)
    v_lshlrev_b32 v122, 16, v65
    v_and_b32 v123, 0xffff0000, v65
    v_mfma_f32_16x16x32_bf16 v[60:63], v[240:243], a[236:239], v[60:63]
    buffer_load_dwordx4 v[96:99], v1, s[20:23], s51 offen offset:0 sc1
    v_mfma_f32_16x16x32_bf16 v[48:51], v[244:247], a[240:243], v[48:51]
    v_add_f32 v150, v150, v122
    v_add_f32 v151, v151, v123
    v_mfma_f32_16x16x32_bf16 v[48:51], v[248:251], v[16:19], v[48:51]
    v_lshlrev_b32 v120, 16, v66
    v_and_b32 v121, 0xffff0000, v66
    v_mfma_f32_16x16x32_bf16 v[80:83], v[252:255], v[32:35], v[48:51]
    v_add_f32 v152, v152, v120
    v_add_f32 v153, v153, v121
    v_mfma_f32_16x16x32_bf16 v[52:55], v[244:247], a[244:247], v[52:55]
    buffer_load_dwordx4 v[100:103], v1, s[20:23], s51 offen offset:1024 sc1
    v_mfma_f32_16x16x32_bf16 v[52:55], v[248:251], v[20:23], v[52:55]
    v_lshlrev_b32 v122, 16, v67
    v_and_b32 v123, 0xffff0000, v67
    v_mfma_f32_16x16x32_bf16 v[84:87], v[252:255], v[36:39], v[52:55]
    v_add_f32 v154, v154, v122
    v_add_f32 v155, v155, v123
    v_mfma_f32_16x16x32_bf16 v[56:59], v[244:247], a[248:251], v[56:59]
    v_lshlrev_b32 v120, 16, v68
    v_and_b32 v121, 0xffff0000, v68
    v_mfma_f32_16x16x32_bf16 v[56:59], v[248:251], v[24:27], v[56:59]
    v_add_f32 v156, v156, v120
    v_add_f32 v157, v157, v121
    v_mfma_f32_16x16x32_bf16 v[88:91], v[252:255], v[40:43], v[56:59]
    v_lshlrev_b32 v122, 16, v69
    v_and_b32 v123, 0xffff0000, v69
    v_mfma_f32_16x16x32_bf16 v[60:63], v[244:247], a[252:255], v[60:63]
    v_add_f32 v158, v158, v122
    v_add_f32 v159, v159, v123
    v_mfma_f32_16x16x32_bf16 v[60:63], v[248:251], v[28:31], v[60:63]
    v_lshlrev_b32 v120, 16, v70
    v_and_b32 v121, 0xffff0000, v70
    v_mfma_f32_16x16x32_bf16 v[92:95], v[252:255], v[44:47], v[60:63]
    v_add_f32 v160, v160, v120
    v_add_f32 v161, v161, v121
KM_tl:
    v_lshlrev_b32 v122, 16, v71
    v_and_b32 v123, 0xffff0000, v71
    v_add_f32 v162, v162, v122
    v_add_f32 v163, v163, v123
    s_waitcnt vmcnt(3)
    v_max3_u32 v124, v72, v73, v74
    v_max3_u32 v124, v124, v75, v76
    v_max3_u32 v124, v124, v77, v78
    v_max_u32 v124, v124, v79
    v_cmp_eq_u32 vcc, -1, v124
    v_pk_add_f32 v[148:149], v[148:149], v[80:81]
    v_pk_add_f32 v[150:151], v[150:151], v[82:83]
    v_pk_add_f32 v[152:153], v[152:153], v[84:85]
    v_pk_add_f32 v[154:155], v[154:155], v[86:87]
    v_pk_add_f32 v[156:157], v[156:157], v[88:89]
    v_pk_add_f32 v[158:159], v[158:159], v[90:91]
    v_pk_add_f32 v[160:161], v[160:161], v[92:93]
    v_pk_add_f32 v[162:163], v[162:163], v[94:95]
    s_cbranch_vccnz KM_g6spin
KM_g6ok:
    v_lshlrev_b32 v120, 16, v72
    v_and_b32 v121, 0xffff0000, v72
    v_pk_add_f32 v[148:149], v[148:149], v[120:121]
    v_lshlrev_b32 v122, 16, v73
    v_and_b32 v123, 0xffff0000, v73
    s_branch KO_10
KP_10:
    s_branch KP_back2
KO_10:
    v_pk_add_f32 v[150:151], v[150:151], v[122:123]
    v_lshlrev_b32 v120, 16, v74
    v_and_b32 v121, 0xffff0000, v74
    v_pk_add_f32 v[152:153], v[152:153], v[120:121]
    v_lshlrev_b32 v122, 16, v75
    v_and_b32 v123, 0xffff0000, v75
    v_pk_add_f32 v[154:155], v[154:155], v[122:123]
    v_lshlrev_b32 v120, 16, v76
    v_and_b32 v121, 0xffff0000, v76
    v_pk_add_f32 v[156:157], v[156:157], v[120:121]
    v_lshlrev_b32 v122, 16, v77
    v_and_b32 v123, 0xffff0000, v77
    v_pk_add_f32 v[158:159], v[158:159], v[122:123]
    v_lshlrev_b32 v120, 16, v78
    v_and_b32 v121, 0xffff0000, v78
    v_pk_add_f32 v[160:161], v[160:161], v[120:121]
    v_lshlrev_b32 v122, 16, v79
    v_and_b32 v123, 0xffff0000, v79
    v_pk_add_f32 v[162:163], v[162:163], v[122:123]
    s_waitcnt vmcnt(0)
    v_max3_u32 v124, v96, v97, v98
    v_max3_u32 v124, v124, v99, v100
    v_max3_u32 v124, v124, v101, v102
    v_max_u32 v124, v124, v103
    v_cmp_eq_u32 vcc, -1, v124
    s_cbranch_vccnz KM_g7spin
KM_g7ok:
    v_lshlrev_b32 v120, 16, v96
    v_and_b32 v121, 0xffff0000, v96
    v_pk_add_f32 v[148:149], v[148:149], v[120:121]
    v_lshlrev_b32 v122, 16, v97
    v_and_b32 v123, 0xffff0000, v97
    v_pk_add_f32 v[150:151], v[150:151], v[122:123]
    v_lshlrev_b32 v120, 16, v98
    v_and_b32 v121, 0xffff0000, v98
    v_pk_add_f32 v[152:153], v[152:153], v[120:121]
    v_lshlrev_b32 v122, 16, v99
    v_and_b32 v123, 0xffff0000, v99
    v_pk_add_f32 v[154:155], v[154:155], v[122:123]
    v_cvt_pk_bf16_f32 v80, v148, v149
    v_cvt_pk_bf16_f32 v82, v152, v153
    v_cvt_pk_bf16_f32 v81, v150, v151
    v_cvt_pk_bf16_f32 v83, v154, v155
    s_nop 0
    v_permlane16_swap_b32 v80, v82
    v_permlane16_swap_b32 v81, v83
    buffer_store_dwordx4 v[80:83], v13, s[4:7], s41 offen
    s_add_u32 s41, s41, 36864
    v_lshlrev_b32 v120, 16, v100
    v_and_b32 v121, 0xffff0000, v100
    v_pk_add_f32 v[156:157], v[156:157], v[120:121]
    v_lshlrev_b32 v122, 16, v101
    v_and_b32 v123, 0xffff0000, v101
    v_pk_add_f32 v[158:159], v[158:159], v[122:123]
    v_lshlrev_b32 v120, 16, v102
    v_and_b32 v121, 0xffff0000, v102
    v_pk_add_f32 v[160:161], v[160:161], v[120:121]
    v_lshlrev_b32 v122, 16, v103
    v_and_b32 v123, 0xffff0000, v103
    v_pk_add_f32 v[162:163], v[162:163], v[122:123]
    v_cvt_pk_bf16_f32 v84, v156, v157
    v_cvt_pk_bf16_f32 v86, v160, v161
    v_cvt_pk_bf16_f32 v85, v158, v159
    v_cvt_pk_bf16_f32 v87, v162, v163
    s_nop 0
    v_permlane16_swap_b32 v84, v86
    v_permlane16_swap_b32 v85, v87
    buffer_store_dwordx4 v[84:87], v13, s[4:7], s41 offen
    s_add_u32 s41, s41, 36864
KM_end:
    s_endpgm
KM_g7spin:
    buffer_load_dwordx4 v[96:99], v1, s[20:23], s51 offen offset:0 sc1
    buffer_load_dwordx4 v[100:103], v1, s[20:23], s51 offen offset:1024 sc1
    s_waitcnt vmcnt(0)
    v_max3_u32 v124, v96, v97, v98
    v_max3_u32 v124, v124, v99, v100
    v_max3_u32 v124, v124, v101, v102
    v_max_u32 v124, v124, v103
    v_cmp_eq_u32 vcc, -1, v124
    s_cbranch_vccz KM_g7spin_ok
    s_sub_u32 s54, s54, 1
    s_cbranch_scc0 KM_g7spin
    s_mov_b32 s54, 0
KM_g7spin_ok:
    s_branch KM_g7ok
KM_g6spin:
    buffer_load_dwordx4 v[72:75], v1, s[20:23], s50 offen offset:0 sc1
    buffer_load_dwordx4 v[76:79], v1, s[20:23], s50 offen offset:1024 sc1
    s_waitcnt vmcnt(0)
    v_max3_u32 v124, v72, v73, v74
    v_max3_u32 v124, v124, v75, v76
    v_max3_u32 v124, v124, v77, v78
    v_max_u32 v124, v124, v79
    v_cmp_eq_u32 vcc, -1, v124
    s_cbranch_vccz KM_g6spin_ok
    s_sub_u32 s54, s54, 1
    s_cbranch_scc0 KM_g6spin
    s_mov_b32 s54, 0
KM_g6spin_ok:
    s_branch KM_g6ok
KM_g5spin:
    buffer_load_dwordx4 v[64:67], v1, s[20:23], s49 offen offset:0 sc1
    buffer_load_dwordx4 v[68:71], v1, s[20:23], s49 offen offset:1024 sc1
    s_waitcnt vmcnt(0)
    v_max3_u32 v124, v64, v65, v66
    v_max3_u32 v124, v124, v67, v68
    v_max3_u32 v124, v124, v69, v70
    v_max_u32 v124, v124, v71
    v_cmp_eq_u32 vcc, -1, v124
    s_cbranch_vccz KM_g5spin_ok
    s_sub_u32 s54, s54, 1
    s_cbranch_scc0 KM_g5spin
    s_mov_b32 s54, 0
KM_g5spin_ok:
    s_branch KM_g5ok
KM_gspin:
    buffer_load_dwordx2 v[8:9], v10, s[20:23], s33 offen sc1
    s_waitcnt vmcnt(0)
    v_cmp_ne_u64 vcc, s[0:1], v[8:9]
    s_cbranch_vccz KM_gspin_ok
    s_sub_u32 s54, s54, 1
    s_cbranch_scc0 KM_gspin
    s_mov_b32 s54, 0
KM_gspin_ok:
    s_branch KM_gok
KM_s0spin:
    buffer_load_dwordx2 v[20:21], v22, s[20:23], s43 offen sc1
    s_waitcnt vmcnt(0)
    v_cmp_ne_u64 vcc, s[0:1], v[20:21]
    s_cbranch_vccz KM_s0spin_ok
    s_sub_u32 s54, s54, 1
    s_cbranch_scc0 KM_s0spin
    s_mov_b32 s54, 0
KM_s0spin_ok:
    s_branch KM_s0ok
KM_nspin:
    buffer_load_dwordx2 v[150:151], off, s[16:19], 0 sc1
    s_waitcnt vmcnt(0)
    v_cmp_eq_u64 vcc, 0, v[150:151]
    s_cbranch_vccz KM_nspin_ok
    s_sub_u32 s54, s54, 1
    s_cbranch_scc0 KM_nspin
    s_mov_b32 s54, 0
KM_nspin_ok:
    s_branch KM_nok
KM_fh:
    buffer_load_dwordx2 v[128:129], v130, s[20:23], s97 offen sc1
    s_waitcnt vmcnt(0)
    v_cmp_ne_u64 vcc, s[0:1], v[128:129]
    s_cbranch_vccz KM_fh_ok
    s_sub_u32 s54, s54, 1
    s_cbranch_scc0 KM_fh
    s_mov_b32 s54, 0
KM_fh_ok:
    s_branch KM_fhok
KM_slow:
    s_nop 7
    s_waitcnt vmcnt(0)
    s_lshl_b32 s40, s26, 11
    s_add_u32 s42, s40, 2424832
    s_lshl_b32 s40, s26, 14
    s_add_u32 s40, s40, 2359296
    s_mul_i32 s3, s26, 18432
    s_add_u32 s41, s3, 2457600
    v_lshlrev_b32 v144, 2, v0
    v_and_b32 v15, 31, v0
    v_lshrrev_b32 v36, 5, v0
    v_mul_u32_u24 v36, 288, v36
    v_lshl_add_u32 v36, v15, 4, v36
    v_add_u32 v36, s3, v36
    v_min_u32 v37, 19, v15
    v_lshlrev_b32 v37, 4, v37
    v_cmp_gt_u32 vcc, 18, v15
    v_add_u32 v37, 125216, v37
    v_mov_b32 v38, 2304
    v_cndmask_b32 v2, v37, v36, vcc
    v_cndmask_b32 v145, 0, v38, vcc
    v_bfe_u32 v36, v0, 3, 2
    v_mul_u32_u24 v36, 576, v36
    v_and_b32 v37, 7, v0
    v_cmp_gt_u32 vcc, 4, v37
    v_lshl_add_u32 v36, v37, 2, v36
    v_add_u32 v36, 125504, v36
    v_mov_b32 v38, 0x3f803f80
    v_cndmask_b32 v37, 0, v38, vcc
    ds_write_b32 v36, v37
    buffer_load_dword a192, v144, s[20:23], s42 offen offset:0 sc1
    buffer_load_dword a193, v144, s[20:23], s42 offen offset:256 sc1
    buffer_load_dword a194, v144, s[20:23], s42 offen offset:512 sc1
    buffer_load_dword a195, v144, s[20:23], s42 offen offset:768 sc1
    buffer_load_dword a196, v144, s[20:23], s42 offen offset:1024 sc1
    buffer_load_dword a197, v144, s[20:23], s42 offen offset:1280 sc1
    buffer_load_dword a198, v144, s[20:23], s42 offen offset:1536 sc1
    buffer_load_dword a199, v144, s[20:23], s42 offen offset:1792 sc1
    buffer_load_dwordx4 a[0:3], v1, s[20:23], s40 offen offset:0 sc1
    buffer_load_dwordx4 a[4:7], v1, s[20:23], s40 offen offset:1024 sc1
    s_add_u32 m0, s3, 0
    s_nop 0
    buffer_load_dwordx4 v1, s[20:23], s41 offen offset:0 sc1 lds
    buffer_load_dwordx4 v1, s[20:23], s41 offen offset:1024 sc1 lds
    buffer_load_dwordx4 v1, s[20:23], s41 offen offset:2048 sc1 lds
    buffer_load_dwordx4 a[8:11], v1, s[20:23], s40 offen offset:2048 sc1
    buffer_load_dwordx4 a[12:15], v1, s[20:23], s40 offen offset:3072 sc1
    buffer_load_dwordx4 v1, s[20:23], s41 offen offset:3072 sc1 lds
    s_add_u32 m0, s3, 4096
    s_add_u32 s41, s41, 4096
    buffer_load_dwordx4 v1, s[20:23], s41 offen offset:0 sc1 lds
    s_add_u32 s40, s40, 4096
    buffer_load_dwordx4 a[16:19], v1, s[20:23], s40 offen offset:0 sc1
    buffer_load_dwordx4 a[20:23], v1, s[20:23], s40 offen offset:1024 sc1
    buffer_load_dwordx4 v1, s[20:23], s41 offen offset:1024 sc1 lds
    buffer_load_dwordx4 v1, s[20:23], s41 offen offset:2048 sc1 lds
    buffer_load_dwordx4 a[24:27], v1, s[20:23], s40 offen offset:2048 sc1
    buffer_load_dwordx4 a[28:31], v1, s[20:23], s40 offen offset:3072 sc1
    buffer_load_dwordx4 v1, s[20:23], s41 offen offset:3072 sc1 lds
    s_add_u32 m0, s3, 8192
    s_add_u32 s41, s41, 4096
    buffer_load_dwordx4 v1, s[20:23], s41 offen offset:0 sc1 lds
    s_add_u32 s40, s40, 4096
    buffer_load_dwordx4 a[32:35], v1, s[20:23], s40 offen offset:0 sc1
    buffer_load_dwordx4 a[36:39], v1, s[20:23], s40 offen offset:1024 sc1
    buffer_load_dwordx4 v1, s[20:23], s41 offen offset:1024 sc1 lds
    buffer_load_dwordx4 v1, s[20:23], s41 offen offset:2048 sc1 lds
    buffer_load_dwordx4 v1, s[20:23], s41 offen offset:3072 sc1 lds
    buffer_load_dwordx4 a[40:43], v1, s[20:23], s40 offen offset:2048 sc1
    buffer_load_dwordx4 a[44:47], v1, s[20:23], s40 offen offset:3072 sc1
    s_add_u32 m0, s3, 12288
    s_add_u32 s41, s41, 4096
    buffer_load_dwordx4 v1, s[20:23], s41 offen offset:0 sc1 lds
    buffer_load_dwordx4 v1, s[20:23], s41 offen offset:1024 sc1 lds
    s_add_u32 s40, s40, 4096
    buffer_load_dwordx4 a[48:51], v1, s[20:23], s40 offen offset:0 sc1
    buffer_load_dwordx4 a[52:55], v1, s[20:23], s40 offen offset:1024 sc1
    buffer_load_dwordx4 v1, s[20:23], s41 offen offset:2048 sc1 lds
    buffer_load_dwordx4 v1, s[20:23], s41 offen offset:3072 sc1 lds
    buffer_load_dwordx4 a[56:59], v1, s[20:23], s40 offen offset:2048 sc1
    buffer_load_dwordx4 a[60:63], v1, s[20:23], s40 offen offset:3072 sc1
    s_add_u32 m0, s3, 16384
    s_add_u32 s41, s41, 4096
    buffer_load_dwordx4 v1, s[20:23], s41 offen offset:0 sc1 lds
    buffer_load_dwordx4 v1, s[20:23], s41 offen offset:1024 sc1 lds
    s_waitcnt vmcnt(0)
    ds_read_b128 a[64:67], v2 offset:0
    ds_read_b128 a[68:71], v2 offset:576
    ds_read_b128 a[72:75], v2 offset:1152
    ds_read_b128 a[76:79], v2 offset:1728
    v_add_u32 v2, v2, v145
    s_waitcnt lgkmcnt(0)
    ds_read_b128 a[80:83], v2 offset:0
    ds_read_b128 a[84:87], v2 offset:576
    ds_read_b128 a[88:91], v2 offset:1152
    ds_read_b128 a[92:95], v2 offset:1728
    v_add_u32 v2, v2, v145
    s_waitcnt lgkmcnt(0)
    ds_read_b128 a[96:99], v2 offset:0
    ds_read_b128 a[100:103], v2 offset:576
    ds_read_b128 a[104:107], v2 offset:1152
    ds_read_b128 a[108:111], v2 offset:1728
    v_add_u32 v2, v2, v145
    s_waitcnt lgkmcnt(0)
    ds_read_b128 a[112:115], v2 offset:0
    ds_read_b128 a[116:119], v2 offset:576
    ds_read_b128 a[120:123], v2 offset:1152
    ds_read_b128 a[124:127], v2 offset:1728
    v_add_u32 v2, v2, v145
    s_waitcnt lgkmcnt(0)
    ds_read_b128 a[128:131], v2 offset:0
    ds_read_b128 a[132:135], v2 offset:576
    ds_read_b128 a[136:139], v2 offset:1152
    ds_read_b128 a[140:143], v2 offset:1728
    v_add_u32 v2, v2, v145
    s_waitcnt lgkmcnt(0)
    ds_read_b128 a[144:147], v2 offset:0
    ds_read_b128 a[148:151], v2 offset:576
    ds_read_b128 a[152:155], v2 offset:1152
    ds_read_b128 a[156:159], v2 offset:1728
    v_add_u32 v2, v2, v145
    s_waitcnt lgkmcnt(0)
    ds_read_b128 a[160:163], v2 offset:0
    ds_read_b128 a[164:167], v2 offset:576
    ds_read_b128 a[168:171], v2 offset:1152
    ds_read_b128 a[172:175], v2 offset:1728
    v_add_u32 v2, v2, v145
    s_waitcnt lgkmcnt(0)
    ds_read_b128 a[176:179], v2 offset:0
    ds_read_b128 a[180:183], v2 offset:576
    ds_read_b128 a[184:187], v2 offset:1152
    ds_read_b128 a[188:191], v2 offset:1728
    v_add_u32 v2, v2, v145
    s_waitcnt lgkmcnt(0)
    s_barrier
    v_bfe_u32 v36, v0, 3, 2
    v_mul_u32_u24 v4, 288, v36
    v_and_b32 v36, 1, v36
    v_mul_u32_u24 v36, 28, v36
    v_and_b32 v37, 7, v0
    v_lshl_add_u32 v4, v37, 3, v4
    v_lshrrev_b32 v37, 5, v0
    v_lshl_add_u32 v146, v37, 7, v4
    v_sub_u32 v4, v4, v36
    v_add_u32 v4, 73984, v4
    v_sub_u32 v3, v146, v36
    v_add_u32 v3, 73728, v3
    v_add_u32 v146, v146, v36
    v_add_u32 v146, 73732, v146
    v_add_u32 v12, 104448, v1
    v_and_b32 v36, 7, v0
    v_lshlrev_b32 v36, 4, v36
    v_lshrrev_b32 v37, 3, v0
    v_lshrrev_b32 v38, 4, v0
    v_lshl_add_u32 v38, v38, 8, v36
    v_and_b32 v39, 1, v37
    v_lshl_add_u32 v38, v39, 3, v38
    s_lshl_b32 s43, s26, 9
    s_add_u32 s43, s43, 104448
    v_add_u32 v38, s43, v38
    s_lshl_b32 s43, s26, 2
    s_add_u32 s43, s43, 106496
    v_add_u32 v39, s43, v36
    v_lshlrev_b32 v40, 2, v0
    v_cmp_eq_u32 vcc, 4, v37
    v_add_u32 v40, 106752, v40
    v_lshrrev_b32 v41, 4, v0
    v_cndmask_b32 v8, v40, v39, vcc
    v_mul_u32_u24 v41, 2304, v41
    v_add_u32 v10, v41, v12
    v_cmp_gt_u32 vcc, 4, v37
    v_add_u32 v39, 4, v38
    s_mul_i32 s27, s26, 165888
    v_cndmask_b32 v8, v8, v38, vcc
    v_cndmask_b32 v9, v40, v39, vcc
    s_add_u32 s27, s27, 2621440
    v_and_b32 v53, 31, v0
    v_lshlrev_b32 v53, 4, v53
    s_lshl_b32 s40, s26, 2
    s_add_u32 s40, s40, 125504
    v_add_u32 v53, s40, v53
    s_mov_b32 s28, 8
    s_waitcnt vmcnt(0)
KM_sl1:
    ds_read_b32 a244, v4 offset:0
    ds_read_b32 a247, v4 offset:0
    ds_read2_b32 a[240:241], v3 offset1:16
    ds_read2_b32 a[242:243], v146 offset1:16
    v_add_u32 v3, 1152, v3
    v_add_u32 v146, 1152, v146
    v_add_u32 v4, 1152, v4
    v_mov_b32 v52, 0xff800000
    s_waitcnt lgkmcnt(0)
    v_mfma_f32_32x32x4_2b_bf16 v[56:87], a[192:193], a[244:245], 0
    s_nop 15
    s_nop 1
    v_mfma_f32_32x32x16_bf16 v[56:71], a[0:3], a[240:243], v[56:71]
    v_mfma_f32_32x32x16_bf16 v[72:87], a[4:7], a[240:243], v[72:87]
    s_nop 11
    v_max3_f32 v52, v52, v56, v57
    v_max3_f32 v52, v52, v58, v59
    v_max3_f32 v52, v52, v60, v61
    v_max3_f32 v52, v52, v62, v63
    v_max3_f32 v52, v52, v64, v65
    v_max3_f32 v52, v52, v66, v67
    v_max3_f32 v52, v52, v68, v69
    v_max3_f32 v52, v52, v70, v71
    v_max3_f32 v52, v52, v72, v73
    v_max3_f32 v52, v52, v74, v75
    v_max3_f32 v52, v52, v76, v77
    v_max3_f32 v52, v52, v78, v79
    v_max3_f32 v52, v52, v80, v81
    v_max3_f32 v52, v52, v82, v83
    v_max3_f32 v52, v52, v84, v85
    v_max3_f32 v52, v52, v86, v87
    v_mfma_f32_32x32x4_2b_bf16 v[56:87], a[192:193], a[246:247], 0
    s_nop 15
    s_nop 1
    v_mfma_f32_32x32x16_bf16 v[56:71], a[8:11], a[240:243], v[56:71]
    v_mfma_f32_32x32x16_bf16 v[72:87], a[12:15], a[240:243], v[72:87]
    s_nop 11
    v_max3_f32 v52, v52, v56, v57
    v_max3_f32 v52, v52, v58, v59
    v_max3_f32 v52, v52, v60, v61
    v_max3_f32 v52, v52, v62, v63
    v_max3_f32 v52, v52, v64, v65
    v_max3_f32 v52, v52, v66, v67
    v_max3_f32 v52, v52, v68, v69
    v_max3_f32 v52, v52, v70, v71
    v_max3_f32 v52, v52, v72, v73
    v_max3_f32 v52, v52, v74, v75
    v_max3_f32 v52, v52, v76, v77
    v_max3_f32 v52, v52, v78, v79
    v_max3_f32 v52, v52, v80, v81
    v_max3_f32 v52, v52, v82, v83
    v_max3_f32 v52, v52, v84, v85
    v_max3_f32 v52, v52, v86, v87
    v_mfma_f32_32x32x4_2b_bf16 v[56:87], a[194:195], a[244:245], 0
    s_nop 15
    s_nop 1
    v_mfma_f32_32x32x16_bf16 v[56:71], a[16:19], a[240:243], v[56:71]
    v_mfma_f32_32x32x16_bf16 v[72:87], a[20:23], a[240:243], v[72:87]
    s_nop 11
    v_max3_f32 v52, v52, v56, v57
    v_max3_f32 v52, v52, v58, v59
    v_max3_f32 v52, v52, v60, v61
    v_max3_f32 v52, v52, v62, v63
    v_max3_f32 v52, v52, v64, v65
    v_max3_f32 v52, v52, v66, v67
    v_max3_f32 v52, v52, v68, v69
    v_max3_f32 v52, v52, v70, v71
    v_max3_f32 v52, v52, v72, v73
    v_max3_f32 v52, v52, v74, v75
    v_max3_f32 v52, v52, v76, v77
    v_max3_f32 v52, v52, v78, v79
    v_max3_f32 v52, v52, v80, v81
    v_max3_f32 v52, v52, v82, v83
    v_max3_f32 v52, v52, v84, v85
    v_max3_f32 v52, v52, v86, v87
    v_mfma_f32_32x32x4_2b_bf16 v[56:87], a[194:195], a[246:247], 0
    s_nop 15
    s_nop 1
    v_mfma_f32_32x32x16_bf16 v[56:71], a[24:27], a[240:243], v[56:71]
    v_mfma_f32_32x32x16_bf16 v[72:87], a[28:31], a[240:243], v[72:87]
    s_nop 11
    v_max3_f32 v52, v52, v56, v57
    v_max3_f32 v52, v52, v58, v59
    v_max3_f32 v52, v52, v60, v61
    v_max3_f32 v52, v52, v62, v63
    v_max3_f32 v52, v52, v64, v65
    v_max3_f32 v52, v52, v66, v67
    v_max3_f32 v52, v52, v68, v69
    v_max3_f32 v52, v52, v70, v71
    v_max3_f32 v52, v52, v72, v73
    v_max3_f32 v52, v52, v74, v75
    v_max3_f32 v52, v52, v76, v77
    v_max3_f32 v52, v52, v78, v79
    v_max3_f32 v52, v52, v80, v81
    v_max3_f32 v52, v52, v82, v83
    v_max3_f32 v52, v52, v84, v85
    v_max3_f32 v52, v52, v86, v87
    v_mfma_f32_32x32x4_2b_bf16 v[56:87], a[196:197], a[244:245], 0
    s_nop 15
    s_nop 1
    v_mfma_f32_32x32x16_bf16 v[56:71], a[32:35], a[240:243], v[56:71]
    v_mfma_f32_32x32x16_bf16 v[72:87], a[36:39], a[240:243], v[72:87]
    s_nop 11
    v_max3_f32 v52, v52, v56, v57
    v_max3_f32 v52, v52, v58, v59
    v_max3_f32 v52, v52, v60, v61
    v_max3_f32 v52, v52, v62, v63
    v_max3_f32 v52, v52, v64, v65
    v_max3_f32 v52, v52, v66, v67
    v_max3_f32 v52, v52, v68, v69
    v_max3_f32 v52, v52, v70, v71
    v_max3_f32 v52, v52, v72, v73
    v_max3_f32 v52, v52, v74, v75
    v_max3_f32 v52, v52, v76, v77
    v_max3_f32 v52, v52, v78, v79
    v_max3_f32 v52, v52, v80, v81
    v_max3_f32 v52, v52, v82, v83
    v_max3_f32 v52, v52, v84, v85
    v_max3_f32 v52, v52, v86, v87
    v_mfma_f32_32x32x4_2b_bf16 v[56:87], a[196:197], a[246:247], 0
    s_nop 15
    s_nop 1
    v_mfma_f32_32x32x16_bf16 v[56:71], a[40:43], a[240:243], v[56:71]
    v_mfma_f32_32x32x16_bf16 v[72:87], a[44:47], a[240:243], v[72:87]
    s_nop 11
    v_max3_f32 v52, v52, v56, v57
    v_max3_f32 v52, v52, v58, v59
    v_max3_f32 v52, v52, v60, v61
    v_max3_f32 v52, v52, v62, v63
    v_max3_f32 v52, v52, v64, v65
    v_max3_f32 v52, v52, v66, v67
    v_max3_f32 v52, v52, v68, v69
    v_max3_f32 v52, v52, v70, v71
    v_max3_f32 v52, v52, v72, v73
    v_max3_f32 v52, v52, v74, v75
    v_max3_f32 v52, v52, v76, v77
    v_max3_f32 v52, v52, v78, v79
    v_max3_f32 v52, v52, v80, v81
    v_max3_f32 v52, v52, v82, v83
    v_max3_f32 v52, v52, v84, v85
    v_max3_f32 v52, v52, v86, v87
    v_mfma_f32_32x32x4_2b_bf16 v[56:87], a[198:199], a[244:245], 0
    s_nop 15
    s_nop 1
    v_mfma_f32_32x32x16_bf16 v[56:71], a[48:51], a[240:243], v[56:71]
    v_mfma_f32_32x32x16_bf16 v[72:87], a[52:55], a[240:243], v[72:87]
    s_nop 11
    v_max3_f32 v52, v52, v56, v57
    v_max3_f32 v52, v52, v58, v59
    v_max3_f32 v52, v52, v60, v61
    v_max3_f32 v52, v52, v62, v63
    v_max3_f32 v52, v52, v64, v65
    v_max3_f32 v52, v52, v66, v67
    v_max3_f32 v52, v52, v68, v69
    v_max3_f32 v52, v52, v70, v71
    v_max3_f32 v52, v52, v72, v73
    v_max3_f32 v52, v52, v74, v75
    v_max3_f32 v52, v52, v76, v77
    v_max3_f32 v52, v52, v78, v79
    v_max3_f32 v52, v52, v80, v81
    v_max3_f32 v52, v52, v82, v83
    v_max3_f32 v52, v52, v84, v85
    v_max3_f32 v52, v52, v86, v87
    v_mfma_f32_32x32x4_2b_bf16 v[56:87], a[198:199], a[246:247], 0
    s_nop 15
    s_nop 1
    v_mfma_f32_32x32x16_bf16 v[56:71], a[56:59], a[240:243], v[56:71]
    v_mfma_f32_32x32x16_bf16 v[72:87], a[60:63], a[240:243], v[72:87]
    s_nop 11
    v_max3_f32 v52, v52, v56, v57
    v_max3_f32 v52, v52, v58, v59
    v_max3_f32 v52, v52, v60, v61
    v_max3_f32 v52, v52, v62, v63
    v_max3_f32 v52, v52, v64, v65
    v_max3_f32 v52, v52, v66, v67
    v_max3_f32 v52, v52, v68, v69
    v_max3_f32 v52, v52, v70, v71
    v_max3_f32 v52, v52, v72, v73
    v_max3_f32 v52, v52, v74, v75
    v_max3_f32 v52, v52, v76, v77
    v_max3_f32 v52, v52, v78, v79
    v_max3_f32 v52, v52, v80, v81
    v_max3_f32 v52, v52, v82, v83
    v_max3_f32 v52, v52, v84, v85
    v_max3_f32 v52, v52, v86, v87
    v_mov_b32 v36, v52
    s_nop 1
    v_permlane32_swap_b32 v52, v36
    v_max_f32 v52, v52, v36
    ds_write_b32 v53, v52
    v_add_u32 v53, 512, v53
    s_sub_u32 s28, s28, 1
    s_cmp_lg_u32 s28, 0
    s_cbranch_scc1 KM_sl1
    s_waitcnt lgkmcnt(0)
    s_barrier
    v_bfe_u32 v36, v0, 3, 2
    v_mul_u32_u24 v4, 288, v36
    v_and_b32 v36, 1, v36
    v_mul_u32_u24 v36, 28, v36
    v_and_b32 v37, 7, v0
    v_lshl_add_u32 v4, v37, 3, v4
    v_lshrrev_b32 v37, 5, v0
    v_lshl_add_u32 v146, v37, 7, v4
    v_sub_u32 v4, v4, v36
    v_add_u32 v4, 73984, v4
    v_sub_u32 v3, v146, v36
    v_add_u32 v3, 73728, v3
    v_add_u32 v146, v146, v36
    v_add_u32 v146, 73732, v146
    v_add_u32 v12, 104448, v1
    v_and_b32 v36, 7, v0
    v_lshlrev_b32 v36, 4, v36
    v_lshrrev_b32 v37, 3, v0
    v_lshrrev_b32 v38, 4, v0
    v_lshl_add_u32 v38, v38, 8, v36
    v_and_b32 v39, 1, v37
    v_lshl_add_u32 v38, v39, 3, v38
    s_lshl_b32 s43, s26, 9
    s_add_u32 s43, s43, 104448
    v_add_u32 v38, s43, v38
    s_lshl_b32 s43, s26, 2
    s_add_u32 s43, s43, 106496
    v_add_u32 v39, s43, v36
    v_lshlrev_b32 v40, 2, v0
    v_cmp_eq_u32 vcc, 4, v37
    v_add_u32 v40, 106752, v40
    v_lshrrev_b32 v41, 4, v0
    v_cndmask_b32 v8, v40, v39, vcc
    v_mul_u32_u24 v41, 2304, v41
    v_add_u32 v10, v41, v12
    v_cmp_gt_u32 vcc, 4, v37
    v_add_u32 v39, 4, v38
    s_mul_i32 s27, s26, 165888
    v_cndmask_b32 v8, v8, v38, vcc
    v_cndmask_b32 v9, v40, v39, vcc
    s_add_u32 s27, s27, 2621440
    v_and_b32 v129, 31, v0
    v_lshlrev_b32 v129, 4, v129
    v_add_u32 v129, 125504, v129
    s_mov_b32 s28, 8
KM_sl2:
    ds_read_b32 a244, v4 offset:0
    ds_read_b32 a247, v4 offset:0
    ds_read2_b32 a[240:241], v3 offset1:16
    ds_read2_b32 a[242:243], v146 offset1:16
    v_add_u32 v3, 1152, v3
    v_add_u32 v146, 1152, v146
    v_add_u32 v4, 1152, v4
    ds_read_b128 v[36:39], v129
    v_add_u32 v129, 512, v129
    v_mfma_f32_32x32x8_bf16 a[216:231], a[248:249], a[248:249], 0
    s_waitcnt lgkmcnt(0)
    v_max3_f32 v128, v36, v37, v38
    v_max_f32 v128, v128, v39
    v_mfma_f32_32x32x4_2b_bf16 v[56:87], a[192:193], a[244:245], 0
    s_nop 15
    s_nop 1
    v_mfma_f32_32x32x16_bf16 v[56:71], a[0:3], a[240:243], v[56:71]
    v_mfma_f32_32x32x16_bf16 v[72:87], a[4:7], a[240:243], v[72:87]
    s_nop 11
    v_sub_f32 v56, v56, v128
    v_sub_f32 v57, v57, v128
    v_sub_f32 v58, v58, v128
    v_sub_f32 v59, v59, v128
    v_sub_f32 v60, v60, v128
    v_sub_f32 v61, v61, v128
    v_sub_f32 v62, v62, v128
    v_sub_f32 v63, v63, v128
    v_sub_f32 v64, v64, v128
    v_sub_f32 v65, v65, v128
    v_sub_f32 v66, v66, v128
    v_sub_f32 v67, v67, v128
    v_sub_f32 v68, v68, v128
    v_sub_f32 v69, v69, v128
    v_sub_f32 v70, v70, v128
    v_sub_f32 v71, v71, v128
    v_sub_f32 v72, v72, v128
    v_sub_f32 v73, v73, v128
    v_sub_f32 v74, v74, v128
    v_sub_f32 v75, v75, v128
    v_sub_f32 v76, v76, v128
    v_sub_f32 v77, v77, v128
    v_sub_f32 v78, v78, v128
    v_sub_f32 v79, v79, v128
    v_sub_f32 v80, v80, v128
    v_sub_f32 v81, v81, v128
    v_sub_f32 v82, v82, v128
    v_sub_f32 v83, v83, v128
    v_sub_f32 v84, v84, v128
    v_sub_f32 v85, v85, v128
    v_sub_f32 v86, v86, v128
    v_sub_f32 v87, v87, v128
    v_exp_f32 v56, v56
    v_exp_f32 v57, v57
    v_exp_f32 v58, v58
    v_exp_f32 v59, v59
    v_exp_f32 v60, v60
    v_exp_f32 v61, v61
    v_exp_f32 v62, v62
    v_exp_f32 v63, v63
    v_exp_f32 v64, v64
    v_exp_f32 v65, v65
    v_exp_f32 v66, v66
    v_exp_f32 v67, v67
    v_exp_f32 v68, v68
    v_exp_f32 v69, v69
    v_exp_f32 v70, v70
    v_exp_f32 v71, v71
    v_exp_f32 v72, v72
    v_exp_f32 v73, v73
    v_exp_f32 v74, v74
    v_exp_f32 v75, v75
    v_exp_f32 v76, v76
    v_exp_f32 v77, v77
    v_exp_f32 v78, v78
    v_exp_f32 v79, v79
    v_exp_f32 v80, v80
    v_exp_f32 v81, v81
    v_exp_f32 v82, v82
    v_exp_f32 v83, v83
    v_exp_f32 v84, v84
    v_exp_f32 v85, v85
    v_exp_f32 v86, v86
    v_exp_f32 v87, v87
    s_nop 1
    v_smfmac_f32_32x32x32_bf16 a[216:231], a[64:67], v[56:63], v13
    v_smfmac_f32_32x32x32_bf16 a[216:231], a[68:71], v[64:71], v13
    v_smfmac_f32_32x32x32_bf16 a[216:231], a[72:75], v[72:79], v13
    v_smfmac_f32_32x32x32_bf16 a[216:231], a[76:79], v[80:87], v13
    v_mfma_f32_32x32x4_2b_bf16 v[56:87], a[192:193], a[246:247], 0
    s_nop 15
    s_nop 1
    v_mfma_f32_32x32x16_bf16 v[56:71], a[8:11], a[240:243], v[56:71]
    v_mfma_f32_32x32x16_bf16 v[72:87], a[12:15], a[240:243], v[72:87]
    s_nop 11
    v_sub_f32 v56, v56, v128
    v_sub_f32 v57, v57, v128
    v_sub_f32 v58, v58, v128
    v_sub_f32 v59, v59, v128
    v_sub_f32 v60, v60, v128
    v_sub_f32 v61, v61, v128
    v_sub_f32 v62, v62, v128
    v_sub_f32 v63, v63, v128
    v_sub_f32 v64, v64, v128
    v_sub_f32 v65, v65, v128
    v_sub_f32 v66, v66, v128
    v_sub_f32 v67, v67, v128
    v_sub_f32 v68, v68, v128
    v_sub_f32 v69, v69, v128
    v_sub_f32 v70, v70, v128
    v_sub_f32 v71, v71, v128
    v_sub_f32 v72, v72, v128
    v_sub_f32 v73, v73, v128
    v_sub_f32 v74, v74, v128
    v_sub_f32 v75, v75, v128
    v_sub_f32 v76, v76, v128
    v_sub_f32 v77, v77, v128
    v_sub_f32 v78, v78, v128
    v_sub_f32 v79, v79, v128
    v_sub_f32 v80, v80, v128
    v_sub_f32 v81, v81, v128
    v_sub_f32 v82, v82, v128
    v_sub_f32 v83, v83, v128
    v_sub_f32 v84, v84, v128
    v_sub_f32 v85, v85, v128
    v_sub_f32 v86, v86, v128
    v_sub_f32 v87, v87, v128
    v_exp_f32 v56, v56
    v_exp_f32 v57, v57
    v_exp_f32 v58, v58
    v_exp_f32 v59, v59
    v_exp_f32 v60, v60
    v_exp_f32 v61, v61
    v_exp_f32 v62, v62
    v_exp_f32 v63, v63
    v_exp_f32 v64, v64
    v_exp_f32 v65, v65
    v_exp_f32 v66, v66
    v_exp_f32 v67, v67
    v_exp_f32 v68, v68
    v_exp_f32 v69, v69
    v_exp_f32 v70, v70
    v_exp_f32 v71, v71
    v_exp_f32 v72, v72
    v_exp_f32 v73, v73
    v_exp_f32 v74, v74
    v_exp_f32 v75, v75
    v_exp_f32 v76, v76
    v_exp_f32 v77, v77
    v_exp_f32 v78, v78
    v_exp_f32 v79, v79
    v_exp_f32 v80, v80
    v_exp_f32 v81, v81
    v_exp_f32 v82, v82
    v_exp_f32 v83, v83
    v_exp_f32 v84, v84
    v_exp_f32 v85, v85
    v_exp_f32 v86, v86
    v_exp_f32 v87, v87
    s_nop 1
    v_smfmac_f32_32x32x32_bf16 a[216:231], a[80:83], v[56:63], v13
    v_smfmac_f32_32x32x32_bf16 a[216:231], a[84:87], v[64:71], v13
    v_smfmac_f32_32x32x32_bf16 a[216:231], a[88:91], v[72:79], v13
    v_smfmac_f32_32x32x32_bf16 a[216:231], a[92:95], v[80:87], v13
    v_mfma_f32_32x32x4_2b_bf16 v[56:87], a[194:195], a[244:245], 0
    s_nop 15
    s_nop 1
    v_mfma_f32_32x32x16_bf16 v[56:71], a[16:19], a[240:243], v[56:71]
    v_mfma_f32_32x32x16_bf16 v[72:87], a[20:23], a[240:243], v[72:87]
    s_nop 11
    v_sub_f32 v56, v56, v128
    v_sub_f32 v57, v57, v128
    v_sub_f32 v58, v58, v128
    v_sub_f32 v59, v59, v128
    v_sub_f32 v60, v60, v128
    v_sub_f32 v61, v61, v128
    v_sub_f32 v62, v62, v128
    v_sub_f32 v63, v63, v128
    v_sub_f32 v64, v64, v128
    v_sub_f32 v65, v65, v128
    v_sub_f32 v66, v66, v128
    v_sub_f32 v67, v67, v128
    v_sub_f32 v68, v68, v128
    v_sub_f32 v69, v69, v128
    v_sub_f32 v70, v70, v128
    v_sub_f32 v71, v71, v128
    v_sub_f32 v72, v72, v128
    v_sub_f32 v73, v73, v128
    v_sub_f32 v74, v74, v128
    v_sub_f32 v75, v75, v128
    v_sub_f32 v76, v76, v128
    v_sub_f32 v77, v77, v128
    v_sub_f32 v78, v78, v128
    v_sub_f32 v79, v79, v128
    v_sub_f32 v80, v80, v128
    v_sub_f32 v81, v81, v128
    v_sub_f32 v82, v82, v128
    v_sub_f32 v83, v83, v128
    v_sub_f32 v84, v84, v128
    v_sub_f32 v85, v85, v128
    v_sub_f32 v86, v86, v128
    v_sub_f32 v87, v87, v128
    v_exp_f32 v56, v56
    v_exp_f32 v57, v57
    v_exp_f32 v58, v58
    v_exp_f32 v59, v59
    v_exp_f32 v60, v60
    v_exp_f32 v61, v61
    v_exp_f32 v62, v62
    v_exp_f32 v63, v63
    v_exp_f32 v64, v64
    v_exp_f32 v65, v65
    v_exp_f32 v66, v66
    v_exp_f32 v67, v67
    v_exp_f32 v68, v68
    v_exp_f32 v69, v69
    v_exp_f32 v70, v70
    v_exp_f32 v71, v71
    v_exp_f32 v72, v72
    v_exp_f32 v73, v73
    v_exp_f32 v74, v74
    v_exp_f32 v75, v75
    v_exp_f32 v76, v76
    v_exp_f32 v77, v77
    v_exp_f32 v78, v78
    v_exp_f32 v79, v79
    v_exp_f32 v80, v80
    v_exp_f32 v81, v81
    v_exp_f32 v82, v82
    v_exp_f32 v83, v83
    v_exp_f32 v84, v84
    v_exp_f32 v85, v85
    v_exp_f32 v86, v86
    v_exp_f32 v87, v87
    s_nop 1
    v_smfmac_f32_32x32x32_bf16 a[216:231], a[96:99], v[56:63], v13
    v_smfmac_f32_32x32x32_bf16 a[216:231], a[100:103], v[64:71], v13
    v_smfmac_f32_32x32x32_bf16 a[216:231], a[104:107], v[72:79], v13
    v_smfmac_f32_32x32x32_bf16 a[216:231], a[108:111], v[80:87], v13
    v_mfma_f32_32x32x4_2b_bf16 v[56:87], a[194:195], a[246:247], 0
    s_nop 15
    s_nop 1
    v_mfma_f32_32x32x16_bf16 v[56:71], a[24:27], a[240:243], v[56:71]
    v_mfma_f32_32x32x16_bf16 v[72:87], a[28:31], a[240:243], v[72:87]
    s_nop 11
    v_sub_f32 v56, v56, v128
    v_sub_f32 v57, v57, v128
    v_sub_f32 v58, v58, v128
    v_sub_f32 v59, v59, v128
    v_sub_f32 v60, v60, v128
    v_sub_f32 v61, v61, v128
    v_sub_f32 v62, v62, v128
    v_sub_f32 v63, v63, v128
    v_sub_f32 v64, v64, v128
    v_sub_f32 v65, v65, v128
    v_sub_f32 v66, v66, v128
    v_sub_f32 v67, v67, v128
    v_sub_f32 v68, v68, v128
    v_sub_f32 v69, v69, v128
    v_sub_f32 v70, v70, v128
    v_sub_f32 v71, v71, v128
    v_sub_f32 v72, v72, v128
    v_sub_f32 v73, v73, v128
    v_sub_f32 v74, v74, v128
    v_sub_f32 v75, v75, v128
    v_sub_f32 v76, v76, v128
    v_sub_f32 v77, v77, v128
    v_sub_f32 v78, v78, v128
    v_sub_f32 v79, v79, v128
    v_sub_f32 v80, v80, v128
    v_sub_f32 v81, v81, v128
    v_sub_f32 v82, v82, v128
    v_sub_f32 v83, v83, v128
    v_sub_f32 v84, v84, v128
    v_sub_f32 v85, v85, v128
    v_sub_f32 v86, v86, v128
    v_sub_f32 v87, v87, v128
    v_exp_f32 v56, v56
    v_exp_f32 v57, v57
    v_exp_f32 v58, v58
    v_exp_f32 v59, v59
    v_exp_f32 v60, v60
    v_exp_f32 v61, v61
    v_exp_f32 v62, v62
    v_exp_f32 v63, v63
    v_exp_f32 v64, v64
    v_exp_f32 v65, v65
    v_exp_f32 v66, v66
    v_exp_f32 v67, v67
    v_exp_f32 v68, v68
    v_exp_f32 v69, v69
    v_exp_f32 v70, v70
    v_exp_f32 v71, v71
    v_exp_f32 v72, v72
    v_exp_f32 v73, v73
    v_exp_f32 v74, v74
    v_exp_f32 v75, v75
    v_exp_f32 v76, v76
    v_exp_f32 v77, v77
    v_exp_f32 v78, v78
    v_exp_f32 v79, v79
    v_exp_f32 v80, v80
    v_exp_f32 v81, v81
    v_exp_f32 v82, v82
    v_exp_f32 v83, v83
    v_exp_f32 v84, v84
    v_exp_f32 v85, v85
    v_exp_f32 v86, v86
    v_exp_f32 v87, v87
    s_nop 1
    v_smfmac_f32_32x32x32_bf16 a[216:231], a[112:115], v[56:63], v13
    v_smfmac_f32_32x32x32_bf16 a[216:231], a[116:119], v[64:71], v13
    v_smfmac_f32_32x32x32_bf16 a[216:231], a[120:123], v[72:79], v13
    v_smfmac_f32_32x32x32_bf16 a[216:231], a[124:127], v[80:87], v13
    v_mfma_f32_32x32x4_2b_bf16 v[56:87], a[196:197], a[244:245], 0
    s_nop 15
    s_nop 1
    v_mfma_f32_32x32x16_bf16 v[56:71], a[32:35], a[240:243], v[56:71]
    v_mfma_f32_32x32x16_bf16 v[72:87], a[36:39], a[240:243], v[72:87]
    s_nop 11
    v_sub_f32 v56, v56, v128
    v_sub_f32 v57, v57, v128
    v_sub_f32 v58, v58, v128
    v_sub_f32 v59, v59, v128
    v_sub_f32 v60, v60, v128
    v_sub_f32 v61, v61, v128
    v_sub_f32 v62, v62, v128
    v_sub_f32 v63, v63, v128
    v_sub_f32 v64, v64, v128
    v_sub_f32 v65, v65, v128
    v_sub_f32 v66, v66, v128
    v_sub_f32 v67, v67, v128
    v_sub_f32 v68, v68, v128
    v_sub_f32 v69, v69, v128
    v_sub_f32 v70, v70, v128
    v_sub_f32 v71, v71, v128
    v_sub_f32 v72, v72, v128
    v_sub_f32 v73, v73, v128
    v_sub_f32 v74, v74, v128
    v_sub_f32 v75, v75, v128
    v_sub_f32 v76, v76, v128
    v_sub_f32 v77, v77, v128
    v_sub_f32 v78, v78, v128
    v_sub_f32 v79, v79, v128
    v_sub_f32 v80, v80, v128
    v_sub_f32 v81, v81, v128
    v_sub_f32 v82, v82, v128
    v_sub_f32 v83, v83, v128
    v_sub_f32 v84, v84, v128
    v_sub_f32 v85, v85, v128
    v_sub_f32 v86, v86, v128
    v_sub_f32 v87, v87, v128
    v_exp_f32 v56, v56
    v_exp_f32 v57, v57
    v_exp_f32 v58, v58
    v_exp_f32 v59, v59
    v_exp_f32 v60, v60
    v_exp_f32 v61, v61
    v_exp_f32 v62, v62
    v_exp_f32 v63, v63
    v_exp_f32 v64, v64
    v_exp_f32 v65, v65
    v_exp_f32 v66, v66
    v_exp_f32 v67, v67
    v_exp_f32 v68, v68
    v_exp_f32 v69, v69
    v_exp_f32 v70, v70
    v_exp_f32 v71, v71
    v_exp_f32 v72, v72
    v_exp_f32 v73, v73
    v_exp_f32 v74, v74
    v_exp_f32 v75, v75
    v_exp_f32 v76, v76
    v_exp_f32 v77, v77
    v_exp_f32 v78, v78
    v_exp_f32 v79, v79
    v_exp_f32 v80, v80
    v_exp_f32 v81, v81
    v_exp_f32 v82, v82
    v_exp_f32 v83, v83
    v_exp_f32 v84, v84
    v_exp_f32 v85, v85
    v_exp_f32 v86, v86
    v_exp_f32 v87, v87
    s_nop 1
    v_smfmac_f32_32x32x32_bf16 a[216:231], a[128:131], v[56:63], v13
    v_smfmac_f32_32x32x32_bf16 a[216:231], a[132:135], v[64:71], v13
    v_smfmac_f32_32x32x32_bf16 a[216:231], a[136:139], v[72:79], v13
    v_smfmac_f32_32x32x32_bf16 a[216:231], a[140:143], v[80:87], v13
    v_mfma_f32_32x32x4_2b_bf16 v[56:87], a[196:197], a[246:247], 0
    s_nop 15
    s_nop 1
    v_mfma_f32_32x32x16_bf16 v[56:71], a[40:43], a[240:243], v[56:71]
    v_mfma_f32_32x32x16_bf16 v[72:87], a[44:47], a[240:243], v[72:87]
    s_nop 11
    v_sub_f32 v56, v56, v128
    v_sub_f32 v57, v57, v128
    v_sub_f32 v58, v58, v128
    v_sub_f32 v59, v59, v128
    v_sub_f32 v60, v60, v128
    v_sub_f32 v61, v61, v128
    v_sub_f32 v62, v62, v128
    v_sub_f32 v63, v63, v128
    v_sub_f32 v64, v64, v128
    v_sub_f32 v65, v65, v128
    v_sub_f32 v66, v66, v128
    v_sub_f32 v67, v67, v128
    v_sub_f32 v68, v68, v128
    v_sub_f32 v69, v69, v128
    v_sub_f32 v70, v70, v128
    v_sub_f32 v71, v71, v128
    v_sub_f32 v72, v72, v128
    v_sub_f32 v73, v73, v128
    v_sub_f32 v74, v74, v128
    v_sub_f32 v75, v75, v128
    v_sub_f32 v76, v76, v128
    v_sub_f32 v77, v77, v128
    v_sub_f32 v78, v78, v128
    v_sub_f32 v79, v79, v128
    v_sub_f32 v80, v80, v128
    v_sub_f32 v81, v81, v128
    v_sub_f32 v82, v82, v128
    v_sub_f32 v83, v83, v128
    v_sub_f32 v84, v84, v128
    v_sub_f32 v85, v85, v128
    v_sub_f32 v86, v86, v128
    v_sub_f32 v87, v87, v128
    v_exp_f32 v56, v56
    v_exp_f32 v57, v57
    v_exp_f32 v58, v58
    v_exp_f32 v59, v59
    v_exp_f32 v60, v60
    v_exp_f32 v61, v61
    v_exp_f32 v62, v62
    v_exp_f32 v63, v63
    v_exp_f32 v64, v64
    v_exp_f32 v65, v65
    v_exp_f32 v66, v66
    v_exp_f32 v67, v67
    v_exp_f32 v68, v68
    v_exp_f32 v69, v69
    v_exp_f32 v70, v70
    v_exp_f32 v71, v71
    v_exp_f32 v72, v72
    v_exp_f32 v73, v73
    v_exp_f32 v74, v74
    v_exp_f32 v75, v75
    v_exp_f32 v76, v76
    v_exp_f32 v77, v77
    v_exp_f32 v78, v78
    v_exp_f32 v79, v79
    v_exp_f32 v80, v80
    v_exp_f32 v81, v81
    v_exp_f32 v82, v82
    v_exp_f32 v83, v83
    v_exp_f32 v84, v84
    v_exp_f32 v85, v85
    v_exp_f32 v86, v86
    v_exp_f32 v87, v87
    s_nop 1
    v_smfmac_f32_32x32x32_bf16 a[216:231], a[144:147], v[56:63], v13
    v_smfmac_f32_32x32x32_bf16 a[216:231], a[148:151], v[64:71], v13
    v_smfmac_f32_32x32x32_bf16 a[216:231], a[152:155], v[72:79], v13
    v_smfmac_f32_32x32x32_bf16 a[216:231], a[156:159], v[80:87], v13
    v_mfma_f32_32x32x4_2b_bf16 v[56:87], a[198:199], a[244:245], 0
    s_nop 15
    s_nop 1
    v_mfma_f32_32x32x16_bf16 v[56:71], a[48:51], a[240:243], v[56:71]
    v_mfma_f32_32x32x16_bf16 v[72:87], a[52:55], a[240:243], v[72:87]
    s_nop 11
    v_sub_f32 v56, v56, v128
    v_sub_f32 v57, v57, v128
    v_sub_f32 v58, v58, v128
    v_sub_f32 v59, v59, v128
    v_sub_f32 v60, v60, v128
    v_sub_f32 v61, v61, v128
    v_sub_f32 v62, v62, v128
    v_sub_f32 v63, v63, v128
    v_sub_f32 v64, v64, v128
    v_sub_f32 v65, v65, v128
    v_sub_f32 v66, v66, v128
    v_sub_f32 v67, v67, v128
    v_sub_f32 v68, v68, v128
    v_sub_f32 v69, v69, v128
    v_sub_f32 v70, v70, v128
    v_sub_f32 v71, v71, v128
    v_sub_f32 v72, v72, v128
    v_sub_f32 v73, v73, v128
    v_sub_f32 v74, v74, v128
    v_sub_f32 v75, v75, v128
    v_sub_f32 v76, v76, v128
    v_sub_f32 v77, v77, v128
    v_sub_f32 v78, v78, v128
    v_sub_f32 v79, v79, v128
    v_sub_f32 v80, v80, v128
    v_sub_f32 v81, v81, v128
    v_sub_f32 v82, v82, v128
    v_sub_f32 v83, v83, v128
    v_sub_f32 v84, v84, v128
    v_sub_f32 v85, v85, v128
    v_sub_f32 v86, v86, v128
    v_sub_f32 v87, v87, v128
    v_exp_f32 v56, v56
    v_exp_f32 v57, v57
    v_exp_f32 v58, v58
    v_exp_f32 v59, v59
    v_exp_f32 v60, v60
    v_exp_f32 v61, v61
    v_exp_f32 v62, v62
    v_exp_f32 v63, v63
    v_exp_f32 v64, v64
    v_exp_f32 v65, v65
    v_exp_f32 v66, v66
    v_exp_f32 v67, v67
    v_exp_f32 v68, v68
    v_exp_f32 v69, v69
    v_exp_f32 v70, v70
    v_exp_f32 v71, v71
    v_exp_f32 v72, v72
    v_exp_f32 v73, v73
    v_exp_f32 v74, v74
    v_exp_f32 v75, v75
    v_exp_f32 v76, v76
    v_exp_f32 v77, v77
    v_exp_f32 v78, v78
    v_exp_f32 v79, v79
    v_exp_f32 v80, v80
    v_exp_f32 v81, v81
    v_exp_f32 v82, v82
    v_exp_f32 v83, v83
    v_exp_f32 v84, v84
    v_exp_f32 v85, v85
    v_exp_f32 v86, v86
    v_exp_f32 v87, v87
    s_nop 1
    v_smfmac_f32_32x32x32_bf16 a[216:231], a[160:163], v[56:63], v13
    v_smfmac_f32_32x32x32_bf16 a[216:231], a[164:167], v[64:71], v13
    v_smfmac_f32_32x32x32_bf16 a[216:231], a[168:171], v[72:79], v13
    v_smfmac_f32_32x32x32_bf16 a[216:231], a[172:175], v[80:87], v13
    v_mfma_f32_32x32x4_2b_bf16 v[56:87], a[198:199], a[246:247], 0
    s_nop 15
    s_nop 1
    v_mfma_f32_32x32x16_bf16 v[56:71], a[56:59], a[240:243], v[56:71]
    v_mfma_f32_32x32x16_bf16 v[72:87], a[60:63], a[240:243], v[72:87]
    s_nop 11
    v_sub_f32 v56, v56, v128
    v_sub_f32 v57, v57, v128
    v_sub_f32 v58, v58, v128
    v_sub_f32 v59, v59, v128
    v_sub_f32 v60, v60, v128
    v_sub_f32 v61, v61, v128
    v_sub_f32 v62, v62, v128
    v_sub_f32 v63, v63, v128
    v_sub_f32 v64, v64, v128
    v_sub_f32 v65, v65, v128
    v_sub_f32 v66, v66, v128
    v_sub_f32 v67, v67, v128
    v_sub_f32 v68, v68, v128
    v_sub_f32 v69, v69, v128
    v_sub_f32 v70, v70, v128
    v_sub_f32 v71, v71, v128
    v_sub_f32 v72, v72, v128
    v_sub_f32 v73, v73, v128
    v_sub_f32 v74, v74, v128
    v_sub_f32 v75, v75, v128
    v_sub_f32 v76, v76, v128
    v_sub_f32 v77, v77, v128
    v_sub_f32 v78, v78, v128
    v_sub_f32 v79, v79, v128
    v_sub_f32 v80, v80, v128
    v_sub_f32 v81, v81, v128
    v_sub_f32 v82, v82, v128
    v_sub_f32 v83, v83, v128
    v_sub_f32 v84, v84, v128
    v_sub_f32 v85, v85, v128
    v_sub_f32 v86, v86, v128
    v_sub_f32 v87, v87, v128
    v_exp_f32 v56, v56
    v_exp_f32 v57, v57
    v_exp_f32 v58, v58
    v_exp_f32 v59, v59
    v_exp_f32 v60, v60
    v_exp_f32 v61, v61
    v_exp_f32 v62, v62
    v_exp_f32 v63, v63
    v_exp_f32 v64, v64
    v_exp_f32 v65, v65
    v_exp_f32 v66, v66
    v_exp_f32 v67, v67
    v_exp_f32 v68, v68
    v_exp_f32 v69, v69
    v_exp_f32 v70, v70
    v_exp_f32 v71, v71
    v_exp_f32 v72, v72
    v_exp_f32 v73, v73
    v_exp_f32 v74, v74
    v_exp_f32 v75, v75
    v_exp_f32 v76, v76
    v_exp_f32 v77, v77
    v_exp_f32 v78, v78
    v_exp_f32 v79, v79
    v_exp_f32 v80, v80
    v_exp_f32 v81, v81
    v_exp_f32 v82, v82
    v_exp_f32 v83, v83
    v_exp_f32 v84, v84
    v_exp_f32 v85, v85
    v_exp_f32 v86, v86
    v_exp_f32 v87, v87
    s_nop 1
    v_smfmac_f32_32x32x32_bf16 a[216:231], a[176:179], v[56:63], v13
    v_smfmac_f32_32x32x32_bf16 a[216:231], a[180:183], v[64:71], v13
    v_smfmac_f32_32x32x32_bf16 a[216:231], a[184:187], v[72:79], v13
    v_smfmac_f32_32x32x32_bf16 a[216:231], a[188:191], v[80:87], v13
    s_nop 11
    ds_write_b128 v5, a[216:219] offset:0
    ds_write_b128 v5, a[220:223] offset:1024
    ds_write_b128 v5, a[224:227] offset:2048
    s_waitcnt lgkmcnt(0)
    s_barrier
    ds_read_b128 v[36:39], v6 offset:0
    ds_read_b128 v[40:43], v6 offset:3072
    ds_read_b128 v[44:47], v6 offset:6144
    ds_read_b128 v[48:51], v6 offset:9216
    s_waitcnt lgkmcnt(0)
    v_add_f32 v38, v38, v42
    v_add_f32 v36, v36, v40
    v_add_f32 v37, v37, v41
    v_add_f32 v39, v39, v43
    v_add_f32 v46, v46, v50
    v_add_f32 v44, v44, v48
    v_add_f32 v45, v45, v49
    v_add_f32 v47, v47, v51
    v_add_f32 v38, v38, v46
    v_add_f32 v36, v36, v44
    v_add_f32 v37, v37, v45
    v_add_f32 v39, v39, v47
    ds_bpermute_b32 v52, v7, v38
    s_waitcnt lgkmcnt(0)
    v_rcp_f32 v54, v52
    s_nop 0
    v_mul_f32 v36, v36, v54
    v_mul_f32 v37, v37, v54
    v_mul_f32 v38, v38, v54
    v_mul_f32 v39, v39, v54
    v_max3_f32 v14, v14, v52, v54
    v_cvt_pk_bf16_f32 v36, v36, v37
    v_cvt_pk_bf16_f32 v37, v38, v39
    ds_write_b32 v8, v36 offset:0
    ds_write_b32 v9, v37 offset:0
    v_add_u32 v8, 2560, v8
    v_add_u32 v9, 2560, v9
    s_waitcnt lgkmcnt(0)
    s_barrier
    s_sub_u32 s28, s28, 1
    s_cmp_lg_u32 s28, 0
    s_cbranch_scc1 KM_sl2
    v_and_b32 v15, 7, v0
    v_mul_u32_u24 v15, 1152, v15
    v_lshrrev_b32 v43, 4, v0
    v_lshl_add_u32 v15, v43, 3, v15
    s_lshl_b32 s43, s26, 5
    s_add_u32 s43, s43, 82944
    v_add_u32 v15, s43, v15
    ds_read_b64 v[92:93], v15 offset:0
    ds_read_b64 v[94:95], v15 offset:128
    ds_read_b64 v[96:97], v15 offset:256
    ds_read_b64 v[98:99], v15 offset:384
    ds_read_b64 v[100:101], v15 offset:512
    ds_read_b64 v[102:103], v15 offset:640
    ds_read_b64 v[104:105], v15 offset:768
    ds_read_b64 v[106:107], v15 offset:896
    ds_read_b64 v[108:109], v15 offset:1024
    s_waitcnt lgkmcnt(0)
    v_lshlrev_b32 v148, 16, v92
    v_and_b32 v149, 0xffff0000, v92
    v_lshlrev_b32 v150, 16, v93
    v_and_b32 v151, 0xffff0000, v93
    v_lshlrev_b32 v152, 16, v94
    v_and_b32 v153, 0xffff0000, v94
    v_lshlrev_b32 v154, 16, v95
    v_and_b32 v155, 0xffff0000, v95
    v_lshlrev_b32 v156, 16, v96
    v_and_b32 v157, 0xffff0000, v96
    v_lshlrev_b32 v158, 16, v97
    v_and_b32 v159, 0xffff0000, v97
    v_lshlrev_b32 v160, 16, v98
    v_and_b32 v161, 0xffff0000, v98
    v_lshlrev_b32 v162, 16, v99
    v_and_b32 v163, 0xffff0000, v99
    v_lshlrev_b32 v164, 16, v100
    v_and_b32 v165, 0xffff0000, v100
    v_lshlrev_b32 v166, 16, v101
    v_and_b32 v167, 0xffff0000, v101
    v_lshlrev_b32 v168, 16, v102
    v_and_b32 v169, 0xffff0000, v102
    v_lshlrev_b32 v170, 16, v103
    v_and_b32 v171, 0xffff0000, v103
    v_lshlrev_b32 v172, 16, v104
    v_and_b32 v173, 0xffff0000, v104
    v_lshlrev_b32 v174, 16, v105
    v_and_b32 v175, 0xffff0000, v105
    v_lshlrev_b32 v176, 16, v106
    v_and_b32 v177, 0xffff0000, v106
    v_lshlrev_b32 v178, 16, v107
    v_and_b32 v179, 0xffff0000, v107
    v_lshlrev_b32 v180, 16, v108
    v_and_b32 v181, 0xffff0000, v108
    v_lshlrev_b32 v182, 16, v109
    v_and_b32 v183, 0xffff0000, v109
    s_mov_b32 s28, 8
KM_sl3:
    s_add_u32 s30, s27, 0
    buffer_load_dwordx4 v[56:59], v1, s[20:23], s30 offen offset:0 sc1
    buffer_load_dwordx4 v[60:63], v1, s[20:23], s30 offen offset:1024 sc1
    buffer_load_dwordx4 v[64:67], v1, s[20:23], s30 offen offset:2048 sc1
    buffer_load_dwordx4 v[68:71], v1, s[20:23], s30 offen offset:3072 sc1
    s_add_u32 s30, s27, 4096
    buffer_load_dwordx4 v[72:75], v1, s[20:23], s30 offen offset:0 sc1
    buffer_load_dwordx4 v[76:79], v1, s[20:23], s30 offen offset:1024 sc1
    buffer_load_dwordx4 v[80:83], v1, s[20:23], s30 offen offset:2048 sc1
    buffer_load_dwordx4 v[84:87], v1, s[20:23], s30 offen offset:3072 sc1
    s_add_u32 s30, s27, 8192
    buffer_load_dwordx4 v[88:91], v1, s[20:23], s30 offen offset:0 sc1
    buffer_load_dwordx4 v[92:95], v1, s[20:23], s30 offen offset:1024 sc1
    buffer_load_dwordx4 v[96:99], v1, s[20:23], s30 offen offset:2048 sc1
    buffer_load_dwordx4 v[100:103], v1, s[20:23], s30 offen offset:3072 sc1
    s_add_u32 s30, s27, 12288
    buffer_load_dwordx4 v[104:107], v1, s[20:23], s30 offen offset:0 sc1
    buffer_load_dwordx4 v[108:111], v1, s[20:23], s30 offen offset:1024 sc1
    buffer_load_dwordx4 v[112:115], v1, s[20:23], s30 offen offset:2048 sc1
    buffer_load_dwordx4 v[116:119], v1, s[20:23], s30 offen offset:3072 sc1
    s_add_u32 s30, s27, 16384
    buffer_load_dwordx4 v[120:123], v1, s[20:23], s30 offen offset:0 sc1
    buffer_load_dwordx4 v[124:127], v1, s[20:23], s30 offen offset:1024 sc1
    ds_read_b128 a[232:235], v12 offset:0
    ds_read_b128 a[236:239], v12 offset:1024
    v_add_u32 v12, 2560, v12
    s_add_u32 s27, s27, 18432
    s_waitcnt vmcnt(0) lgkmcnt(0)
    v_mfma_f32_16x16x32_bf16 v[148:151], v[56:59], a[232:235], v[148:151]
    v_mfma_f32_16x16x32_bf16 v[152:155], v[60:63], a[232:235], v[152:155]
    v_mfma_f32_16x16x32_bf16 v[156:159], v[64:67], a[232:235], v[156:159]
    v_mfma_f32_16x16x32_bf16 v[160:163], v[68:71], a[232:235], v[160:163]
    v_mfma_f32_16x16x32_bf16 v[164:167], v[72:75], a[232:235], v[164:167]
    v_mfma_f32_16x16x32_bf16 v[168:171], v[76:79], a[232:235], v[168:171]
    v_mfma_f32_16x16x32_bf16 v[172:175], v[80:83], a[232:235], v[172:175]
    v_mfma_f32_16x16x32_bf16 v[176:179], v[84:87], a[232:235], v[176:179]
    v_mfma_f32_16x16x32_bf16 v[180:183], v[88:91], a[232:235], v[180:183]
    v_mfma_f32_16x16x32_bf16 v[148:151], v[92:95], a[236:239], v[148:151]
    v_mfma_f32_16x16x32_bf16 v[152:155], v[96:99], a[236:239], v[152:155]
    v_mfma_f32_16x16x32_bf16 v[156:159], v[100:103], a[236:239], v[156:159]
    v_mfma_f32_16x16x32_bf16 v[160:163], v[104:107], a[236:239], v[160:163]
    v_mfma_f32_16x16x32_bf16 v[164:167], v[108:111], a[236:239], v[164:167]
    v_mfma_f32_16x16x32_bf16 v[168:171], v[112:115], a[236:239], v[168:171]
    v_mfma_f32_16x16x32_bf16 v[172:175], v[116:119], a[236:239], v[172:175]
    v_mfma_f32_16x16x32_bf16 v[176:179], v[120:123], a[236:239], v[176:179]
    v_mfma_f32_16x16x32_bf16 v[180:183], v[124:127], a[236:239], v[180:183]
    s_sub_u32 s28, s28, 1
    s_cmp_lg_u32 s28, 0
    s_cbranch_scc1 KM_sl3
    s_mov_b32 s28, 1
KM_sl4:
    s_add_u32 s30, s27, 0
    buffer_load_dwordx4 v[56:59], v1, s[20:23], s30 offen offset:0 sc1
    buffer_load_dwordx4 v[60:63], v1, s[20:23], s30 offen offset:1024 sc1
    buffer_load_dwordx4 v[64:67], v1, s[20:23], s30 offen offset:2048 sc1
    buffer_load_dwordx4 v[68:71], v1, s[20:23], s30 offen offset:3072 sc1
    s_add_u32 s30, s27, 4096
    buffer_load_dwordx4 v[72:75], v1, s[20:23], s30 offen offset:0 sc1
    buffer_load_dwordx4 v[76:79], v1, s[20:23], s30 offen offset:1024 sc1
    buffer_load_dwordx4 v[80:83], v1, s[20:23], s30 offen offset:2048 sc1
    buffer_load_dwordx4 v[84:87], v1, s[20:23], s30 offen offset:3072 sc1
    s_add_u32 s30, s27, 8192
    buffer_load_dwordx4 v[88:91], v1, s[20:23], s30 offen offset:0 sc1
    buffer_load_dwordx4 v[92:95], v1, s[20:23], s30 offen offset:1024 sc1
    buffer_load_dwordx4 v[96:99], v1, s[20:23], s30 offen offset:2048 sc1
    buffer_load_dwordx4 v[100:103], v1, s[20:23], s30 offen offset:3072 sc1
    s_add_u32 s30, s27, 12288
    buffer_load_dwordx4 v[104:107], v1, s[20:23], s30 offen offset:0 sc1
    buffer_load_dwordx4 v[108:111], v1, s[20:23], s30 offen offset:1024 sc1
    buffer_load_dwordx4 v[112:115], v1, s[20:23], s30 offen offset:2048 sc1
    buffer_load_dwordx4 v[116:119], v1, s[20:23], s30 offen offset:3072 sc1
    s_add_u32 s30, s27, 16384
    buffer_load_dwordx4 v[120:123], v1, s[20:23], s30 offen offset:0 sc1
    buffer_load_dwordx4 v[124:127], v1, s[20:23], s30 offen offset:1024 sc1
    ds_read_b128 a[232:235], v10 offset:2048
    ds_read_b128 a[236:239], v10 offset:12288
    v_add_u32 v10, 0, v10
    s_add_u32 s27, s27, 18432
    s_waitcnt vmcnt(0) lgkmcnt(0)
    v_mfma_f32_16x16x32_bf16 v[148:151], v[56:59], a[232:235], v[148:151]
    v_mfma_f32_16x16x32_bf16 v[152:155], v[60:63], a[232:235], v[152:155]
    v_mfma_f32_16x16x32_bf16 v[156:159], v[64:67], a[232:235], v[156:159]
    v_mfma_f32_16x16x32_bf16 v[160:163], v[68:71], a[232:235], v[160:163]
    v_mfma_f32_16x16x32_bf16 v[164:167], v[72:75], a[232:235], v[164:167]
    v_mfma_f32_16x16x32_bf16 v[168:171], v[76:79], a[232:235], v[168:171]
    v_mfma_f32_16x16x32_bf16 v[172:175], v[80:83], a[232:235], v[172:175]
    v_mfma_f32_16x16x32_bf16 v[176:179], v[84:87], a[232:235], v[176:179]
    v_mfma_f32_16x16x32_bf16 v[180:183], v[88:91], a[232:235], v[180:183]
    v_mfma_f32_16x16x32_bf16 v[148:151], v[92:95], a[236:239], v[148:151]
    v_mfma_f32_16x16x32_bf16 v[152:155], v[96:99], a[236:239], v[152:155]
    v_mfma_f32_16x16x32_bf16 v[156:159], v[100:103], a[236:239], v[156:159]
    v_mfma_f32_16x16x32_bf16 v[160:163], v[104:107], a[236:239], v[160:163]
    v_mfma_f32_16x16x32_bf16 v[164:167], v[108:111], a[236:239], v[164:167]
    v_mfma_f32_16x16x32_bf16 v[168:171], v[112:115], a[236:239], v[168:171]
    v_mfma_f32_16x16x32_bf16 v[172:175], v[116:119], a[236:239], v[172:175]
    v_mfma_f32_16x16x32_bf16 v[176:179], v[120:123], a[236:239], v[176:179]
    v_mfma_f32_16x16x32_bf16 v[180:183], v[124:127], a[236:239], v[180:183]
    s_sub_u32 s28, s28, 1
    s_cmp_lg_u32 s28, 0
    s_cbranch_scc1 KM_sl4
    s_nop 7
    v_add_f32 v40, v148, v149
    v_add_f32 v41, v150, v151
    v_mul_f32 v42, v148, v148
    v_mul_f32 v43, v149, v149
    v_fmac_f32 v42, v150, v150
    v_fmac_f32 v43, v151, v151
    v_add_f32 v40, v40, v152
    v_fmac_f32 v42, v152, v152
    v_add_f32 v41, v41, v153
    v_fmac_f32 v43, v153, v153
    v_add_f32 v40, v40, v154
    v_fmac_f32 v42, v154, v154
    v_add_f32 v41, v41, v155
    v_fmac_f32 v43, v155, v155
    v_add_f32 v40, v40, v156
    v_fmac_f32 v42, v156, v156
    v_add_f32 v41, v41, v157
    v_fmac_f32 v43, v157, v157
    v_add_f32 v40, v40, v158
    v_fmac_f32 v42, v158, v158
    v_add_f32 v41, v41, v159
    v_fmac_f32 v43, v159, v159
    v_add_f32 v40, v40, v160
    v_fmac_f32 v42, v160, v160
    v_add_f32 v41, v41, v161
    v_fmac_f32 v43, v161, v161
    v_add_f32 v40, v40, v162
    v_fmac_f32 v42, v162, v162
    v_add_f32 v41, v41, v163
    v_fmac_f32 v43, v163, v163
    v_add_f32 v40, v40, v164
    v_fmac_f32 v42, v164, v164
    v_add_f32 v41, v41, v165
    v_fmac_f32 v43, v165, v165
    v_add_f32 v40, v40, v166
    v_fmac_f32 v42, v166, v166
    v_add_f32 v41, v41, v167
    v_fmac_f32 v43, v167, v167
    v_add_f32 v40, v40, v168
    v_fmac_f32 v42, v168, v168
    v_add_f32 v41, v41, v169
    v_fmac_f32 v43, v169, v169
    v_add_f32 v40, v40, v170
    v_fmac_f32 v42, v170, v170
    v_add_f32 v41, v41, v171
    v_fmac_f32 v43, v171, v171
    s_branch KM_ln
KA_aux:
    s_load_dwordx2 s[4:5], s[0:1], 32
    s_memrealtime s[62:63]
    v_and_b32 v1, 15, v0
    v_lshrrev_b32 v2, 4, v0
    s_mov_b32 s22, 268435456
    s_mov_b32 s23, 0x20000
    s_mov_b32 s18, 256
    s_mov_b32 s19, 0x20000
    s_waitcnt lgkmcnt(0)
    s_lshl2_add_u32 s46, s61, s26
    s_cmp_lg_u32 s46, 992
    s_cbranch_scc1 KA_nonc
    s_or_b32 s47, s63, 0x40000000
    v_mov_b32 v118, s62
    v_mov_b32 v119, s47
    s_mov_b64 exec, 1
    buffer_store_dwordx2 v[118:119], off, s[16:19], 0 sc1
    s_mov_b64 exec, -1
KA_nonc:
    s_mov_b32 s52, s46
    s_lshl_b32 s46, s61, 12
    s_mul_i32 s47, s26, 1024
    s_add_u32 s46, s46, s47
    s_add_u32 s46, s46, 41943040
    v_min_u32 v148, 7, v0
    v_lshlrev_b32 v148, 7, v148
    buffer_load_dword v149, v148, s[20:23], s46 offen
    s_mov_b32 s46, s52
    s_sub_u32 s62, s46, 968
    s_getpc_b64 s[46:47]
KA_pc:
    s_sub_u32 s46, s46, KA_pc-KA_fin
    s_subb_u32 s47, s47, 0
    s_lshl_b32 s48, s26, 13
    v_lshl_add_u32 v124, v0, 7, s48
    v_min_u32 v124, KM_slow-KA_fin, v124
    v_mov_b32 v125, 0
    v_lshl_add_u64 v[126:127], s[46:47], 0, v[124:125]
    global_load_dword v149, v[126:127], off
    s_add_u32 s48, s48, 32768
    v_lshl_add_u32 v124, v0, 7, s48
    v_min_u32 v124, KM_slow-KA_fin, v124
    v_mov_b32 v125, 0
    v_lshl_add_u64 v[126:127], s[46:47], 0, v[124:125]
    global_load_dword v149, v[126:127], off
    s_mov_b32 s6, 663552
    s_mov_b32 s7, 0x20000
    s_mul_i32 s46, s62, 3641
    s_lshr_b32 s46, s46, 16
    s_mul_i32 s47, s46, 18
    s_sub_u32 s47, s62, s47
    v_lshrrev_b32 v124, 3, v1
    v_lshl_add_u32 v124, s47, 1, v124
    v_and_b32 v125, 3, v124
    v_mul_u32_u24 v125, 162, v125
    v_lshrrev_b32 v124, 2, v124
    s_mul_i32 s48, s46, 9
    v_add3_u32 v124, v124, v125, s48
    v_and_b32 v125, 7, v1
    v_lshlrev_b32 v125, 4, v125
    v_lshl_add_u32 v125, v2, 8, v125
    v_lshl_add_u32 v16, v124, 10, v125
    s_mul_i32 s48, s46, 41472
    s_mov_b32 s49, 9216
    s_mov_b32 s50, 20736
    s_mov_b32 s51, 1152
    s_cmp_lt_u32 s46, 16
    s_cbranch_scc1 KA_wom0
    s_sub_u32 s48, s46, 16
    s_mul_i32 s48, s48, 331776
    s_add_u32 s48, s48, 18432
    s_mov_b32 s49, 82944
    s_mov_b32 s50, 165888
    s_mov_b32 s51, 19584
KA_wom0:
    s_lshl_b32 s47, s47, 6
    s_add_u32 s48, s48, s47
    v_and_b32 v124, 1, v2
    v_mul_u32_u24 v124, s49, v124
    v_lshrrev_b32 v125, 1, v2
    v_mad_u32_u24 v124, v125, s50, v124
    v_lshl_add_u32 v145, v1, 2, v124
    buffer_load_dword v8, v145, s[4:7], s48 offen
    s_add_u32 s48, s48, 1152
    buffer_load_dword v9, v145, s[4:7], s48 offen
    s_add_u32 s48, s48, s51
    buffer_load_dword v10, v145, s[4:7], s48 offen
    s_add_u32 s48, s48, 1152
    buffer_load_dword v11, v145, s[4:7], s48 offen
    s_add_u32 s48, s48, s51
    buffer_load_dword v12, v145, s[4:7], s48 offen
    s_add_u32 s48, s48, 1152
    buffer_load_dword v13, v145, s[4:7], s48 offen
    s_add_u32 s48, s48, s51
    buffer_load_dword v14, v145, s[4:7], s48 offen
    s_add_u32 s48, s48, 1152
    buffer_load_dword v15, v145, s[4:7], s48 offen
    s_add_u32 s62, s62, 56
    s_cmp_ge_u32 s62, 324
    s_cselect_b32 s63, 1073741824, 0
    s_min_u32 s62, s62, 323
    s_mul_i32 s46, s62, 3641
    s_lshr_b32 s46, s46, 16
    s_mul_i32 s47, s46, 18
    s_sub_u32 s47, s62, s47
    v_lshrrev_b32 v124, 3, v1
    v_lshl_add_u32 v124, s47, 1, v124
    v_and_b32 v125, 3, v124
    v_mul_u32_u24 v125, 162, v125
    v_lshrrev_b32 v124, 2, v124
    s_mul_i32 s48, s46, 9
    v_add3_u32 v124, v124, v125, s48
    v_and_b32 v125, 7, v1
    v_lshlrev_b32 v125, 4, v125
    v_lshl_add_u32 v125, v2, 8, v125
    v_lshl_add_u32 v26, v124, 10, v125
    s_mul_i32 s48, s46, 41472
    s_mov_b32 s49, 9216
    s_mov_b32 s50, 20736
    s_mov_b32 s51, 1152
    s_cmp_lt_u32 s46, 16
    s_cbranch_scc1 KA_wom1
    s_sub_u32 s48, s46, 16
    s_mul_i32 s48, s48, 331776
    s_add_u32 s48, s48, 18432
    s_mov_b32 s49, 82944
    s_mov_b32 s50, 165888
    s_mov_b32 s51, 19584
KA_wom1:
    s_lshl_b32 s47, s47, 6
    s_add_u32 s48, s48, s47
    v_and_b32 v124, 1, v2
    v_mul_u32_u24 v124, s49, v124
    v_lshrrev_b32 v125, 1, v2
    v_mad_u32_u24 v124, v125, s50, v124
    v_lshl_add_u32 v145, v1, 2, v124
    buffer_load_dword v18, v145, s[4:7], s48 offen
    s_add_u32 s48, s48, 1152
    buffer_load_dword v19, v145, s[4:7], s48 offen
    s_add_u32 s48, s48, s51
    buffer_load_dword v20, v145, s[4:7], s48 offen
    s_add_u32 s48, s48, 1152
    buffer_load_dword v21, v145, s[4:7], s48 offen
    s_add_u32 s48, s48, s51
    buffer_load_dword v22, v145, s[4:7], s48 offen
    s_add_u32 s48, s48, 1152
    buffer_load_dword v23, v145, s[4:7], s48 offen
    s_add_u32 s48, s48, s51
    buffer_load_dword v24, v145, s[4:7], s48 offen
    s_add_u32 s48, s48, 1152
    buffer_load_dword v25, v145, s[4:7], s48 offen
    s_add_u32 s62, s62, 56
    s_cmp_ge_u32 s62, 324
    s_cselect_b32 s63, 1073741824, 0
    s_min_u32 s62, s62, 323
    s_mul_i32 s46, s62, 3641
    s_lshr_b32 s46, s46, 16
    s_mul_i32 s47, s46, 18
    s_sub_u32 s47, s62, s47
    v_lshrrev_b32 v124, 3, v1
    v_lshl_add_u32 v124, s47, 1, v124
    v_and_b32 v125, 3, v124
    v_mul_u32_u24 v125, 162, v125
    v_lshrrev_b32 v124, 2, v124
    s_mul_i32 s48, s46, 9
    v_add3_u32 v124, v124, v125, s48
    v_and_b32 v125, 7, v1
    v_lshlrev_b32 v125, 4, v125
    v_lshl_add_u32 v125, v2, 8, v125
    v_lshl_add_u32 v36, v124, 10, v125
    s_mul_i32 s48, s46, 41472
    s_mov_b32 s49, 9216
    s_mov_b32 s50, 20736
    s_mov_b32 s51, 1152
    s_cmp_lt_u32 s46, 16
    s_cbranch_scc1 KA_wom2
    s_sub_u32 s48, s46, 16
    s_mul_i32 s48, s48, 331776
    s_add_u32 s48, s48, 18432
    s_mov_b32 s49, 82944
    s_mov_b32 s50, 165888
    s_mov_b32 s51, 19584
KA_wom2:
    s_lshl_b32 s47, s47, 6
    s_add_u32 s48, s48, s47
    v_and_b32 v124, 1, v2
    v_mul_u32_u24 v124, s49, v124
    v_lshrrev_b32 v125, 1, v2
    v_mad_u32_u24 v124, v125, s50, v124
    v_lshl_add_u32 v145, v1, 2, v124
    buffer_load_dword v28, v145, s[4:7], s48 offen
    s_add_u32 s48, s48, 1152
    buffer_load_dword v29, v145, s[4:7], s48 offen
    s_add_u32 s48, s48, s51
    buffer_load_dword v30, v145, s[4:7], s48 offen
    s_add_u32 s48, s48, 1152
    buffer_load_dword v31, v145, s[4:7], s48 offen
    s_add_u32 s48, s48, s51
    buffer_load_dword v32, v145, s[4:7], s48 offen
    s_add_u32 s48, s48, 1152
    buffer_load_dword v33, v145, s[4:7], s48 offen
    s_add_u32 s48, s48, s51
    buffer_load_dword v34, v145, s[4:7], s48 offen
    s_add_u32 s48, s48, 1152
    buffer_load_dword v35, v145, s[4:7], s48 offen
    s_add_u32 s62, s62, 56
    s_cmp_ge_u32 s62, 324
    s_cselect_b32 s63, 1073741824, 0
    s_min_u32 s62, s62, 323
    s_mul_i32 s46, s62, 3641
    s_lshr_b32 s46, s46, 16
    s_mul_i32 s47, s46, 18
    s_sub_u32 s47, s62, s47
    v_lshrrev_b32 v124, 3, v1
    v_lshl_add_u32 v124, s47, 1, v124
    v_and_b32 v125, 3, v124
    v_mul_u32_u24 v125, 162, v125
    v_lshrrev_b32 v124, 2, v124
    s_mul_i32 s48, s46, 9
    v_add3_u32 v124, v124, v125, s48
    v_and_b32 v125, 7, v1
    v_lshlrev_b32 v125, 4, v125
    v_lshl_add_u32 v125, v2, 8, v125
    v_lshl_add_u32 v46, v124, 10, v125
    s_mul_i32 s48, s46, 41472
    s_mov_b32 s49, 9216
    s_mov_b32 s50, 20736
    s_mov_b32 s51, 1152
    s_cmp_lt_u32 s46, 16
    s_cbranch_scc1 KA_wom3
    s_sub_u32 s48, s46, 16
    s_mul_i32 s48, s48, 331776
    s_add_u32 s48, s48, 18432
    s_mov_b32 s49, 82944
    s_mov_b32 s50, 165888
    s_mov_b32 s51, 19584
KA_wom3:
    s_lshl_b32 s47, s47, 6
    s_add_u32 s48, s48, s47
    v_and_b32 v124, 1, v2
    v_mul_u32_u24 v124, s49, v124
    v_lshrrev_b32 v125, 1, v2
    v_mad_u32_u24 v124, v125, s50, v124
    v_lshl_add_u32 v145, v1, 2, v124
    buffer_load_dword v38, v145, s[4:7], s48 offen
    s_add_u32 s48, s48, 1152
    buffer_load_dword v39, v145, s[4:7], s48 offen
    s_add_u32 s48, s48, s51
    buffer_load_dword v40, v145, s[4:7], s48 offen
    s_add_u32 s48, s48, 1152
    buffer_load_dword v41, v145, s[4:7], s48 offen
    s_add_u32 s48, s48, s51
    buffer_load_dword v42, v145, s[4:7], s48 offen
    s_add_u32 s48, s48, 1152
    buffer_load_dword v43, v145, s[4:7], s48 offen
    s_add_u32 s48, s48, s51
    buffer_load_dword v44, v145, s[4:7], s48 offen
    s_add_u32 s48, s48, 1152
    buffer_load_dword v45, v145, s[4:7], s48 offen
    s_add_u32 s62, s62, 56
    s_cmp_ge_u32 s62, 324
    s_cselect_b32 s63, 1073741824, 0
    s_min_u32 s62, s62, 323
    s_mul_i32 s46, s62, 3641
    s_lshr_b32 s46, s46, 16
    s_mul_i32 s47, s46, 18
    s_sub_u32 s47, s62, s47
    v_lshrrev_b32 v124, 3, v1
    v_lshl_add_u32 v124, s47, 1, v124
    v_and_b32 v125, 3, v124
    v_mul_u32_u24 v125, 162, v125
    v_lshrrev_b32 v124, 2, v124
    s_mul_i32 s48, s46, 9
    v_add3_u32 v124, v124, v125, s48
    v_and_b32 v125, 7, v1
    v_lshlrev_b32 v125, 4, v125
    v_lshl_add_u32 v125, v2, 8, v125
    v_lshl_add_u32 v56, v124, 10, v125
    s_mul_i32 s48, s46, 41472
    s_mov_b32 s49, 9216
    s_mov_b32 s50, 20736
    s_mov_b32 s51, 1152
    s_cmp_lt_u32 s46, 16
    s_cbranch_scc1 KA_wom4
    s_sub_u32 s48, s46, 16
    s_mul_i32 s48, s48, 331776
    s_add_u32 s48, s48, 18432
    s_mov_b32 s49, 82944
    s_mov_b32 s50, 165888
    s_mov_b32 s51, 19584
KA_wom4:
    s_lshl_b32 s47, s47, 6
    s_add_u32 s48, s48, s47
    v_and_b32 v124, 1, v2
    v_mul_u32_u24 v124, s49, v124
    v_lshrrev_b32 v125, 1, v2
    v_mad_u32_u24 v124, v125, s50, v124
    v_lshl_add_u32 v145, v1, 2, v124
    buffer_load_dword v48, v145, s[4:7], s48 offen
    s_add_u32 s48, s48, 1152
    buffer_load_dword v49, v145, s[4:7], s48 offen
    s_add_u32 s48, s48, s51
    buffer_load_dword v50, v145, s[4:7], s48 offen
    s_add_u32 s48, s48, 1152
    buffer_load_dword v51, v145, s[4:7], s48 offen
    s_add_u32 s48, s48, s51
    buffer_load_dword v52, v145, s[4:7], s48 offen
    s_add_u32 s48, s48, 1152
    buffer_load_dword v53, v145, s[4:7], s48 offen
    s_add_u32 s48, s48, s51
    buffer_load_dword v54, v145, s[4:7], s48 offen
    s_add_u32 s48, s48, 1152
    buffer_load_dword v55, v145, s[4:7], s48 offen
    s_add_u32 s62, s62, 56
    s_cmp_ge_u32 s62, 324
    s_cselect_b32 s63, 1073741824, 0
    s_min_u32 s62, s62, 323
    s_mul_i32 s46, s62, 3641
    s_lshr_b32 s46, s46, 16
    s_mul_i32 s47, s46, 18
    s_sub_u32 s47, s62, s47
    v_lshrrev_b32 v124, 3, v1
    v_lshl_add_u32 v124, s47, 1, v124
    v_and_b32 v125, 3, v124
    v_mul_u32_u24 v125, 162, v125
    v_lshrrev_b32 v124, 2, v124
    s_mul_i32 s48, s46, 9
    v_add3_u32 v124, v124, v125, s48
    v_and_b32 v125, 7, v1
    v_lshlrev_b32 v125, 4, v125
    v_lshl_add_u32 v125, v2, 8, v125
    v_lshl_add_u32 v66, v124, 10, v125
    s_mul_i32 s48, s46, 41472
    s_mov_b32 s49, 9216
    s_mov_b32 s50, 20736
    s_mov_b32 s51, 1152
    s_cmp_lt_u32 s46, 16
    s_cbranch_scc1 KA_wom5
    s_sub_u32 s48, s46, 16
    s_mul_i32 s48, s48, 331776
    s_add_u32 s48, s48, 18432
    s_mov_b32 s49, 82944
    s_mov_b32 s50, 165888
    s_mov_b32 s51, 19584
KA_wom5:
    s_lshl_b32 s47, s47, 6
    s_add_u32 s48, s48, s47
    v_and_b32 v124, 1, v2
    v_mul_u32_u24 v124, s49, v124
    v_lshrrev_b32 v125, 1, v2
    v_mad_u32_u24 v124, v125, s50, v124
    v_lshl_add_u32 v145, v1, 2, v124
    buffer_load_dword v58, v145, s[4:7], s48 offen
    s_add_u32 s48, s48, 1152
    buffer_load_dword v59, v145, s[4:7], s48 offen
    s_add_u32 s48, s48, s51
    buffer_load_dword v60, v145, s[4:7], s48 offen
    s_add_u32 s48, s48, 1152
    buffer_load_dword v61, v145, s[4:7], s48 offen
    s_add_u32 s48, s48, s51
    buffer_load_dword v62, v145, s[4:7], s48 offen
    s_add_u32 s48, s48, 1152
    buffer_load_dword v63, v145, s[4:7], s48 offen
    s_add_u32 s48, s48, s51
    buffer_load_dword v64, v145, s[4:7], s48 offen
    s_add_u32 s48, s48, 1152
    buffer_load_dword v65, v145, s[4:7], s48 offen
    v_or_b32 v66, s63, v66
    s_add_u32 s62, s62, 56
    s_cmp_ge_u32 s62, 324
    s_cselect_b32 s63, 1073741824, 0
    s_min_u32 s62, s62, 323
    s_mov_b32 s46, 0x05040100
    s_mov_b32 s47, 0x07060302
    s_mov_b32 s48, 2621440
    s_lshl_b32 s49, s26, 11
    v_lshl_add_u32 v118, v0, 5, s49
    v_and_b32 v119, 7, v0
    v_lshrrev_b32 v120, 3, v0
    v_lshlrev_b32 v119, 4, v119
    v_lshl_add_u32 v119, v120, 8, v119
    v_add_u32 v119, s49, v119
    s_waitcnt vmcnt(40)
    v_perm_b32 v136, v9, v8, s46
    v_perm_b32 v137, v11, v10, s46
    v_perm_b32 v138, v13, v12, s46
    v_perm_b32 v139, v15, v14, s46
    ds_write_b128 v118, v[136:139] offset:0
    v_perm_b32 v140, v9, v8, s47
    v_perm_b32 v141, v11, v10, s47
    v_perm_b32 v142, v13, v12, s47
    v_perm_b32 v143, v15, v14, s47
    ds_write_b128 v118, v[140:143] offset:16
    ds_read_b128 v[8:11], v119 offset:0
    ds_read_b128 v[12:15], v119 offset:128
    s_waitcnt lgkmcnt(0)
    buffer_store_dwordx4 v[8:11], v16, s[20:23], s48 offen offset:0 sc1
    buffer_store_dwordx4 v[12:15], v16, s[20:23], s48 offen offset:128 sc1
    s_waitcnt vmcnt(34)
    v_perm_b32 v136, v19, v18, s46
    v_perm_b32 v137, v21, v20, s46
    v_perm_b32 v138, v23, v22, s46
    v_perm_b32 v139, v25, v24, s46
    ds_write_b128 v118, v[136:139] offset:0
    v_perm_b32 v140, v19, v18, s47
    v_perm_b32 v141, v21, v20, s47
    v_perm_b32 v142, v23, v22, s47
    v_perm_b32 v143, v25, v24, s47
    ds_write_b128 v118, v[140:143] offset:16
    ds_read_b128 v[18:21], v119 offset:0
    ds_read_b128 v[22:25], v119 offset:128
    s_waitcnt lgkmcnt(0)
    buffer_store_dwordx4 v[18:21], v26, s[20:23], s48 offen offset:0 sc1
    buffer_store_dwordx4 v[22:25], v26, s[20:23], s48 offen offset:128 sc1
    s_waitcnt vmcnt(28)
    v_perm_b32 v136, v29, v28, s46
    v_perm_b32 v137, v31, v30, s46
    v_perm_b32 v138, v33, v32, s46
    v_perm_b32 v139, v35, v34, s46
    ds_write_b128 v118, v[136:139] offset:0
    v_perm_b32 v140, v29, v28, s47
    v_perm_b32 v141, v31, v30, s47
    v_perm_b32 v142, v33, v32, s47
    v_perm_b32 v143, v35, v34, s47
    ds_write_b128 v118, v[140:143] offset:16
    ds_read_b128 v[28:31], v119 offset:0
    ds_read_b128 v[32:35], v119 offset:128
    s_waitcnt lgkmcnt(0)
    buffer_store_dwordx4 v[28:31], v36, s[20:23], s48 offen offset:0 sc1
    buffer_store_dwordx4 v[32:35], v36, s[20:23], s48 offen offset:128 sc1
    s_waitcnt vmcnt(22)
    v_perm_b32 v136, v39, v38, s46
    v_perm_b32 v137, v41, v40, s46
    v_perm_b32 v138, v43, v42, s46
    v_perm_b32 v139, v45, v44, s46
    ds_write_b128 v118, v[136:139] offset:0
    v_perm_b32 v140, v39, v38, s47
    v_perm_b32 v141, v41, v40, s47
    v_perm_b32 v142, v43, v42, s47
    v_perm_b32 v143, v45, v44, s47
    ds_write_b128 v118, v[140:143] offset:16
    ds_read_b128 v[38:41], v119 offset:0
    ds_read_b128 v[42:45], v119 offset:128
    s_waitcnt lgkmcnt(0)
    buffer_store_dwordx4 v[38:41], v46, s[20:23], s48 offen offset:0 sc1
    buffer_store_dwordx4 v[42:45], v46, s[20:23], s48 offen offset:128 sc1
    s_waitcnt vmcnt(16)
    v_perm_b32 v136, v49, v48, s46
    v_perm_b32 v137, v51, v50, s46
    v_perm_b32 v138, v53, v52, s46
    v_perm_b32 v139, v55, v54, s46
    ds_write_b128 v118, v[136:139] offset:0
    v_perm_b32 v140, v49, v48, s47
    v_perm_b32 v141, v51, v50, s47
    v_perm_b32 v142, v53, v52, s47
    v_perm_b32 v143, v55, v54, s47
    ds_write_b128 v118, v[140:143] offset:16
    ds_read_b128 v[48:51], v119 offset:0
    ds_read_b128 v[52:55], v119 offset:128
    s_waitcnt lgkmcnt(0)
    buffer_store_dwordx4 v[48:51], v56, s[20:23], s48 offen offset:0 sc1
    buffer_store_dwordx4 v[52:55], v56, s[20:23], s48 offen offset:128 sc1
    s_waitcnt vmcnt(10)
    v_perm_b32 v136, v59, v58, s46
    v_perm_b32 v137, v61, v60, s46
    v_perm_b32 v138, v63, v62, s46
    v_perm_b32 v139, v65, v64, s46
    ds_write_b128 v118, v[136:139] offset:0
    v_perm_b32 v140, v59, v58, s47
    v_perm_b32 v141, v61, v60, s47
    v_perm_b32 v142, v63, v62, s47
    v_perm_b32 v143, v65, v64, s47
    ds_write_b128 v118, v[140:143] offset:16
    ds_read_b128 v[58:61], v119 offset:0
    ds_read_b128 v[62:65], v119 offset:128
    s_waitcnt lgkmcnt(0)
    buffer_store_dwordx4 v[58:61], v66, s[20:23], s48 offen offset:0 sc1
    buffer_store_dwordx4 v[62:65], v66, s[20:23], s48 offen offset:128 sc1
    buffer_load_dwordx2 v[150:151], off, s[16:19], 0 sc1
    s_branch KA_fin
.section .rodata,"a"
.p2align 6
.amdhsa_kernel sequential_preLN__grouped_kv_mqa__glu_gated_geglu__prompt_kernel
  .amdhsa_next_free_vgpr 512
  .amdhsa_next_free_sgpr 102
  .amdhsa_accum_offset 256
  .amdhsa_group_segment_fixed_size 0
  .amdhsa_kernarg_size 96
  .amdhsa_user_sgpr_count 2
  .amdhsa_user_sgpr_kernarg_segment_ptr 1
  .amdhsa_system_sgpr_workgroup_id_x 1
.end_amdhsa_kernel
```
